```python
import torch

def _softmax(x, axis=-1):
    return torch.softmax(x, dim=axis)
def _gelu(x):
    return torch.nn.functional.gelu(x, approximate="tanh")
def _silu(x):
    return torch.nn.functional.silu(x)
def _sigmoid(x):
    return torch.sigmoid(x)
def _layernorm(x, axis=-1, eps=1e-5):
    m = x.mean(dim=axis, keepdim=True)
    v = x.var(dim=axis, keepdim=True, unbiased=False)
    return (x - m) / torch.sqrt(v + eps)
def _scatter_add(tgt, idx, src, axis=0):
    return tgt.clone().index_add_(axis, idx, src)
def _segment_sum(src, seg, n):
    out = torch.zeros((n,) + src.shape[1:], dtype=src.dtype)
    return out.index_add_(0, seg, src)
def _pad(x, pw):
    flat = tuple(v for pair in reversed(pw) for v in pair)
    return torch.nn.functional.pad(x, flat)

kernel_name = 'interleave_layers__sliding_local_dilated__glu_gated_glu__prompt'

def setup_inputs():

    _w = (lambda a: (lambda t: t.to(torch.bfloat16) if t.is_floating_point() else t)(torch.as_tensor(a)))
    def _A_setup():
        B, S, D = 1, 2048, 512
        return {
            "x": _w((lambda *s: torch.randn(*s, dtype=torch.bfloat16) * 0.05)(B, S, D)),
            "wqkv": _w((lambda *s: torch.randn(*s, dtype=torch.bfloat16) * 0.05)(D, 3 * D)),
            "wo": _w((lambda *s: torch.randn(*s, dtype=torch.bfloat16) * 0.05)(D, D)),
        }
    _A_in = _A_setup()

    def _B_setup():
        B, S, D, F = 1, 2048, 512, 1792
        return {
            "x": _w((lambda *s: torch.randn(*s, dtype=torch.bfloat16) * 0.05)(B, S, D)),
            "w_gate": _w((lambda *s: torch.randn(*s, dtype=torch.bfloat16) * 0.05)(D, F)),
            "w_up": _w((lambda *s: torch.randn(*s, dtype=torch.bfloat16) * 0.05)(D, F)),
            "w_down": _w((lambda *s: torch.randn(*s, dtype=torch.bfloat16) * 0.05)(F, D)),
        }
    _B_in = _B_setup()

    return {
        "A_x": _A_in["x"],
        "A_wqkv": _A_in["wqkv"],
        "A_wo": _A_in["wo"],
        "B_x": _B_in["x"],
        "B_w_gate": _B_in["w_gate"],
        "B_w_up": _B_in["w_up"],
        "B_w_down": _B_in["w_down"],
    }

def reference(A_x, A_wqkv, A_wo, B_x, B_w_gate, B_w_up, B_w_down):
    def _A_ref(x, wqkv, wo):
        B, S, D = x.shape
        H = 32; Dh = D // H
        W, dil = 8, 2
        qkv = (lambda x, *d: x.permute(*d))((x @ wqkv).reshape(B, S, 3, H, Dh), 2, 0, 3, 1, 4)
        q, k, v = qkv[0], qkv[1], qkv[2]
        scale = Dh ** -0.5
        pos = torch.arange(S)
        off = torch.arange(W) * dil
        idx = pos[:, None] - off[None, :]
        mask = idx >= 0
        idx_c = torch.where(mask, idx, 0).reshape(-1)
        kg = k[:, :, idx_c, :].reshape(B, H, S, W, Dh)
        vg = v[:, :, idx_c, :].reshape(B, H, S, W, Dh)
        logits = torch.einsum("bhsd,bhswd->bhsw", q, kg) * scale
        logits = torch.where(mask[None, None, :, :], logits, -1e9)
        attn = _softmax(logits, axis=-1)
        o = torch.einsum("bhsw,bhswd->bhsd", attn, vg)
        return (lambda x, *d: x.permute(*d))(o, 0, 2, 1, 3).reshape(B, S, D) @ wo

    def _B_ref(x, w_gate, w_up, w_down):
        g = torch.einsum("bsd,df->bsf", x, w_gate)
        u = torch.einsum("bsd,df->bsf", x, w_up)
        h = _sigmoid(g) * u
        return torch.einsum("bsf,fd->bsd", h, w_down)

    x = A_x
    x = x + _A_ref(_layernorm(x, axis=-1), A_wqkv, A_wo)
    x = x + _B_ref(_layernorm(x, axis=-1), B_w_gate, B_w_up, B_w_down)
    x = x + _A_ref(_layernorm(x, axis=-1), A_wqkv, A_wo)
    x = x + _B_ref(_layernorm(x, axis=-1), B_w_gate, B_w_up, B_w_down)
    return x
```

```asm
; @launch grid=(256,1,1) block=(256,1,1) lds=163840
.amdgcn_target "amdgcn-amd-amdhsa--gfx950"
.text
.globl interleave_layers__sliding_local_dilated__glu_gated_glu__prompt_kernel
.p2align 8
.type interleave_layers__sliding_local_dilated__glu_gated_glu__prompt_kernel,@function
interleave_layers__sliding_local_dilated__glu_gated_glu__prompt_kernel:
s_cmp_ge_u32 s2, 256
s_cbranch_scc1 L_end
s_load_dwordx16 s[64:79], s[0:1], 0
s_load_dwordx4 s[80:83], s[0:1], 64
s_getpc_b64 s[100:101]
Lpc:
v_lshrrev_b32 v1, 6, v0
v_and_b32 v0, 63, v0
s_lshr_b32 s89, s2, 3
s_xor_b32 s89, s89, 0
v_readfirstlane_b32 s36, v1
s_lshl_b32 s90, s89, 11
v_and_b32 v10, 3, v0
v_lshl_add_u32 v10, v1, 2, v10
v_lshl_add_u32 v10, v10, 7, s90
v_min_u32 v10, L_last-Lpc-4, v10
global_load_dword v35, v10, s[100:101]
s_and_b32 s88, s2, 7
s_lshr_b32 s86, s89, 3
s_and_b32 s44, s89, 7
s_lshr_b32 s90, s88, 1
s_lshl_b32 s90, s90, 2
s_add_u32 s90, s90, s86
s_and_b32 s91, s88, 1
s_lshl_b32 s85, s86, 1
s_add_u32 s85, s85, s91
s_lshl_b32 s85, s86, 1
s_cmp_eq_u32 s44, 3
s_cselect_b32 s85, s85, 0
s_xor_b32 s85, s85, s88
s_lshl_b32 s3, s85, 7
s_lshl_b32 s39, s90, 17
s_lshl_b32 s91, s91, 10
s_add_u32 s39, s39, s91
s_cmp_eq_u32 s90, 0
s_cselect_b32 s47, 0, 1
s_cselect_b32 s91, 0, 16384
s_sub_u32 s40, s39, s91
s_lshl_b32 s56, s36, 15
s_add_u32 s56, s56, s39
s_lshl_b32 s61, s36, 11
s_mul_i32 s84, s36, 3072
v_lshrrev_b32 v200, 3, v0
v_and_b32 v201, 7, v0
v_lshrrev_b32 v202, 1, v200
v_xor_b32 v203, v201, v202
v_lshlrev_b32 v203, 4, v203
v_lshl_add_u32 v2, v200, 11, v203
v_xor_b32 v124, 64, v2
v_add_u32 v3, 15360, v124
v_and_b32 v204, 1, v202
s_and_b32 s91, s36, 1
s_lshl_b32 s91, s91, 2
v_lshl_add_u32 v205, v204, 1, s91
v_xor_b32 v205, v205, v201
v_lshlrev_b32 v205, 4, v205
s_mul_i32 s91, s36, 24576
s_lshl_b32 s92, s44, 7
s_add_u32 s91, s91, s92
v_mul_u32_u24 v206, 3072, v200
v_add3_u32 v4, v205, v206, s91
s_waitcnt lgkmcnt(0)
s_mov_b32 s4, s64
s_and_b32 s5, s65, 0xffff
s_mov_b32 s6, 2097152
s_mov_b32 s7, 0x20000
s_mov_b32 s8, s66
s_and_b32 s9, s67, 0xffff
s_mov_b32 s10, 1572864
s_mov_b32 s11, 0x20000
s_add_u32 m0, s61, 0
s_xor_b32 s38, s3, 0
s_add_u32 s38, s38, s56
buffer_load_dwordx4 v2, s[4:7], s38 offen lds
buffer_load_dwordx4 v3, s[4:7], s38 offen offset:1024 lds
s_add_u32 m0, s84, 73728
s_xor_b32 s59, s85, 0
s_mul_i32 s59, s59, 196608
buffer_load_dwordx4 v4, s[8:11], s59 offen offset:0 lds
buffer_load_dwordx4 v4, s[8:11], s59 offen offset:1024 lds
buffer_load_dwordx4 v4, s[8:11], s59 offen offset:2048 lds
s_mov_b32 s32, 0xff00ff00
s_mov_b32 s33, 0xff00ff00
v_lshrrev_b32 v40, 4, v0
v_and_b32 v41, 15, v0
v_lshrrev_b32 v42, 2, v41
v_and_b32 v43, 3, v0
s_add_u32 m0, s61, 65536
s_lshl_b32 s38, s36, 8
s_add_u32 s38, s38, 0
s_xor_b32 s38, s38, s3
s_add_u32 s38, s38, s40
buffer_load_dwordx4 v124, s[4:7], s38 offen lds
v_lshrrev_b32 v44, 1, v42
v_and_b32 v45, 1, v40
v_lshl_add_u32 v46, v45, 1, v44
v_xor_b32 v46, s36, v46
v_lshlrev_b32 v46, 5, v46
v_lshl_add_u32 v46, v43, 3, v46
v_lshl_add_u32 v46, v42, 7, v46
v_mul_u32_u24 v47, 3072, v40
v_add_u32 v46, v46, v47
v_add_u32 v5, 73728, v46
v_add_u32 v6, 122880, v46
v_lshrrev_b32 v46, 1, v41
v_xor_b32 v46, v46, v40
v_lshlrev_b32 v46, 4, v46
v_lshl_add_u32 v7, v41, 7, v46
v_xor_b32 v8, 64, v7
s_getreg_b32 s60, hwreg(HW_REG_XCC_ID)
s_add_u32 m0, s61, 66560
s_lshl_b32 s38, s36, 8
s_add_u32 s38, s38, 128
s_xor_b32 s38, s38, s3
s_add_u32 s38, s38, s40
buffer_load_dwordx4 v124, s[4:7], s38 offen lds
s_and_b32 s60, s60, 15
s_add_u32 s60, s60, 1
s_and_b32 s43, s89, 15
s_lshl_b32 s41, s88, 2
s_add_u32 s41, s41, s86
s_lshr_b32 s42, s41, 1
s_cmp_eq_u32 s86, 0
s_cselect_b32 s91, 5, 1
s_sub_u32 s48, s41, s91
s_cmp_eq_u32 s90, 0
s_cselect_b32 s48, s41, s48
s_lshl_b32 s45, s36, 10
s_lshl_b32 s46, s36, 12
s_and_b32 s91, s36, 1
s_lshl_b32 s57, s41, 1
s_add_u32 s57, s57, s91
s_and_b32 s91, s42, 1
s_add_u32 m0, s84, 86016
s_add_u32 s59, s59, 98304
buffer_load_dwordx4 v4, s[8:11], s59 offen offset:0 lds
s_and_b32 s87, s88, 3
s_lshl_b32 s87, s87, 1
s_add_u32 s87, s87, s91
v_lshlrev_b32 v1, 4, v0
s_mov_b32 s12, s68
s_and_b32 s13, s69, 0xffff
s_mov_b32 s14, 524288
s_mov_b32 s15, 0x20000
s_bitcmp1_b32 s36, 0
s_cselect_b32 s72, s74, s72
s_cselect_b32 s73, s75, s73
s_mov_b32 s16, s72
s_and_b32 s17, s73, 0xffff
s_mov_b32 s18, 1835008
s_mov_b32 s19, 0x20000
s_mov_b32 s20, s76
s_and_b32 s21, s77, 0xffff
buffer_load_dwordx4 v4, s[8:11], s59 offen offset:1024 lds
s_mov_b32 s22, 1835008
s_mov_b32 s23, 0x20000
s_mov_b32 s24, s78
s_and_b32 s25, s79, 0xffff
s_mov_b32 s26, 2097152
s_mov_b32 s27, 0x20000
s_mov_b32 s28, s82
s_and_b32 s29, s83, 0xffff
s_mov_b32 s30, 268435456
s_mov_b32 s31, 0x20000
s_cmp_ge_u32 s43, 14
s_cselect_b32 s49, 1, 0
s_lshr_b32 s93, s36, 1
s_and_b32 s94, s86, 1
s_lshl_b32 s94, s94, 5
s_mov_b32 s34, -1
s_mov_b32 s35, 0
buffer_load_dwordx4 v4, s[8:11], s59 offen offset:2048 lds
s_lshl_b64 s[54:55], s[34:35], s94
s_lshl_b32 s91, s93, 4
s_add_u32 s91, s91, s94
s_mov_b32 s34, 0xffff
s_lshl_b64 s[50:51], s[34:35], s91
s_mul_i32 s91, s93, 28
s_mov_b32 s34, 0xfffffff
s_lshl_b64 s[52:53], s[34:35], s91
s_mul_i32 s91, s93, 28672
s_lshl_b32 s94, s43, 8
s_add_u32 s91, s91, s94
v_mul_u32_u24 v206, 3584, v200
v_add3_u32 v36, v205, v206, s91
v_lshlrev_b32 v205, 2, v204
v_xor_b32 v205, v205, v201
v_lshlrev_b32 v205, 4, v205
s_add_u32 m0, s61, 8192
s_xor_b32 s38, s3, 128
s_add_u32 s38, s38, s56
buffer_load_dwordx4 v2, s[4:7], s38 offen lds
v_lshl_add_u32 v205, v200, 10, v205
s_lshl_b32 s91, s36, 13
s_add_u32 s94, s91, s92
v_add_u32 v9, s94, v205
s_mul_i32 s64, s93, 917504
s_and_b32 s94, s36, 1
s_lshl_b32 s94, s94, 15
s_add_u32 s64, s64, s94
s_sub_u32 s64, s64, s91
v_lshrrev_b32 v200, 4, v0
v_and_b32 v201, 15, v0
v_lshrrev_b32 v202, 2, v201
v_and_b32 v203, 3, v0
v_lshrrev_b32 v204, 1, v202
v_and_b32 v205, 1, v200
v_lshrrev_b32 v207, 1, v200
v_lshrrev_b32 v208, 1, v203
buffer_load_dwordx4 v3, s[4:7], s38 offen offset:1024 lds
v_and_b32 v209, 1, v203
v_lshl_add_u32 v210, v209, 1, v208
v_lshl_add_u32 v210, v205, 2, v210
v_lshlrev_b32 v210, 3, v210
v_xor_b32 v211, s93, v204
v_lshl_add_u32 v210, v211, 6, v210
v_lshl_add_u32 v210, v202, 7, v210
v_lshl_add_u32 v11, v207, 10, v210
v_xor_b32 v12, 64, v11
v_lshl_add_u32 v210, v209, 1, v205
v_lshlrev_b32 v210, 3, v210
v_lshl_add_u32 v211, v208, 1, v204
v_xor_b32 v211, s36, v211
v_lshl_add_u32 v210, v211, 5, v210
v_lshl_add_u32 v210, v202, 7, v210
v_lshl_add_u32 v210, v208, 12, v210
v_lshl_add_u32 v37, v207, 13, v210
s_add_u32 m0, s84, 98304
s_xor_b32 s59, s85, 1
s_mul_i32 s59, s59, 196608
buffer_load_dwordx4 v4, s[8:11], s59 offen offset:0 lds
v_and_b32 v200, 31, v0
v_lshrrev_b32 v201, 5, v0
v_lshlrev_b32 v201, 4, v201
v_lshl_add_u32 v200, v200, 11, v201
s_and_b32 s91, s36, 1
s_lshl_b32 s91, s91, 16
s_lshl_b32 s94, s93, 6
s_add_u32 s91, s91, s94
s_add_u32 s91, s91, s92
v_add_u32 v13, s91, v200
s_lshl_b32 s91, s42, 8
s_add_u32 s91, s91, 12320768
v_lshl_add_u32 v14, v0, 2, s91
s_lshl_b32 s94, s43, 2
s_add_u32 s94, s94, s36
s_lshl_b32 s94, s94, 2
s_add_u32 s91, s91, s94
buffer_load_dwordx4 v4, s[8:11], s59 offen offset:1024 lds
v_mov_b32 v15, s91
v_mov_b32 v200, 0x7ff00000
v_cmp_eq_u32 vcc, 0, v0
s_nop 1
v_cndmask_b32 v15, v200, v15, vcc
s_add_u32 s91, s36, 0
s_xor_b32 s91, s91, s87
s_lshl_b32 s91, s91, 12
s_lshl_b32 s94, s42, 17
s_add_u32 s65, s91, s94
s_add_u32 s91, s36, 4
s_xor_b32 s91, s91, s87
s_lshl_b32 s91, s91, 12
s_lshl_b32 s94, s42, 17
s_add_u32 s66, s91, s94
s_cmp_eq_u32 s85, 7
s_cselect_b32 s91, 3, s85
s_lshl_b32 s69, s91, 13
buffer_load_dwordx4 v4, s[8:11], s59 offen offset:2048 lds
s_add_u32 s70, s69, 8192
s_cmp_eq_u32 s70, 57344
s_cselect_b32 s70, 0, s70
s_add_u32 s71, s70, 8192
s_cmp_eq_u32 s71, 57344
s_cselect_b32 s71, 0, s71
s_add_u32 s72, s71, 8192
s_cmp_eq_u32 s72, 57344
s_cselect_b32 s72, 0, s72
s_add_u32 s73, s72, 8192
s_cmp_eq_u32 s73, 57344
s_cselect_b32 s73, 0, s73
s_add_u32 s74, s73, 8192
s_cmp_eq_u32 s74, 57344
s_cselect_b32 s74, 0, s74
s_add_u32 s75, s74, 8192
s_add_u32 m0, s84, 110592
s_add_u32 s59, s59, 98304
buffer_load_dwordx4 v4, s[8:11], s59 offen offset:0 lds
s_cmp_eq_u32 s75, 57344
s_cselect_b32 s75, 0, s75
s_cmp_eq_u32 s86, 3
s_cselect_b32 s91, 5, 1
s_add_u32 s83, s41, s91
s_cmp_eq_u32 s90, 15
s_cselect_b32 s83, s41, s83
s_lshr_b32 s91, s83, 1
v_mov_b32 v252, s42
v_mov_b32 v253, s91
v_cmp_eq_u32 vcc, 0, v0
s_nop 1
v_cndmask_b32 v252, v253, v252, vcc
v_lshlrev_b32 v252, 7, v252
s_mov_b32 s91, 12328960
buffer_load_dword v253, v252, s[28:31], s91 offen sc1
v_mov_b32 v216, -1
v_mov_b32 v217, -1
buffer_load_dwordx4 v4, s[8:11], s59 offen offset:1024 lds
v_mov_b32 v218, -1
v_mov_b32 v219, -1
s_lshl_b32 s88, s41, 5
s_lshl_b32 s91, s44, 2
s_add_u32 s88, s88, s91
s_add_u32 s88, s88, s36
s_lshl_b32 s88, s88, 8
s_add_u32 s88, s88, 11534336
s_lshl_b32 s91, s41, 7
s_lshl_b32 s94, s36, 4
s_add_u32 s91, s91, s94
s_add_u32 s91, s91, 12058624
s_cmp_eq_u32 s44, 0
s_cselect_b32 s91, s91, 0x7ff00000
v_mov_b32 v222, s91
s_mov_b64 exec, 0xffff
buffer_store_dwordx4 v[216:219], v1, s[28:31], s88 offen sc1
s_mov_b64 exec, 1
buffer_store_dwordx4 v[216:219], v222, s[28:31], 0 offen sc1
s_mov_b64 exec, -1
buffer_load_dwordx4 v4, s[8:11], s59 offen offset:2048 lds
v_and_b32 v196, 1023, v7
v_not_b32 v197, v0
v_and_b32 v197, 8, v197
v_lshlrev_b32 v197, 3, v197
v_xor_b32 v196, v196, v197
v_add_u32 v196, 65536, v196
v_xor_b32 v197, 64, v196
v_add_u32 v126, s61, v7
v_xor_b32 v127, 64, v126
v_mov_b32 v120, 0x3f803f80
v_mov_b32 v121, 0x3f803f80
v_mov_b32 v122, 0x3f803f80
v_mov_b32 v123, 0x3f803f80
v_mov_b32 v112, 0x3f803f80
v_mov_b32 v113, 0x3f803f80
v_mov_b32 v114, 0x3f803f80
v_mov_b32 v115, 0x3f803f80
v_mov_b32 v172, 0x3f803f80
v_mov_b32 v173, 0x3f803f80
v_mov_b32 v174, 0x3f803f80
v_mov_b32 v175, 0x3f803f80
v_mov_b32 v180, 0x3f803f80
v_mov_b32 v181, 0x3f803f80
v_mov_b32 v182, 0x3f803f80
v_mov_b32 v183, 0x3f803f80
buffer_load_dwordx4 v[16:19], v13, s[4:7], s39 offen offset:0
buffer_load_dwordx4 v[20:23], v13, s[4:7], s39 offen offset:32
v_mov_b32 v124, v196
v_mov_b32 v125, v197
s_branch Lmain
.p2align 12
Lmain:
s_mov_b64 exec, 0
s_cmp_eq_u32 s36, 0
s_cbranch_scc1 Lpage1
s_cmp_eq_u32 s36, 1
s_cbranch_scc1 Lpage2
s_cmp_eq_u32 s36, 2
s_cbranch_scc1 Lpage3
s_branch Lpage4
Ltour0:
s_mov_b64 exec, -1
s_waitcnt vmcnt(16)
s_barrier
ds_read_b64_tr_b16 v[224:225], v5 offset:0
ds_read_b64_tr_b16 v[226:227], v5 offset:512
ds_read_b64_tr_b16 v[228:229], v5 offset:1024
ds_read_b64_tr_b16 v[230:231], v5 offset:1536
ds_read_b64_tr_b16 v[232:233], v5 offset:2048
ds_read_b64_tr_b16 v[234:235], v5 offset:2560
s_mov_b64 exec, s[32:33]
ds_read_b128 v[112:115], v124 offset:0
s_mov_b64 exec, -1
ds_read_b128 v[96:99], v7 offset:0
ds_read_b128 v[100:103], v7 offset:2048
ds_read_b128 v[104:107], v7 offset:4096
ds_read_b128 v[108:111], v7 offset:6144
s_waitcnt lgkmcnt(9)
v_mfma_f32_16x16x32_bf16 v[24:27], v[224:227], v[120:123], 0
s_waitcnt vmcnt(8) lgkmcnt(5)
s_barrier
s_waitcnt lgkmcnt(4)
v_mfma_f32_16x16x32_bf16 v[56:59], v[228:231], v[112:115], 0
s_add_u32 m0, s61, 16384
s_xor_b32 s38, s3, 256
s_add_u32 s38, s38, s56
buffer_load_dwordx4 v2, s[4:7], s38 offen lds
v_mfma_f32_16x16x32_bf16 v[76:79], v[112:115], v[232:235], 0
ds_read_b64_tr_b16 v[236:237], v5 offset:12288
ds_read_b64_tr_b16 v[238:239], v5 offset:12800
s_waitcnt lgkmcnt(5)
v_mfma_f32_16x16x32_bf16 v[40:43], v[224:227], v[96:99], 0
ds_read_b64_tr_b16 v[240:241], v5 offset:13312
v_mfma_f32_16x16x32_bf16 v[60:63], v[228:231], v[96:99], 0
buffer_load_dwordx4 v3, s[4:7], s38 offen offset:1024 lds
v_mfma_f32_16x16x32_bf16 v[80:83], v[96:99], v[232:235], 0
s_add_u32 m0, s84, 122880
s_xor_b32 s59, s85, 2
s_waitcnt lgkmcnt(5)
v_mfma_f32_16x16x32_bf16 v[44:47], v[224:227], v[100:103], 0
s_mul_i32 s59, s59, 196608
ds_read_b64_tr_b16 v[242:243], v5 offset:13824
v_mfma_f32_16x16x32_bf16 v[64:67], v[228:231], v[100:103], 0
buffer_load_dwordx4 v4, s[8:11], s59 offen offset:0 lds
v_mfma_f32_16x16x32_bf16 v[84:87], v[100:103], v[232:235], 0
s_mov_b64 exec, s[32:33]
ds_read_b128 v[112:115], v125 offset:0
s_mov_b64 exec, -1
s_waitcnt lgkmcnt(6)
v_mfma_f32_16x16x32_bf16 v[48:51], v[224:227], v[104:107], 0
ds_read_b64_tr_b16 v[244:245], v5 offset:14336
ds_read_b64_tr_b16 v[246:247], v5 offset:14848
v_mfma_f32_16x16x32_bf16 v[68:71], v[228:231], v[104:107], 0
buffer_load_dwordx4 v4, s[8:11], s59 offen offset:1024 lds
ds_read_b128 v[96:99], v8 offset:0
v_mfma_f32_16x16x32_bf16 v[88:91], v[104:107], v[232:235], 0
ds_read_b128 v[100:103], v8 offset:2048
s_waitcnt lgkmcnt(9)
v_mfma_f32_16x16x32_bf16 v[52:55], v[224:227], v[108:111], 0
ds_read_b128 v[104:107], v8 offset:4096
v_mfma_f32_16x16x32_bf16 v[72:75], v[228:231], v[108:111], 0
buffer_load_dwordx4 v4, s[8:11], s59 offen offset:2048 lds
v_mfma_f32_16x16x32_bf16 v[92:95], v[108:111], v[232:235], 0
s_cmp_lg_u32 s49, 0
s_cselect_b32 s18, 0, s18
s_waitcnt lgkmcnt(3)
v_mfma_f32_16x16x32_bf16 v[24:27], v[236:239], v[120:123], v[24:27]
s_add_u32 m0, s61, 24576
s_xor_b32 s38, s3, 384
v_mfma_f32_16x16x32_bf16 v[56:59], v[240:243], v[112:115], v[56:59]
s_add_u32 s38, s38, s56
ds_read_b128 v[108:111], v8 offset:6144
v_mfma_f32_16x16x32_bf16 v[76:79], v[112:115], v[244:247], v[76:79]
buffer_load_dwordx4 v2, s[4:7], s38 offen lds
s_waitcnt lgkmcnt(2)
v_mfma_f32_16x16x32_bf16 v[40:43], v[236:239], v[96:99], v[40:43]
ds_read_b64_tr_b16 v[224:225], v5 offset:24576
ds_read_b64_tr_b16 v[226:227], v5 offset:25088
v_mfma_f32_16x16x32_bf16 v[60:63], v[240:243], v[96:99], v[60:63]
ds_read_b64_tr_b16 v[228:229], v5 offset:25600
ds_read_b64_tr_b16 v[230:231], v5 offset:26112
v_mfma_f32_16x16x32_bf16 v[80:83], v[96:99], v[244:247], v[80:83]
buffer_load_dwordx4 v3, s[4:7], s38 offen offset:1024 lds
v_mfma_f32_16x16x32_bf16 v[44:47], v[236:239], v[100:103], v[44:47]
s_add_u32 m0, s84, 135168
s_add_u32 s59, s59, 98304
v_mfma_f32_16x16x32_bf16 v[64:67], v[240:243], v[100:103], v[64:67]
s_mov_b64 exec, s[32:33]
ds_read_b128 v[112:115], v124 offset:1024
s_mov_b64 exec, -1
v_mfma_f32_16x16x32_bf16 v[84:87], v[100:103], v[244:247], v[84:87]
buffer_load_dwordx4 v4, s[8:11], s59 offen offset:0 lds
s_waitcnt lgkmcnt(5)
v_mfma_f32_16x16x32_bf16 v[48:51], v[236:239], v[104:107], v[48:51]
ds_read_b64_tr_b16 v[232:233], v5 offset:26624
ds_read_b64_tr_b16 v[234:235], v5 offset:27136
v_mfma_f32_16x16x32_bf16 v[68:71], v[240:243], v[104:107], v[68:71]
ds_read_b128 v[96:99], v7 offset:8192
v_mfma_f32_16x16x32_bf16 v[88:91], v[104:107], v[244:247], v[88:91]
buffer_load_dwordx4 v4, s[8:11], s59 offen offset:1024 lds
v_mfma_f32_16x16x32_bf16 v[52:55], v[236:239], v[108:111], v[52:55]
ds_read_b128 v[100:103], v7 offset:10240
v_mfma_f32_16x16x32_bf16 v[72:75], v[240:243], v[108:111], v[72:75]
ds_read_b128 v[104:107], v7 offset:12288
v_mfma_f32_16x16x32_bf16 v[92:95], v[108:111], v[244:247], v[92:95]
buffer_load_dwordx4 v4, s[8:11], s59 offen offset:2048 lds
s_waitcnt lgkmcnt(3)
v_mfma_f32_16x16x32_bf16 v[24:27], v[224:227], v[120:123], v[24:27]
s_waitcnt vmcnt(5)
s_barrier
v_mfma_f32_16x16x32_bf16 v[56:59], v[228:231], v[112:115], v[56:59]
s_add_u32 m0, s84, 147456
s_xor_b32 s59, s85, 3
v_mfma_f32_16x16x32_bf16 v[76:79], v[112:115], v[232:235], v[76:79]
s_mul_i32 s59, s59, 196608
s_waitcnt lgkmcnt(1)
v_mfma_f32_16x16x32_bf16 v[40:43], v[224:227], v[96:99], v[40:43]
buffer_load_dwordx4 v4, s[8:11], s59 offen offset:0 lds
v_mfma_f32_16x16x32_bf16 v[60:63], v[228:231], v[96:99], v[60:63]
ds_read_b128 v[108:111], v7 offset:14336
v_mfma_f32_16x16x32_bf16 v[80:83], v[96:99], v[232:235], v[80:83]
ds_read_b64_tr_b16 v[236:237], v5 offset:36864
ds_read_b128 v[168:171], v126 offset:0
v_mfma_f32_16x16x32_bf16 v[44:47], v[224:227], v[100:103], v[44:47]
buffer_load_dwordx4 v4, s[8:11], s59 offen offset:1024 lds
ds_read_b64_tr_b16 v[238:239], v5 offset:37376
v_mfma_f32_16x16x32_bf16 v[64:67], v[228:231], v[100:103], v[64:67]
ds_read_b64_tr_b16 v[240:241], v5 offset:37888
ds_read_b64_tr_b16 v[242:243], v5 offset:38400
v_mfma_f32_16x16x32_bf16 v[84:87], v[100:103], v[232:235], v[84:87]
s_mov_b64 exec, s[32:33]
ds_read_b128 v[172:175], v124 offset:0
s_mov_b64 exec, -1
s_waitcnt lgkmcnt(6)
v_mfma_f32_16x16x32_bf16 v[48:51], v[224:227], v[104:107], v[48:51]
buffer_load_dwordx4 v4, s[8:11], s59 offen offset:2048 lds
ds_read_b64_tr_b16 v[244:245], v5 offset:38912
v_mfma_f32_16x16x32_bf16 v[68:71], v[228:231], v[104:107], v[68:71]
s_add_u32 m0, s61, 32768
s_xor_b32 s38, s3, 512
ds_read_b64_tr_b16 v[246:247], v5 offset:39424
v_mfma_f32_16x16x32_bf16 v[88:91], v[104:107], v[232:235], v[88:91]
ds_read_b128 v[176:179], v127 offset:0
s_mov_b64 exec, s[32:33]
ds_read_b128 v[180:183], v125 offset:0
s_mov_b64 exec, -1
v_mfma_f32_16x16x32_bf16 v[52:55], v[224:227], v[108:111], v[52:55]
s_add_u32 s38, s38, s56
buffer_load_dwordx4 v2, s[4:7], s38 offen lds
v_mfma_f32_16x16x32_bf16 v[72:75], v[228:231], v[108:111], v[72:75]
s_mov_b64 exec, s[32:33]
ds_read_b128 v[112:115], v125 offset:1024
s_mov_b64 exec, -1
v_mfma_f32_16x16x32_bf16 v[92:95], v[108:111], v[232:235], v[92:95]
ds_read_b128 v[96:99], v8 offset:8192
ds_read_b128 v[100:103], v8 offset:10240
s_waitcnt lgkmcnt(3)
v_mfma_f32_16x16x32_bf16 v[152:155], v[120:123], v[168:171], 0
buffer_load_dwordx4 v3, s[4:7], s38 offen offset:1024 lds
v_mfma_f32_16x16x32_bf16 v[156:159], v[168:171], v[168:171], 0
ds_read_b128 v[104:107], v8 offset:12288
v_mfma_f32_16x16x32_bf16 v[164:167], v[172:175], v[172:175], 0
s_add_u32 m0, s61, 40960
s_xor_b32 s38, s3, 640
v_mfma_f32_16x16x32_bf16 v[152:155], v[120:123], v[176:179], v[152:155]
s_add_u32 s38, s38, s56
ds_read_b128 v[108:111], v8 offset:14336
v_mfma_f32_16x16x32_bf16 v[156:159], v[176:179], v[176:179], v[156:159]
buffer_load_dwordx4 v2, s[4:7], s38 offen lds
v_mfma_f32_16x16x32_bf16 v[164:167], v[180:183], v[180:183], v[164:167]
s_waitcnt lgkmcnt(4)
v_mfma_f32_16x16x32_bf16 v[24:27], v[236:239], v[120:123], v[24:27]
v_mfma_f32_16x16x32_bf16 v[56:59], v[240:243], v[112:115], v[56:59]
buffer_load_dwordx4 v3, s[4:7], s38 offen offset:1024 lds
v_mfma_f32_16x16x32_bf16 v[76:79], v[112:115], v[244:247], v[76:79]
s_add_u32 m0, s84, 73728
s_waitcnt lgkmcnt(2)
v_mfma_f32_16x16x32_bf16 v[40:43], v[236:239], v[96:99], v[40:43]
s_add_u32 s59, s59, 98304
ds_read_b64_tr_b16 v[224:225], v6 offset:0
v_mfma_f32_16x16x32_bf16 v[60:63], v[240:243], v[96:99], v[60:63]
buffer_load_dwordx4 v4, s[8:11], s59 offen offset:0 lds
v_mfma_f32_16x16x32_bf16 v[80:83], v[96:99], v[244:247], v[80:83]
ds_read_b128 v[168:171], v126 offset:8192
v_mfma_f32_16x16x32_bf16 v[44:47], v[236:239], v[100:103], v[44:47]
ds_read_b64_tr_b16 v[226:227], v6 offset:512
ds_read_b64_tr_b16 v[228:229], v6 offset:1024
v_mfma_f32_16x16x32_bf16 v[64:67], v[240:243], v[100:103], v[64:67]
buffer_load_dwordx4 v4, s[8:11], s59 offen offset:1024 lds
v_mfma_f32_16x16x32_bf16 v[84:87], v[100:103], v[244:247], v[84:87]
ds_read_b64_tr_b16 v[230:231], v6 offset:1536
s_waitcnt lgkmcnt(5)
v_mfma_f32_16x16x32_bf16 v[48:51], v[236:239], v[104:107], v[48:51]
s_mov_b64 exec, s[32:33]
ds_read_b128 v[172:175], v124 offset:1024
s_mov_b64 exec, -1
v_mfma_f32_16x16x32_bf16 v[68:71], v[240:243], v[104:107], v[68:71]
buffer_load_dwordx4 v4, s[8:11], s59 offen offset:2048 lds
ds_read_b64_tr_b16 v[232:233], v6 offset:2048
v_mfma_f32_16x16x32_bf16 v[88:91], v[104:107], v[244:247], v[88:91]
ds_read_b128 v[176:179], v127 offset:8192
s_mov_b64 exec, s[32:33]
ds_read_b128 v[180:183], v125 offset:1024
s_mov_b64 exec, -1
v_mfma_f32_16x16x32_bf16 v[52:55], v[236:239], v[108:111], v[52:55]
ds_read_b64_tr_b16 v[234:235], v6 offset:2560
s_add_u32 m0, s84, 86016
v_mfma_f32_16x16x32_bf16 v[72:75], v[240:243], v[108:111], v[72:75]
s_mov_b64 exec, s[32:33]
ds_read_b128 v[112:115], v124 offset:2048
s_mov_b64 exec, -1
v_mfma_f32_16x16x32_bf16 v[92:95], v[108:111], v[244:247], v[92:95]
s_xor_b32 s59, s85, 4
s_mul_i32 s59, s59, 196608
buffer_load_dwordx4 v4, s[8:11], s59 offen offset:0 lds
s_waitcnt lgkmcnt(2)
v_mfma_f32_16x16x32_bf16 v[152:155], v[120:123], v[168:171], v[152:155]
ds_read_b128 v[96:99], v7 offset:16384
ds_read_b128 v[100:103], v7 offset:18432
v_mfma_f32_16x16x32_bf16 v[156:159], v[168:171], v[168:171], v[156:159]
ds_read_b128 v[104:107], v7 offset:20480
v_mfma_f32_16x16x32_bf16 v[164:167], v[172:175], v[172:175], v[164:167]
buffer_load_dwordx4 v4, s[8:11], s59 offen offset:1024 lds
v_mfma_f32_16x16x32_bf16 v[152:155], v[120:123], v[176:179], v[152:155]
ds_read_b128 v[108:111], v7 offset:22528
v_mfma_f32_16x16x32_bf16 v[156:159], v[176:179], v[176:179], v[156:159]
v_mfma_f32_16x16x32_bf16 v[164:167], v[180:183], v[180:183], v[164:167]
buffer_load_dwordx4 v4, s[8:11], s59 offen offset:2048 lds
s_waitcnt lgkmcnt(4)
v_mfma_f32_16x16x32_bf16 v[24:27], v[224:227], v[120:123], v[24:27]
s_waitcnt vmcnt(10)
s_barrier
v_mfma_f32_16x16x32_bf16 v[56:59], v[228:231], v[112:115], v[56:59]
s_add_u32 m0, s61, 49152
s_xor_b32 s38, s3, 768
v_mfma_f32_16x16x32_bf16 v[76:79], v[112:115], v[232:235], v[76:79]
s_add_u32 s38, s38, s56
buffer_load_dwordx4 v2, s[4:7], s38 offen lds
s_waitcnt lgkmcnt(2)
v_mfma_f32_16x16x32_bf16 v[40:43], v[224:227], v[96:99], v[40:43]
ds_read_b64_tr_b16 v[236:237], v6 offset:12288
v_readlane_b32 s81, v253, 0
v_mfma_f32_16x16x32_bf16 v[60:63], v[228:231], v[96:99], v[60:63]
ds_read_b128 v[168:171], v126 offset:16384
v_readlane_b32 s82, v253, 1
v_mfma_f32_16x16x32_bf16 v[80:83], v[96:99], v[232:235], v[80:83]
buffer_load_dwordx4 v3, s[4:7], s38 offen offset:1024 lds
v_mfma_f32_16x16x32_bf16 v[44:47], v[224:227], v[100:103], v[44:47]
ds_read_b64_tr_b16 v[238:239], v6 offset:12800
ds_read_b64_tr_b16 v[240:241], v6 offset:13312
v_mfma_f32_16x16x32_bf16 v[64:67], v[228:231], v[100:103], v[64:67]
s_add_u32 m0, s61, 57344
s_xor_b32 s38, s3, 896
v_mfma_f32_16x16x32_bf16 v[84:87], v[100:103], v[232:235], v[84:87]
s_cmp_lg_u32 s36, 0
s_cbranch_scc1 Lpx1
s_lshl_b32 s88, s41, 3
s_add_u32 s88, s88, s44
s_lshl_b32 s88, s88, 8
s_add_u32 s88, s88, 12337152
v_sub_u32 v252, 15, v0
v_add_u32 v252, v252, v253
v_mov_b32 v253, s60
v_lshlrev_b32 v254, 7, v0
s_mov_b64 exec, 3
buffer_store_dwordx2 v[252:253], v254, s[28:31], s88 offen sc1
s_mov_b64 exec, -1
Lpx1:
s_waitcnt lgkmcnt(4)
v_mfma_f32_16x16x32_bf16 v[48:51], v[224:227], v[104:107], v[48:51]
s_add_u32 s38, s38, s56
buffer_load_dwordx4 v2, s[4:7], s38 offen lds
v_mfma_f32_16x16x32_bf16 v[68:71], v[228:231], v[104:107], v[68:71]
ds_read_b64_tr_b16 v[242:243], v6 offset:13824
ds_read_b64_tr_b16 v[244:245], v6 offset:14336
ds_read_b64_tr_b16 v[246:247], v6 offset:14848
v_mfma_f32_16x16x32_bf16 v[88:91], v[104:107], v[232:235], v[88:91]
s_mov_b64 exec, s[32:33]
ds_read_b128 v[172:175], v124 offset:2048
s_mov_b64 exec, -1
ds_read_b128 v[176:179], v127 offset:16384
s_mov_b64 exec, s[32:33]
ds_read_b128 v[180:183], v125 offset:2048
s_mov_b64 exec, -1
v_mfma_f32_16x16x32_bf16 v[52:55], v[224:227], v[108:111], v[52:55]
buffer_load_dwordx4 v3, s[4:7], s38 offen offset:1024 lds
s_mul_i32 s79, s41, 229376
v_mfma_f32_16x16x32_bf16 v[72:75], v[228:231], v[108:111], v[72:75]
s_mov_b64 exec, s[32:33]
ds_read_b128 v[112:115], v125 offset:2048
s_mov_b64 exec, -1
v_mfma_f32_16x16x32_bf16 v[92:95], v[108:111], v[232:235], v[92:95]
ds_read_b128 v[96:99], v8 offset:16384
ds_read_b128 v[100:103], v8 offset:18432
s_waitcnt lgkmcnt(3)
v_mfma_f32_16x16x32_bf16 v[152:155], v[120:123], v[168:171], v[152:155]
s_add_u32 m0, s84, 98304
s_add_u32 s59, s59, 98304
buffer_load_dwordx4 v4, s[8:11], s59 offen offset:0 lds
v_mfma_f32_16x16x32_bf16 v[156:159], v[168:171], v[168:171], v[156:159]
s_lshl_b32 s80, s44, 12
ds_read_b128 v[104:107], v8 offset:20480
v_mfma_f32_16x16x32_bf16 v[164:167], v[172:175], v[172:175], v[164:167]
s_add_u32 s79, s79, s80
ds_read_b128 v[108:111], v8 offset:22528
v_mfma_f32_16x16x32_bf16 v[152:155], v[120:123], v[176:179], v[152:155]
buffer_load_dwordx4 v4, s[8:11], s59 offen offset:1024 lds
v_mfma_f32_16x16x32_bf16 v[156:159], v[176:179], v[176:179], v[156:159]
s_add_u32 s79, s79, s45
s_add_u32 s79, s79, 16777216
v_mfma_f32_16x16x32_bf16 v[164:167], v[180:183], v[180:183], v[164:167]
s_add_u32 s80, s79, 114688
s_waitcnt lgkmcnt(4)
v_mfma_f32_16x16x32_bf16 v[24:27], v[236:239], v[120:123], v[24:27]
buffer_load_dwordx4 v4, s[8:11], s59 offen offset:2048 lds
v_mfma_f32_16x16x32_bf16 v[56:59], v[240:243], v[112:115], v[56:59]
ds_read_b64_tr_b16 v[224:225], v6 offset:24576
ds_read_b128 v[168:171], v126 offset:24576
v_mfma_f32_16x16x32_bf16 v[76:79], v[112:115], v[244:247], v[76:79]
s_add_u32 m0, s84, 110592
s_waitcnt lgkmcnt(4)
v_mfma_f32_16x16x32_bf16 v[40:43], v[236:239], v[96:99], v[40:43]
s_xor_b32 s59, s85, 5
s_mul_i32 s59, s59, 196608
v_mfma_f32_16x16x32_bf16 v[60:63], v[240:243], v[96:99], v[60:63]
buffer_load_dwordx4 v4, s[8:11], s59 offen offset:0 lds
v_mfma_f32_16x16x32_bf16 v[80:83], v[96:99], v[244:247], v[80:83]
ds_read_b64_tr_b16 v[226:227], v6 offset:25088
ds_read_b64_tr_b16 v[228:229], v6 offset:25600
v_mfma_f32_16x16x32_bf16 v[44:47], v[236:239], v[100:103], v[44:47]
v_and_b32 v196, 7, v0
ds_read_b64_tr_b16 v[230:231], v6 offset:26112
v_mfma_f32_16x16x32_bf16 v[64:67], v[240:243], v[100:103], v[64:67]
buffer_load_dwordx4 v4, s[8:11], s59 offen offset:1024 lds
v_mfma_f32_16x16x32_bf16 v[84:87], v[100:103], v[244:247], v[84:87]
s_mov_b64 exec, s[32:33]
ds_read_b128 v[172:175], v124 offset:3072
s_mov_b64 exec, -1
s_waitcnt lgkmcnt(6)
v_mfma_f32_16x16x32_bf16 v[48:51], v[236:239], v[104:107], v[48:51]
ds_read_b64_tr_b16 v[232:233], v6 offset:26624
v_lshlrev_b32 v196, 7, v196
v_mfma_f32_16x16x32_bf16 v[68:71], v[240:243], v[104:107], v[68:71]
buffer_load_dwordx4 v4, s[8:11], s59 offen offset:2048 lds
ds_read_b64_tr_b16 v[234:235], v6 offset:27136
v_mfma_f32_16x16x32_bf16 v[88:91], v[104:107], v[244:247], v[88:91]
ds_read_b128 v[176:179], v127 offset:24576
s_mov_b64 exec, s[32:33]
ds_read_b128 v[180:183], v125 offset:3072
s_mov_b64 exec, -1
v_mfma_f32_16x16x32_bf16 v[52:55], v[236:239], v[108:111], v[52:55]
s_mov_b64 exec, s[32:33]
ds_read_b128 v[112:115], v124 offset:3072
s_mov_b64 exec, -1
v_mfma_f32_16x16x32_bf16 v[72:75], v[240:243], v[108:111], v[72:75]
s_add_u32 m0, s84, 122880
s_add_u32 s59, s59, 98304
buffer_load_dwordx4 v4, s[8:11], s59 offen offset:0 lds
v_mfma_f32_16x16x32_bf16 v[92:95], v[108:111], v[244:247], v[92:95]
ds_read_b128 v[96:99], v7 offset:24576
v_bfe_u32 v34, v0, 3, 1
s_waitcnt lgkmcnt(2)
v_mfma_f32_16x16x32_bf16 v[152:155], v[120:123], v[168:171], v[152:155]
ds_read_b128 v[100:103], v7 offset:26624
v_mul_u32_u24 v34, 114688, v34
v_mfma_f32_16x16x32_bf16 v[156:159], v[168:171], v[168:171], v[156:159]
buffer_load_dwordx4 v4, s[8:11], s59 offen offset:1024 lds
ds_read_b128 v[104:107], v7 offset:28672
v_mfma_f32_16x16x32_bf16 v[164:167], v[172:175], v[172:175], v[164:167]
v_add_u32 v196, v196, v34
ds_read_b128 v[108:111], v7 offset:30720
v_mfma_f32_16x16x32_bf16 v[152:155], v[120:123], v[176:179], v[152:155]
v_mfma_f32_16x16x32_bf16 v[156:159], v[176:179], v[176:179], v[156:159]
v_mfma_f32_16x16x32_bf16 v[164:167], v[180:183], v[180:183], v[164:167]
buffer_load_dwordx4 v4, s[8:11], s59 offen offset:2048 lds
s_waitcnt lgkmcnt(4)
v_mfma_f32_16x16x32_bf16 v[24:27], v[224:227], v[120:123], v[24:27]
s_waitcnt vmcnt(13)
s_barrier
v_mfma_f32_16x16x32_bf16 v[56:59], v[228:231], v[112:115], v[56:59]
s_add_u32 m0, s84, 135168
s_xor_b32 s59, s85, 6
v_mfma_f32_16x16x32_bf16 v[76:79], v[112:115], v[232:235], v[76:79]
s_mul_i32 s59, s59, 196608
buffer_load_dwordx4 v4, s[8:11], s59 offen offset:0 lds
s_waitcnt lgkmcnt(2)
v_mfma_f32_16x16x32_bf16 v[40:43], v[224:227], v[96:99], v[40:43]
ds_read_b64_tr_b16 v[236:237], v5 offset:0
ds_read_b128 v[168:171], v126 offset:32768
v_mfma_f32_16x16x32_bf16 v[60:63], v[228:231], v[96:99], v[60:63]
ds_read_b64_tr_b16 v[238:239], v5 offset:512
v_mfma_f32_16x16x32_bf16 v[80:83], v[96:99], v[232:235], v[80:83]
buffer_load_dwordx4 v4, s[8:11], s59 offen offset:1024 lds
v_mfma_f32_16x16x32_bf16 v[44:47], v[224:227], v[100:103], v[44:47]
ds_read_b64_tr_b16 v[240:241], v5 offset:1024
ds_read_b64_tr_b16 v[242:243], v5 offset:1536
v_mfma_f32_16x16x32_bf16 v[64:67], v[228:231], v[100:103], v[64:67]
s_mov_b64 exec, s[32:33]
ds_read_b128 v[172:175], v124 offset:4096
s_mov_b64 exec, -1
v_mfma_f32_16x16x32_bf16 v[84:87], v[100:103], v[232:235], v[84:87]
buffer_load_dwordx4 v4, s[8:11], s59 offen offset:2048 lds
s_waitcnt lgkmcnt(6)
v_mfma_f32_16x16x32_bf16 v[48:51], v[224:227], v[104:107], v[48:51]
s_add_u32 m0, s84, 147456
s_add_u32 s59, s59, 98304
ds_read_b64_tr_b16 v[244:245], v5 offset:2048
v_mfma_f32_16x16x32_bf16 v[68:71], v[228:231], v[104:107], v[68:71]
ds_read_b64_tr_b16 v[246:247], v5 offset:2560
ds_read_b128 v[176:179], v127 offset:32768
v_mfma_f32_16x16x32_bf16 v[88:91], v[104:107], v[232:235], v[88:91]
buffer_load_dwordx4 v4, s[8:11], s59 offen offset:0 lds
s_mov_b64 exec, s[32:33]
ds_read_b128 v[180:183], v125 offset:4096
s_mov_b64 exec, -1
v_mfma_f32_16x16x32_bf16 v[52:55], v[224:227], v[108:111], v[52:55]
s_mov_b64 exec, s[32:33]
ds_read_b128 v[112:115], v125 offset:3072
s_mov_b64 exec, -1
v_mfma_f32_16x16x32_bf16 v[72:75], v[228:231], v[108:111], v[72:75]
ds_read_b128 v[96:99], v8 offset:24576
ds_read_b128 v[100:103], v8 offset:26624
v_mfma_f32_16x16x32_bf16 v[92:95], v[108:111], v[232:235], v[92:95]
buffer_load_dwordx4 v4, s[8:11], s59 offen offset:1024 lds
s_waitcnt lgkmcnt(3)
v_mfma_f32_16x16x32_bf16 v[152:155], v[120:123], v[168:171], v[152:155]
ds_read_b128 v[104:107], v8 offset:28672
v_mfma_f32_16x16x32_bf16 v[156:159], v[168:171], v[168:171], v[156:159]
ds_read_b128 v[108:111], v8 offset:30720
v_mfma_f32_16x16x32_bf16 v[164:167], v[172:175], v[172:175], v[164:167]
v_mfma_f32_16x16x32_bf16 v[152:155], v[120:123], v[176:179], v[152:155]
buffer_load_dwordx4 v4, s[8:11], s59 offen offset:2048 lds
v_mfma_f32_16x16x32_bf16 v[156:159], v[176:179], v[176:179], v[156:159]
v_mfma_f32_16x16x32_bf16 v[164:167], v[180:183], v[180:183], v[164:167]
s_waitcnt lgkmcnt(4)
v_mfma_f32_16x16x32_bf16 v[24:27], v[236:239], v[120:123], v[24:27]
v_mfma_f32_16x16x32_bf16 v[56:59], v[240:243], v[112:115], v[56:59]
ds_read_b64_tr_b16 v[224:225], v5 offset:12288
ds_read_b128 v[168:171], v126 offset:40960
v_mfma_f32_16x16x32_bf16 v[76:79], v[112:115], v[244:247], v[76:79]
ds_read_b64_tr_b16 v[226:227], v5 offset:12800
s_waitcnt lgkmcnt(5)
v_mfma_f32_16x16x32_bf16 v[40:43], v[236:239], v[96:99], v[40:43]
ds_read_b64_tr_b16 v[228:229], v5 offset:13312
v_mfma_f32_16x16x32_bf16 v[60:63], v[240:243], v[96:99], v[60:63]
ds_read_b64_tr_b16 v[230:231], v5 offset:13824
v_mfma_f32_16x16x32_bf16 v[80:83], v[96:99], v[244:247], v[80:83]
s_mov_b64 exec, s[32:33]
ds_read_b128 v[172:175], v124 offset:5120
s_mov_b64 exec, -1
v_mfma_f32_16x16x32_bf16 v[44:47], v[236:239], v[100:103], v[44:47]
ds_read_b64_tr_b16 v[232:233], v5 offset:14336
ds_read_b64_tr_b16 v[234:235], v5 offset:14848
v_mfma_f32_16x16x32_bf16 v[64:67], v[240:243], v[100:103], v[64:67]
s_mov_b64 exec, s[32:33]
ds_read_b128 v[112:115], v124 offset:4096
s_mov_b64 exec, -1
v_mfma_f32_16x16x32_bf16 v[84:87], v[100:103], v[244:247], v[84:87]
ds_read_b128 v[96:99], v7 offset:32768
s_waitcnt lgkmcnt(10)
v_mfma_f32_16x16x32_bf16 v[48:51], v[236:239], v[104:107], v[48:51]
ds_read_b128 v[176:179], v127 offset:40960
v_mfma_f32_16x16x32_bf16 v[68:71], v[240:243], v[104:107], v[68:71]
s_mov_b64 exec, s[32:33]
ds_read_b128 v[180:183], v125 offset:5120
s_mov_b64 exec, -1
v_mfma_f32_16x16x32_bf16 v[88:91], v[104:107], v[244:247], v[88:91]
ds_read_b128 v[100:103], v7 offset:34816
v_mfma_f32_16x16x32_bf16 v[52:55], v[236:239], v[108:111], v[52:55]
ds_read_b128 v[104:107], v7 offset:36864
v_mfma_f32_16x16x32_bf16 v[72:75], v[240:243], v[108:111], v[72:75]
s_mov_b64 exec, 65535
buffer_load_dword v34, v196, s[28:31], s79 offen sc1
s_mov_b64 exec, -1
v_mfma_f32_16x16x32_bf16 v[92:95], v[108:111], v[244:247], v[92:95]
s_lshl_b32 s88, s57, 15
s_lshl_b32 s89, s44, 12
s_waitcnt lgkmcnt(2)
v_mfma_f32_16x16x32_bf16 v[152:155], v[120:123], v[168:171], v[152:155]
s_add_u32 s88, s88, s89
s_and_b32 s89, s45, 2048
s_add_u32 s88, s88, s89
v_mfma_f32_16x16x32_bf16 v[156:159], v[168:171], v[168:171], v[156:159]
s_add_u32 s88, s88, 4194304
v_lshlrev_b32 v196, 7, v0
v_mfma_f32_16x16x32_bf16 v[164:167], v[172:175], v[172:175], v[164:167]
s_mov_b64 exec, 65535
buffer_load_dword v34, v196, s[28:31], s88 offen sc1
s_mov_b64 exec, -1
v_mfma_f32_16x16x32_bf16 v[152:155], v[120:123], v[176:179], v[152:155]
s_lshl_b32 s88, s57, 12
s_lshl_b32 s89, s44, 9
s_add_u32 s88, s88, s89
v_mfma_f32_16x16x32_bf16 v[156:159], v[176:179], v[176:179], v[156:159]
s_lshr_b32 s89, s36, 1
s_lshl_b32 s89, s89, 8
s_add_u32 s88, s88, s89
v_mfma_f32_16x16x32_bf16 v[164:167], v[180:183], v[180:183], v[164:167]
s_add_u32 s88, s88, 10485760
ds_read_b128 v[108:111], v7 offset:38912
v_mfma_f32_16x16x32_bf16 v[24:27], v[224:227], v[120:123], v[24:27]
s_waitcnt vmcnt(11)
s_barrier
s_mov_b64 exec, 3
buffer_load_dword v34, v196, s[28:31], s88 offen sc1
s_mov_b64 exec, -1
buffer_load_dword v34, v14, s[28:31], 0 offen sc1
v_mfma_f32_16x16x32_bf16 v[56:59], v[228:231], v[112:115], v[56:59]
s_add_u32 m0, s84, 73728
s_xor_b32 s59, s85, 7
s_mul_i32 s59, s59, 196608
buffer_load_dwordx4 v4, s[8:11], s59 offen offset:0 lds
v_mfma_f32_16x16x32_bf16 v[76:79], v[112:115], v[232:235], v[76:79]
v_and_b32 v184, 15, v0
s_waitcnt lgkmcnt(2)
v_mfma_f32_16x16x32_bf16 v[40:43], v[224:227], v[96:99], v[40:43]
ds_read_b64_tr_b16 v[236:237], v5 offset:24576
v_lshrrev_b32 v185, 4, v0
v_mfma_f32_16x16x32_bf16 v[60:63], v[228:231], v[96:99], v[60:63]
buffer_load_dwordx4 v4, s[8:11], s59 offen offset:1024 lds
v_mfma_f32_16x16x32_bf16 v[80:83], v[96:99], v[232:235], v[80:83]
ds_read_b128 v[168:171], v126 offset:49152
v_lshlrev_b32 v142, 2, v184
v_mfma_f32_16x16x32_bf16 v[44:47], v[224:227], v[100:103], v[44:47]
ds_read_b64_tr_b16 v[238:239], v5 offset:25088
v_add_u32 v142, 159744, v142
v_mfma_f32_16x16x32_bf16 v[64:67], v[228:231], v[100:103], v[64:67]
buffer_load_dwordx4 v4, s[8:11], s59 offen offset:2048 lds
ds_read_b64_tr_b16 v[240:241], v5 offset:25600
v_mfma_f32_16x16x32_bf16 v[84:87], v[100:103], v[232:235], v[84:87]
v_lshlrev_b32 v143, 4, v185
ds_read_b64_tr_b16 v[242:243], v5 offset:26112
s_waitcnt lgkmcnt(5)
v_mfma_f32_16x16x32_bf16 v[48:51], v[224:227], v[104:107], v[48:51]
s_add_u32 m0, s84, 86016
s_add_u32 s59, s59, 98304
v_add_u32 v143, 159744, v143
v_mfma_f32_16x16x32_bf16 v[68:71], v[228:231], v[104:107], v[68:71]
buffer_load_dwordx4 v4, s[8:11], s59 offen offset:0 lds
ds_read_b64_tr_b16 v[244:245], v5 offset:26624
v_mfma_f32_16x16x32_bf16 v[88:91], v[104:107], v[232:235], v[88:91]
s_mov_b64 exec, s[32:33]
ds_read_b128 v[172:175], v124 offset:6144
s_mov_b64 exec, -1
ds_read_b128 v[176:179], v127 offset:49152
s_mov_b64 exec, s[32:33]
ds_read_b128 v[180:183], v125 offset:6144
s_mov_b64 exec, -1
v_mfma_f32_16x16x32_bf16 v[52:55], v[224:227], v[108:111], v[52:55]
v_lshlrev_b32 v185, 2, v185
ds_read_b64_tr_b16 v[246:247], v5 offset:27136
v_sub_u32 v184, v184, v185
v_mfma_f32_16x16x32_bf16 v[72:75], v[228:231], v[108:111], v[72:75]
buffer_load_dwordx4 v4, s[8:11], s59 offen offset:1024 lds
v_mov_b32 v188, 0xff800000
v_mfma_f32_16x16x32_bf16 v[92:95], v[108:111], v[232:235], v[92:95]
s_mov_b64 exec, s[32:33]
ds_read_b128 v[112:115], v125 offset:4096
s_mov_b64 exec, -1
s_waitcnt lgkmcnt(2)
v_mfma_f32_16x16x32_bf16 v[152:155], v[120:123], v[168:171], v[152:155]
ds_read_b128 v[96:99], v8 offset:32768
v_mov_b32 v189, 0xffff
v_mov_b32 v190, 0xffff0000
v_mfma_f32_16x16x32_bf16 v[156:159], v[168:171], v[168:171], v[156:159]
ds_read_b128 v[100:103], v8 offset:34816
s_cmp_eq_u32 s47, 0
s_cselect_b64 s[88:89], 0, -1
v_mfma_f32_16x16x32_bf16 v[164:167], v[172:175], v[172:175], v[164:167]
buffer_load_dwordx4 v4, s[8:11], s59 offen offset:2048 lds
v_subrev_u32 v185, 0, v184
v_mfma_f32_16x16x32_bf16 v[152:155], v[120:123], v[176:179], v[152:155]
ds_read_b128 v[104:107], v8 offset:36864
v_add_u32 v191, 16, v185
v_cmp_gt_u32 vcc, 8, v185
v_mfma_f32_16x16x32_bf16 v[156:159], v[176:179], v[176:179], v[156:159]
v_cmp_gt_u32 s[90:91], 8, v191
v_cndmask_b32 v128, v188, 0, vcc
ds_read_b128 v[108:111], v8 offset:38912
v_mfma_f32_16x16x32_bf16 v[164:167], v[180:183], v[180:183], v[164:167]
v_cndmask_b32 v192, 0, v189, vcc
v_cndmask_b32 v132, v188, 0, s[90:91]
s_waitcnt lgkmcnt(4)
v_mfma_f32_16x16x32_bf16 v[24:27], v[236:239], v[120:123], v[24:27]
v_cndmask_b32 v136, v188, v132, s[88:89]
v_subrev_u32 v185, 1, v184
v_mfma_f32_16x16x32_bf16 v[56:59], v[240:243], v[112:115], v[56:59]
v_add_u32 v191, 16, v185
v_cmp_gt_u32 vcc, 8, v185
v_mfma_f32_16x16x32_bf16 v[76:79], v[112:115], v[244:247], v[76:79]
Lpage1:
s_cbranch_execz Ltour0
v_cmp_gt_u32 s[90:91], 8, v191
s_waitcnt lgkmcnt(2)
v_mfma_f32_16x16x32_bf16 v[40:43], v[236:239], v[96:99], v[40:43]
v_cndmask_b32 v129, v188, 0, vcc
ds_read_b64_tr_b16 v[224:225], v5 offset:36864
v_mfma_f32_16x16x32_bf16 v[60:63], v[240:243], v[96:99], v[60:63]
ds_read_b128 v[168:171], v126 offset:57344
v_cndmask_b32 v193, 0, v190, vcc
v_mfma_f32_16x16x32_bf16 v[80:83], v[96:99], v[244:247], v[80:83]
ds_read_b64_tr_b16 v[226:227], v5 offset:37376
v_cndmask_b32 v133, v188, 0, s[90:91]
v_mfma_f32_16x16x32_bf16 v[44:47], v[236:239], v[100:103], v[44:47]
ds_read_b64_tr_b16 v[228:229], v5 offset:37888
v_cndmask_b32 v137, v188, v133, s[88:89]
v_mfma_f32_16x16x32_bf16 v[64:67], v[240:243], v[100:103], v[64:67]
ds_read_b64_tr_b16 v[230:231], v5 offset:38400
v_subrev_u32 v185, 2, v184
v_mfma_f32_16x16x32_bf16 v[84:87], v[100:103], v[244:247], v[84:87]
s_mov_b64 exec, s[32:33]
ds_read_b128 v[172:175], v124 offset:7168
s_mov_b64 exec, -1
s_waitcnt lgkmcnt(6)
v_mfma_f32_16x16x32_bf16 v[48:51], v[236:239], v[104:107], v[48:51]
ds_read_b64_tr_b16 v[232:233], v5 offset:38912
v_add_u32 v191, 16, v185
v_mfma_f32_16x16x32_bf16 v[68:71], v[240:243], v[104:107], v[68:71]
ds_read_b64_tr_b16 v[234:235], v5 offset:39424
v_cmp_gt_u32 vcc, 8, v185
ds_read_b128 v[176:179], v127 offset:57344
v_mfma_f32_16x16x32_bf16 v[88:91], v[104:107], v[244:247], v[88:91]
s_mov_b64 exec, s[32:33]
ds_read_b128 v[180:183], v125 offset:7168
s_mov_b64 exec, -1
v_mfma_f32_16x16x32_bf16 v[52:55], v[236:239], v[108:111], v[52:55]
s_mov_b64 exec, s[32:33]
ds_read_b128 v[112:115], v124 offset:5120
s_mov_b64 exec, -1
v_mfma_f32_16x16x32_bf16 v[72:75], v[240:243], v[108:111], v[72:75]
ds_read_b128 v[96:99], v7 offset:40960
v_cmp_gt_u32 s[90:91], 8, v191
v_cndmask_b32 v130, v188, 0, vcc
v_mfma_f32_16x16x32_bf16 v[92:95], v[108:111], v[244:247], v[92:95]
v_cndmask_b32 v194, 0, v189, vcc
ds_read_b128 v[100:103], v7 offset:43008
s_waitcnt lgkmcnt(3)
v_mfma_f32_16x16x32_bf16 v[152:155], v[120:123], v[168:171], v[152:155]
v_cndmask_b32 v134, v188, 0, s[90:91]
v_cndmask_b32 v138, v188, v134, s[88:89]
v_subrev_u32 v185, 3, v184
v_mfma_f32_16x16x32_bf16 v[156:159], v[168:171], v[168:171], v[156:159]
ds_read_b128 v[104:107], v7 offset:45056
v_add_u32 v191, 16, v185
v_mfma_f32_16x16x32_bf16 v[164:167], v[172:175], v[172:175], v[164:167]
v_cmp_gt_u32 vcc, 8, v185
v_cmp_gt_u32 s[90:91], 8, v191
v_mfma_f32_16x16x32_bf16 v[152:155], v[120:123], v[176:179], v[152:155]
v_cndmask_b32 v131, v188, 0, vcc
ds_read_b128 v[108:111], v7 offset:47104
v_mfma_f32_16x16x32_bf16 v[156:159], v[176:179], v[176:179], v[156:159]
v_cndmask_b32 v195, 0, v190, vcc
v_cndmask_b32 v135, v188, 0, s[90:91]
v_mfma_f32_16x16x32_bf16 v[164:167], v[180:183], v[180:183], v[164:167]
v_cndmask_b32 v139, v188, v135, s[88:89]
v_or_b32 v140, v192, v193
v_or_b32 v141, v194, v195
s_waitcnt lgkmcnt(4)
v_mfma_f32_16x16x32_bf16 v[24:27], v[224:227], v[120:123], v[24:27]
s_waitcnt vmcnt(13)
s_barrier
v_mfma_f32_16x16x32_bf16 v[56:59], v[228:231], v[112:115], v[56:59]
s_add_u32 m0, s45, 98304
s_xor_b32 s38, s86, 0
s_lshl_b32 s38, s38, 16
s_add_u32 s38, s38, 32768
buffer_load_dwordx4 v9, s[12:15], s38 offen lds
v_mfma_f32_16x16x32_bf16 v[76:79], v[112:115], v[232:235], v[76:79]
s_add_u32 m0, s45, 102400
s_waitcnt lgkmcnt(2)
v_mfma_f32_16x16x32_bf16 v[40:43], v[224:227], v[96:99], v[40:43]
s_xor_b32 s38, s86, 1
s_lshl_b32 s38, s38, 16
v_mfma_f32_16x16x32_bf16 v[60:63], v[228:231], v[96:99], v[60:63]
buffer_load_dwordx4 v9, s[12:15], s38 offen lds
v_mfma_f32_16x16x32_bf16 v[80:83], v[96:99], v[232:235], v[80:83]
s_add_u32 m0, s45, 106496
s_xor_b32 s38, s86, 1
ds_read_b64_tr_b16 v[236:237], v6 offset:0
v_mfma_f32_16x16x32_bf16 v[44:47], v[224:227], v[100:103], v[44:47]
s_lshl_b32 s38, s38, 16
s_add_u32 s38, s38, 32768
v_add_u32 v252, 56320, v36
v_mfma_f32_16x16x32_bf16 v[64:67], v[228:231], v[100:103], v[64:67]
buffer_load_dwordx4 v9, s[12:15], s38 offen lds
ds_read_b64_tr_b16 v[238:239], v6 offset:512
v_mfma_f32_16x16x32_bf16 v[84:87], v[100:103], v[232:235], v[84:87]
v_add_u32 v253, 112640, v36
v_add_u32 v254, 168960, v36
s_waitcnt lgkmcnt(2)
v_mfma_f32_16x16x32_bf16 v[48:51], v[224:227], v[104:107], v[48:51]
v_and_b32 v168, 3, v0
v_cmp_eq_u32 vcc, 1, v168
ds_read_b64_tr_b16 v[240:241], v6 offset:1024
v_mfma_f32_16x16x32_bf16 v[68:71], v[228:231], v[104:107], v[68:71]
s_add_u32 m0, s45, 110592
s_xor_b32 s38, s86, 2
s_lshl_b32 s38, s38, 16
ds_read_b64_tr_b16 v[242:243], v6 offset:1536
ds_read_b64_tr_b16 v[244:245], v6 offset:2048
buffer_load_dwordx4 v9, s[12:15], s38 offen lds
ds_read_b64_tr_b16 v[246:247], v6 offset:2560
v_mfma_f32_16x16x32_bf16 v[88:91], v[104:107], v[232:235], v[88:91]
s_mov_b64 exec, s[32:33]
ds_read_b128 v[112:115], v125 offset:5120
s_mov_b64 exec, -1
v_mfma_f32_16x16x32_bf16 v[52:55], v[224:227], v[108:111], v[52:55]
ds_read_b128 v[96:99], v8 offset:40960
v_cmp_eq_u32 s[88:89], 2, v168
v_cmp_eq_u32 s[90:91], 3, v168
v_mfma_f32_16x16x32_bf16 v[72:75], v[228:231], v[108:111], v[72:75]
s_add_u32 m0, s45, 114688
s_xor_b32 s38, s86, 2
s_lshl_b32 s38, s38, 16
s_add_u32 s38, s38, 32768
buffer_load_dwordx4 v9, s[12:15], s38 offen lds
v_mfma_f32_16x16x32_bf16 v[92:95], v[108:111], v[232:235], v[92:95]
ds_read_b128 v[100:103], v8 offset:43008
v_mov_b32 v160, v164
s_waitcnt lgkmcnt(2)
v_mfma_f32_16x16x32_bf16 v[24:27], v[236:239], v[120:123], v[24:27]
v_mov_b32 v161, v164
s_nop 1
v_permlane32_swap_b32 v160, v161
v_cndmask_b32 v156, v156, v157, vcc
v_mfma_f32_16x16x32_bf16 v[56:59], v[240:243], v[112:115], v[56:59]
s_add_u32 m0, s45, 118784
s_xor_b32 s38, s86, 3
s_lshl_b32 s38, s38, 16
buffer_load_dwordx4 v9, s[12:15], s38 offen lds
v_mfma_f32_16x16x32_bf16 v[76:79], v[112:115], v[244:247], v[76:79]
v_cndmask_b32 v156, v156, v158, s[88:89]
v_cndmask_b32 v156, v156, v159, s[90:91]
s_waitcnt lgkmcnt(0)
v_mfma_f32_16x16x32_bf16 v[40:43], v[236:239], v[96:99], v[40:43]
ds_read_b128 v[104:107], v8 offset:45056
v_cndmask_b32 v164, v164, v165, vcc
v_cndmask_b32 v164, v164, v166, s[88:89]
v_mfma_f32_16x16x32_bf16 v[60:63], v[240:243], v[96:99], v[60:63]
v_cndmask_b32 v164, v164, v167, s[90:91]
v_mul_f32 v152, 0xbb000000, v152
v_mul_f32 v156, 0x3b000000, v156
v_fma_f32 v156, -v152, v152, v156
v_max_f32 v156, 0, v156
v_cvt_pk_bf16_f32 v156, v156, v156
v_and_b32 v156, 0xffff0000, v156
v_add_f32 v156, 0x3727c5ac, v156
v_cvt_pk_bf16_f32 v156, v156, v156
v_and_b32 v156, 0xffff0000, v156
v_sqrt_f32 v153, v156
ds_read_b128 v[108:111], v8 offset:47104
v_cvt_pk_bf16_f32 v152, v152, v152
v_and_b32 v152, 0xffff0000, v152
v_cvt_pk_bf16_f32 v153, v153, v153
v_and_b32 v153, 0xffff0000, v153
v_rcp_f32 v156, v153
v_mul_f32 v160, 0xbb000000, v160
v_mul_f32 v164, 0x3b000000, v164
v_mfma_f32_16x16x32_bf16 v[80:83], v[96:99], v[244:247], v[80:83]
ds_read_b64_tr_b16 v[224:225], v6 offset:12288
ds_read_b64_tr_b16 v[226:227], v6 offset:12800
v_mfma_f32_16x16x32_bf16 v[44:47], v[236:239], v[100:103], v[44:47]
ds_read_b64_tr_b16 v[228:229], v6 offset:13312
ds_read_b64_tr_b16 v[230:231], v6 offset:13824
v_mfma_f32_16x16x32_bf16 v[64:67], v[240:243], v[100:103], v[64:67]
s_lshl_b32 s88, s42, 12
ds_read_b64_tr_b16 v[232:233], v6 offset:14336
v_mfma_f32_16x16x32_bf16 v[84:87], v[100:103], v[244:247], v[84:87]
s_mov_b64 exec, s[32:33]
ds_read_b128 v[112:115], v124 offset:6144
s_mov_b64 exec, -1
s_waitcnt lgkmcnt(6)
v_mfma_f32_16x16x32_bf16 v[48:51], v[236:239], v[104:107], v[48:51]
s_lshl_b32 s89, s48, 11
s_sub_u32 s89, s89, 3968
v_mfma_f32_16x16x32_bf16 v[68:71], v[240:243], v[104:107], v[68:71]
ds_read_b64_tr_b16 v[234:235], v6 offset:14848
ds_read_b128 v[96:99], v7 offset:49152
v_lshlrev_b32 v197, 8, v0
v_mfma_f32_16x16x32_bf16 v[88:91], v[104:107], v[244:247], v[88:91]
v_add_u32 v198, s89, v197
v_add_u32 v197, s88, v197
v_mfma_f32_16x16x32_bf16 v[52:55], v[236:239], v[108:111], v[52:55]
ds_read_b128 v[100:103], v7 offset:51200
v_cmp_gt_u32 vcc, 16, v0
v_mfma_f32_16x16x32_bf16 v[72:75], v[240:243], v[108:111], v[72:75]
s_nop 0
v_cndmask_b32 v197, v198, v197, vcc
v_mov_b32 v198, s88
v_mfma_f32_16x16x32_bf16 v[92:95], v[108:111], v[244:247], v[92:95]
s_add_u32 m0, s46, 16384
s_waitcnt lgkmcnt(2)
v_mfma_f32_16x16x32_bf16 v[24:27], v[224:227], v[120:123], v[24:27]
s_waitcnt vmcnt(9)
s_barrier
v_cmp_gt_u32 vcc, 24, v0
s_nop 1
v_cndmask_b32 v197, v198, v197, vcc
v_add_u32 v197, 12337152, v197
buffer_load_dwordx2 v[198:199], v197, s[28:31], 0 offen sc1
v_mfma_f32_16x16x32_bf16 v[56:59], v[228:231], v[112:115], v[56:59]
s_xor_b32 s95, s87, 0
s_mul_i32 s95, s95, 229376
buffer_load_dwordx4 v36, s[16:19], s95 offen offset:0 lds
v_mfma_f32_16x16x32_bf16 v[76:79], v[112:115], v[232:235], v[76:79]
ds_read_b128 v[104:107], v7 offset:53248
s_waitcnt lgkmcnt(1)
v_mfma_f32_16x16x32_bf16 v[40:43], v[224:227], v[96:99], v[40:43]
ds_read_b128 v[108:111], v7 offset:55296
v_fma_f32 v164, -v160, v160, v164
v_mfma_f32_16x16x32_bf16 v[60:63], v[228:231], v[96:99], v[60:63]
buffer_load_dwordx4 v252, s[16:19], s95 offen offset:1024 lds
v_mfma_f32_16x16x32_bf16 v[80:83], v[96:99], v[232:235], v[80:83]
ds_read_b64_tr_b16 v[236:237], v6 offset:24576
ds_read_b64_tr_b16 v[238:239], v6 offset:25088
v_mfma_f32_16x16x32_bf16 v[44:47], v[224:227], v[100:103], v[44:47]
v_max_f32 v164, 0, v164
ds_read_b64_tr_b16 v[240:241], v6 offset:25600
v_mfma_f32_16x16x32_bf16 v[64:67], v[228:231], v[100:103], v[64:67]
buffer_load_dwordx4 v253, s[16:19], s95 offen offset:2048 lds
v_cvt_pk_bf16_f32 v164, v164, v164
v_mfma_f32_16x16x32_bf16 v[84:87], v[100:103], v[232:235], v[84:87]
ds_read_b64_tr_b16 v[242:243], v6 offset:26112
s_waitcnt lgkmcnt(4)
v_mfma_f32_16x16x32_bf16 v[48:51], v[224:227], v[104:107], v[48:51]
s_mov_b64 exec, s[32:33]
ds_read_b128 v[112:115], v125 offset:6144
s_mov_b64 exec, -1
v_mfma_f32_16x16x32_bf16 v[68:71], v[228:231], v[104:107], v[68:71]
ds_read_b64_tr_b16 v[244:245], v6 offset:26624
buffer_load_dwordx4 v254, s[16:19], s95 offen offset:3072 lds
ds_read_b64_tr_b16 v[246:247], v6 offset:27136
v_mfma_f32_16x16x32_bf16 v[88:91], v[104:107], v[232:235], v[88:91]
v_and_b32 v164, 0xffff0000, v164
ds_read_b128 v[96:99], v8 offset:49152
v_add_f32 v164, 0x3727c5ac, v164
v_mfma_f32_16x16x32_bf16 v[52:55], v[224:227], v[108:111], v[52:55]
s_add_u32 m0, s46, 32768
s_xor_b32 s95, s87, 1
v_cvt_pk_bf16_f32 v164, v164, v164
v_mfma_f32_16x16x32_bf16 v[72:75], v[228:231], v[108:111], v[72:75]
s_mul_i32 s95, s95, 229376
buffer_load_dwordx4 v36, s[16:19], s95 offen offset:0 lds
v_mfma_f32_16x16x32_bf16 v[92:95], v[108:111], v[232:235], v[92:95]
ds_read_b128 v[100:103], v8 offset:51200
v_and_b32 v164, 0xffff0000, v164
s_waitcnt lgkmcnt(2)
v_mfma_f32_16x16x32_bf16 v[24:27], v[236:239], v[120:123], v[24:27]
v_sqrt_f32 v161, v164
v_mfma_f32_16x16x32_bf16 v[56:59], v[240:243], v[112:115], v[56:59]
ds_read_b128 v[104:107], v8 offset:53248
v_cvt_pk_bf16_f32 v160, v160, v160
v_mfma_f32_16x16x32_bf16 v[76:79], v[112:115], v[244:247], v[76:79]
buffer_load_dwordx4 v252, s[16:19], s95 offen offset:1024 lds
s_waitcnt lgkmcnt(1)
v_mfma_f32_16x16x32_bf16 v[40:43], v[236:239], v[96:99], v[40:43]
v_and_b32 v160, 0xffff0000, v160
ds_read_b128 v[108:111], v8 offset:55296
v_mfma_f32_16x16x32_bf16 v[60:63], v[240:243], v[96:99], v[60:63]
v_cvt_pk_bf16_f32 v161, v161, v161
v_and_b32 v161, 0xffff0000, v161
v_mfma_f32_16x16x32_bf16 v[80:83], v[96:99], v[244:247], v[80:83]
buffer_load_dwordx4 v253, s[16:19], s95 offen offset:2048 lds
ds_read_b64_tr_b16 v[224:225], v5 offset:0
v_mfma_f32_16x16x32_bf16 v[44:47], v[236:239], v[100:103], v[44:47]
v_rcp_f32 v164, v161
v_and_b32 v168, 15, v0
v_mfma_f32_16x16x32_bf16 v[64:67], v[240:243], v[100:103], v[64:67]
v_lshlrev_b32 v168, 2, v168
v_add_u32 v168, 159744, v168
s_lshl_b32 s88, s36, 6
v_mfma_f32_16x16x32_bf16 v[84:87], v[100:103], v[244:247], v[84:87]
buffer_load_dwordx4 v254, s[16:19], s95 offen offset:3072 lds
s_waitcnt lgkmcnt(1)
v_mfma_f32_16x16x32_bf16 v[48:51], v[236:239], v[104:107], v[48:51]
v_add_u32 v169, s88, v168
ds_read_b64_tr_b16 v[226:227], v5 offset:512
ds_read_b64_tr_b16 v[228:229], v5 offset:1024
v_mfma_f32_16x16x32_bf16 v[68:71], v[240:243], v[104:107], v[68:71]
ds_read_b64_tr_b16 v[230:231], v5 offset:1536
ds_read_b64_tr_b16 v[232:233], v5 offset:2048
ds_read_b64_tr_b16 v[234:235], v5 offset:2560
v_mfma_f32_16x16x32_bf16 v[88:91], v[104:107], v[244:247], v[88:91]
s_mov_b64 exec, s[32:33]
ds_read_b128 v[112:115], v124 offset:7168
s_mov_b64 exec, -1
s_add_u32 m0, s45, 122880
s_xor_b32 s38, s86, 3
s_lshl_b32 s38, s38, 16
s_add_u32 s38, s38, 32768
buffer_load_dwordx4 v9, s[12:15], s38 offen lds
v_mfma_f32_16x16x32_bf16 v[52:55], v[236:239], v[108:111], v[52:55]
ds_read_b128 v[96:99], v7 offset:57344
s_add_u32 m0, s45, 126976
v_mfma_f32_16x16x32_bf16 v[72:75], v[240:243], v[108:111], v[72:75]
s_mov_b32 exec_lo, 0x00f0000f
s_mov_b32 exec_hi, 0xf0000f00
ds_write2_b32 v169, v152, v156 offset0:16 offset1:96
ds_write2_b32 v168, v160, v164 offset0:0 offset1:80
s_mov_b64 exec, -1
v_mfma_f32_16x16x32_bf16 v[92:95], v[108:111], v[244:247], v[92:95]
s_xor_b32 s38, s86, 0
s_lshl_b32 s38, s38, 16
s_add_u32 s38, s38, 262144
ds_read_b128 v[100:103], v7 offset:59392
buffer_load_dwordx4 v9, s[12:15], s38 offen lds
s_waitcnt lgkmcnt(4)
v_mfma_f32_16x16x32_bf16 v[24:27], v[224:227], v[120:123], v[24:27]
s_waitcnt vmcnt(17)
s_barrier
s_lshr_b32 s88, s36, 1
s_lshl_b32 s89, s88, 15
s_add_u32 s89, s89, 94208
v_add_u32 v126, s89, v11
v_add_u32 v127, s89, v12
s_lshl_b32 s88, s88, 14
s_mul_i32 s89, s57, 114688
s_add_u32 s89, s89, s88
s_add_u32 s89, s89, 16777216
s_xor_b32 s40, s86, 0
s_lshl_b32 s40, s40, 12
s_add_u32 s40, s40, s89
s_xor_b32 s67, s86, 1
s_lshl_b32 s67, s67, 12
s_add_u32 s67, s67, s89
s_xor_b32 s68, s86, 2
s_lshl_b32 s68, s68, 12
s_add_u32 s68, s68, s89
s_xor_b32 s77, s86, 3
s_lshl_b32 s77, s77, 12
s_add_u32 s77, s77, s89
v_mfma_f32_16x16x32_bf16 v[56:59], v[228:231], v[112:115], v[56:59]
s_add_u32 m0, s45, 131072
s_xor_b32 s38, s86, 0
ds_read_b128 v[104:107], v7 offset:61440
v_mfma_f32_16x16x32_bf16 v[76:79], v[112:115], v[232:235], v[76:79]
s_lshl_b32 s38, s38, 16
s_waitcnt lgkmcnt(1)
v_mfma_f32_16x16x32_bf16 v[40:43], v[224:227], v[96:99], v[40:43]
s_add_u32 s38, s38, 294912
buffer_load_dwordx4 v9, s[12:15], s38 offen lds
v_mfma_f32_16x16x32_bf16 v[60:63], v[228:231], v[96:99], v[60:63]
ds_read_b128 v[108:111], v7 offset:63488
s_add_u32 m0, s45, 135168
v_mfma_f32_16x16x32_bf16 v[80:83], v[96:99], v[232:235], v[80:83]
s_xor_b32 s38, s86, 1
s_lshl_b32 s38, s38, 16
ds_read_b64_tr_b16 v[236:237], v5 offset:12288
v_mfma_f32_16x16x32_bf16 v[44:47], v[224:227], v[100:103], v[44:47]
s_add_u32 s38, s38, 262144
buffer_load_dwordx4 v9, s[12:15], s38 offen lds
v_mfma_f32_16x16x32_bf16 v[64:67], v[228:231], v[100:103], v[64:67]
ds_read_b64_tr_b16 v[238:239], v5 offset:12800
s_add_u32 m0, s45, 139264
ds_read_b64_tr_b16 v[240:241], v5 offset:13312
v_mfma_f32_16x16x32_bf16 v[84:87], v[100:103], v[232:235], v[84:87]
s_xor_b32 s38, s86, 1
ds_read_b64_tr_b16 v[242:243], v5 offset:13824
s_waitcnt lgkmcnt(4)
v_mfma_f32_16x16x32_bf16 v[48:51], v[224:227], v[104:107], v[48:51]
s_lshl_b32 s38, s38, 16
s_add_u32 s38, s38, 294912
buffer_load_dwordx4 v9, s[12:15], s38 offen lds
v_mfma_f32_16x16x32_bf16 v[68:71], v[228:231], v[104:107], v[68:71]
ds_read_b64_tr_b16 v[244:245], v5 offset:14336
ds_read_b64_tr_b16 v[246:247], v5 offset:14848
v_mfma_f32_16x16x32_bf16 v[88:91], v[104:107], v[232:235], v[88:91]
s_mov_b64 exec, s[32:33]
ds_read_b128 v[112:115], v125 offset:7168
s_mov_b64 exec, -1
v_mfma_f32_16x16x32_bf16 v[52:55], v[224:227], v[108:111], v[52:55]
s_add_u32 m0, s45, 143360
s_xor_b32 s38, s86, 2
s_lshl_b32 s38, s38, 16
s_add_u32 s38, s38, 262144
ds_read_b128 v[96:99], v8 offset:57344
buffer_load_dwordx4 v9, s[12:15], s38 offen lds
v_mfma_f32_16x16x32_bf16 v[72:75], v[228:231], v[108:111], v[72:75]
s_cmp_eq_u32 s47, 0
s_mov_b32 s92, 0xffffff
s_cselect_b32 s92, 0xffff, s92
s_mov_b32 s93, 0
v_lshrrev_b32 v33, 4, v0
v_sub_u32 v33, 15, v33
v_add_u32 v33, s81, v33
s_waitcnt vmcnt(14)
v_cmp_ne_u32 vcc, v33, v198
s_nop 0
s_and_b64 vcc, vcc, s[92:93]
s_cbranch_scc1 Ls2
Lb3:
v_cmp_ne_u32 vcc, s60, v199
s_nop 0
s_and_b32 s37, vcc_lo, 0xffff
v_mfma_f32_16x16x32_bf16 v[92:95], v[108:111], v[232:235], v[92:95]
ds_read_b128 v[100:103], v8 offset:59392
s_waitcnt lgkmcnt(2)
v_mfma_f32_16x16x32_bf16 v[24:27], v[236:239], v[120:123], v[24:27]
s_barrier
s_add_u32 m0, s45, 147456
s_xor_b32 s38, s86, 2
s_lshl_b32 s38, s38, 16
s_add_u32 s38, s38, 294912
buffer_load_dwordx4 v9, s[12:15], s38 offen lds
v_mfma_f32_16x16x32_bf16 v[56:59], v[240:243], v[112:115], v[56:59]
s_add_u32 m0, s45, 151552
s_xor_b32 s38, s86, 3
ds_read_b128 v[104:107], v8 offset:61440
v_mfma_f32_16x16x32_bf16 v[76:79], v[112:115], v[244:247], v[76:79]
s_lshl_b32 s38, s38, 16
s_waitcnt lgkmcnt(1)
v_mfma_f32_16x16x32_bf16 v[40:43], v[236:239], v[96:99], v[40:43]
s_add_u32 s38, s38, 262144
buffer_load_dwordx4 v9, s[12:15], s38 offen lds
v_mfma_f32_16x16x32_bf16 v[60:63], v[240:243], v[96:99], v[60:63]
ds_read_b128 v[108:111], v8 offset:63488
v_mfma_f32_16x16x32_bf16 v[80:83], v[96:99], v[244:247], v[80:83]
s_add_u32 m0, s45, 155648
s_xor_b32 s38, s86, 3
ds_read2_b32 v[144:145], v142 offset0:0 offset1:80
v_mfma_f32_16x16x32_bf16 v[44:47], v[236:239], v[100:103], v[44:47]
s_lshl_b32 s38, s38, 16
s_add_u32 s38, s38, 294912
ds_read2_b32 v[146:147], v142 offset0:16 offset1:96
v_mfma_f32_16x16x32_bf16 v[64:67], v[240:243], v[100:103], v[64:67]
buffer_load_dwordx4 v9, s[12:15], s38 offen lds
ds_read2_b32 v[148:149], v142 offset0:32 offset1:112
v_mfma_f32_16x16x32_bf16 v[84:87], v[100:103], v[244:247], v[84:87]
ds_read2_b32 v[150:151], v142 offset0:48 offset1:128
ds_read2_b32 v[152:153], v142 offset0:64 offset1:144
s_waitcnt lgkmcnt(5)
v_mfma_f32_16x16x32_bf16 v[48:51], v[236:239], v[104:107], v[48:51]
s_add_u32 m0, s45, 94208
s_xor_b32 s38, s86, 0
ds_read_b128 v[154:157], v143 offset:0
v_mfma_f32_16x16x32_bf16 v[68:71], v[240:243], v[104:107], v[68:71]
s_lshl_b32 s38, s38, 16
buffer_load_dwordx4 v9, s[12:15], s38 offen lds
v_mfma_f32_16x16x32_bf16 v[88:91], v[104:107], v[244:247], v[88:91]
ds_read_b128 v[158:161], v143 offset:320
ds_read_b128 v[162:165], v143 offset:64
v_mfma_f32_16x16x32_bf16 v[52:55], v[236:239], v[108:111], v[52:55]
ds_read_b128 v[166:169], v143 offset:384
v_mfma_f32_16x16x32_bf16 v[72:75], v[240:243], v[108:111], v[72:75]
ds_read_b128 v[170:173], v143 offset:128
ds_read_b128 v[174:177], v143 offset:448
ds_read_b128 v[178:181], v143 offset:192
ds_read_b128 v[182:185], v143 offset:512
ds_read_b128 v[186:189], v143 offset:256
ds_read_b128 v[190:193], v143 offset:576
v_mfma_f32_16x16x32_bf16 v[92:95], v[108:111], v[244:247], v[92:95]
v_mov_b32_dpp v28, v56 row_newbcast:0 row_mask:0xf bank_mask:0xf
v_mov_b32_dpp v29, v57 row_newbcast:0 row_mask:0xf bank_mask:0xf
v_mov_b32_dpp v30, v58 row_newbcast:0 row_mask:0xf bank_mask:0xf
v_mov_b32_dpp v31, v59 row_newbcast:0 row_mask:0xf bank_mask:0xf
v_mov_b32 v32, v76
v_mov_b32 v33, v76
s_nop 1
v_permlane32_swap_b32 v32, v33
s_waitcnt lgkmcnt(0)
s_barrier
s_add_u32 m0, s46, 49152
s_xor_b32 s95, s87, 2
s_mul_i32 s95, s95, 229376
buffer_load_dwordx4 v36, s[16:19], s95 offen offset:0 lds
buffer_load_dwordx4 v252, s[16:19], s95 offen offset:1024 lds
buffer_load_dwordx4 v253, s[16:19], s95 offen offset:2048 lds
buffer_load_dwordx4 v254, s[16:19], s95 offen offset:3072 lds
v_pk_fma_f32 v[56:57], v[28:29], v[144:145], v[56:57] op_sel_hi:[1,0,1]
v_pk_fma_f32 v[58:59], v[30:31], v[144:145], v[58:59] op_sel_hi:[1,0,1]
v_pk_mul_f32 v[56:57], v[56:57], v[144:145] op_sel:[0,1] op_sel_hi:[1,1]
v_pk_mul_f32 v[58:59], v[58:59], v[144:145] op_sel:[0,1] op_sel_hi:[1,1]
v_cvt_pk_bf16_f32 v210, v56, v57
v_cvt_pk_bf16_f32 v211, v58, v59
v_pk_fma_f32 v[60:61], v[28:29], v[146:147], v[60:61] op_sel_hi:[1,0,1]
v_pk_fma_f32 v[62:63], v[30:31], v[146:147], v[62:63] op_sel_hi:[1,0,1]
v_pk_fma_f32 v[40:41], v[24:25], v[146:147], v[40:41] op_sel_hi:[1,0,1]
v_pk_fma_f32 v[42:43], v[26:27], v[146:147], v[42:43] op_sel_hi:[1,0,1]
v_pk_mul_f32 v[60:61], v[60:61], v[146:147] op_sel:[0,1] op_sel_hi:[1,1]
v_pk_mul_f32 v[62:63], v[62:63], v[146:147] op_sel:[0,1] op_sel_hi:[1,1]
v_cvt_pk_bf16_f32 v202, v40, v41
v_cvt_pk_bf16_f32 v203, v42, v43
v_cvt_pk_bf16_f32 v212, v60, v61
v_cvt_pk_bf16_f32 v213, v62, v63
v_pk_fma_f32 v[64:65], v[28:29], v[148:149], v[64:65] op_sel_hi:[1,0,1]
v_pk_fma_f32 v[66:67], v[30:31], v[148:149], v[66:67] op_sel_hi:[1,0,1]
v_pk_fma_f32 v[44:45], v[24:25], v[148:149], v[44:45] op_sel_hi:[1,0,1]
v_pk_fma_f32 v[46:47], v[26:27], v[148:149], v[46:47] op_sel_hi:[1,0,1]
v_pk_mul_f32 v[64:65], v[64:65], v[148:149] op_sel:[0,1] op_sel_hi:[1,1]
v_pk_mul_f32 v[66:67], v[66:67], v[148:149] op_sel:[0,1] op_sel_hi:[1,1]
v_cvt_pk_bf16_f32 v204, v44, v45
v_cvt_pk_bf16_f32 v205, v46, v47
v_cvt_pk_bf16_f32 v214, v64, v65
v_cvt_pk_bf16_f32 v215, v66, v67
v_pk_fma_f32 v[68:69], v[28:29], v[150:151], v[68:69] op_sel_hi:[1,0,1]
v_pk_fma_f32 v[70:71], v[30:31], v[150:151], v[70:71] op_sel_hi:[1,0,1]
v_pk_fma_f32 v[48:49], v[24:25], v[150:151], v[48:49] op_sel_hi:[1,0,1]
v_pk_fma_f32 v[50:51], v[26:27], v[150:151], v[50:51] op_sel_hi:[1,0,1]
v_pk_mul_f32 v[68:69], v[68:69], v[150:151] op_sel:[0,1] op_sel_hi:[1,1]
v_pk_mul_f32 v[70:71], v[70:71], v[150:151] op_sel:[0,1] op_sel_hi:[1,1]
v_cvt_pk_bf16_f32 v206, v48, v49
v_cvt_pk_bf16_f32 v207, v50, v51
v_cvt_pk_bf16_f32 v216, v68, v69
v_cvt_pk_bf16_f32 v217, v70, v71
v_pk_fma_f32 v[72:73], v[28:29], v[152:153], v[72:73] op_sel_hi:[1,0,1]
v_pk_fma_f32 v[74:75], v[30:31], v[152:153], v[74:75] op_sel_hi:[1,0,1]
v_pk_fma_f32 v[52:53], v[24:25], v[152:153], v[52:53] op_sel_hi:[1,0,1]
v_pk_fma_f32 v[54:55], v[26:27], v[152:153], v[54:55] op_sel_hi:[1,0,1]
v_pk_mul_f32 v[72:73], v[72:73], v[152:153] op_sel:[0,1] op_sel_hi:[1,1]
v_pk_mul_f32 v[74:75], v[74:75], v[152:153] op_sel:[0,1] op_sel_hi:[1,1]
v_cvt_pk_bf16_f32 v208, v52, v53
v_cvt_pk_bf16_f32 v209, v54, v55
v_cvt_pk_bf16_f32 v218, v72, v73
v_cvt_pk_bf16_f32 v219, v74, v75
s_add_u32 m0, s46, 65536
s_xor_b32 s95, s87, 3
s_mul_i32 s95, s95, 229376
buffer_load_dwordx4 v36, s[16:19], s95 offen offset:0 lds
buffer_load_dwordx4 v252, s[16:19], s95 offen offset:1024 lds
buffer_load_dwordx4 v253, s[16:19], s95 offen offset:2048 lds
buffer_load_dwordx4 v254, s[16:19], s95 offen offset:3072 lds
v_mfma_f32_16x16x16_bf16 v[40:43], v[212:213], v[202:203], v[128:131]
v_mul_f32 v194, 0x3eb8aa3b, v147
v_mfma_f32_16x16x16_bf16 v[96:99], v[210:211], v[202:203], v[136:139]
v_mfma_f32_16x16x16_bf16 v[44:47], v[214:215], v[204:205], v[128:131]
v_mul_f32 v196, 0x3eb8aa3b, v149
v_mfma_f32_16x16x16_bf16 v[100:103], v[212:213], v[204:205], v[132:135]
v_mfma_f32_16x16x16_bf16 v[48:51], v[216:217], v[206:207], v[128:131]
v_mul_f32 v198, 0x3eb8aa3b, v151
v_mfma_f32_16x16x16_bf16 v[104:107], v[214:215], v[206:207], v[132:135]
v_mfma_f32_16x16x16_bf16 v[52:55], v[218:219], v[208:209], v[128:131]
v_mul_f32 v200, 0x3eb8aa3b, v153
v_mfma_f32_16x16x16_bf16 v[108:111], v[216:217], v[208:209], v[132:135]
v_mov_b32 v112, 0x3f803f80
v_mov_b32 v113, 0x3f803f80
v_mov_b32 v114, 0x3f803f80
v_mov_b32 v115, 0x3f803f80
v_pk_fma_f32 v[76:77], v[154:155], v[32:33], v[76:77] op_sel_hi:[1,0,1]
v_pk_fma_f32 v[78:79], v[156:157], v[32:33], v[78:79] op_sel_hi:[1,0,1]
v_pk_mul_f32 v[76:77], v[76:77], v[158:159]
v_pk_mul_f32 v[78:79], v[78:79], v[160:161]
v_cvt_pk_bf16_f32 v220, v76, v77
v_cvt_pk_bf16_f32 v221, v78, v79
v_pk_fma_f32 v[80:81], v[162:163], v[32:33], v[80:81] op_sel_hi:[1,0,1]
v_pk_fma_f32 v[82:83], v[164:165], v[32:33], v[82:83] op_sel_hi:[1,0,1]
v_pk_mul_f32 v[80:81], v[80:81], v[166:167]
v_pk_mul_f32 v[82:83], v[82:83], v[168:169]
v_cvt_pk_bf16_f32 v222, v80, v81
v_cvt_pk_bf16_f32 v223, v82, v83
v_pk_fma_f32 v[84:85], v[170:171], v[32:33], v[84:85] op_sel_hi:[1,0,1]
v_pk_fma_f32 v[86:87], v[172:173], v[32:33], v[86:87] op_sel_hi:[1,0,1]
v_pk_mul_f32 v[84:85], v[84:85], v[174:175]
v_pk_mul_f32 v[86:87], v[86:87], v[176:177]
v_cvt_pk_bf16_f32 v224, v84, v85
v_cvt_pk_bf16_f32 v225, v86, v87
v_pk_fma_f32 v[88:89], v[178:179], v[32:33], v[88:89] op_sel_hi:[1,0,1]
v_pk_fma_f32 v[90:91], v[180:181], v[32:33], v[90:91] op_sel_hi:[1,0,1]
v_pk_mul_f32 v[88:89], v[88:89], v[182:183]
v_pk_mul_f32 v[90:91], v[90:91], v[184:185]
v_cvt_pk_bf16_f32 v226, v88, v89
v_cvt_pk_bf16_f32 v227, v90, v91
v_pk_fma_f32 v[92:93], v[186:187], v[32:33], v[92:93] op_sel_hi:[1,0,1]
v_pk_fma_f32 v[94:95], v[188:189], v[32:33], v[94:95] op_sel_hi:[1,0,1]
v_pk_mul_f32 v[92:93], v[92:93], v[190:191]
v_pk_mul_f32 v[94:95], v[94:95], v[192:193]
v_cvt_pk_bf16_f32 v228, v92, v93
v_cvt_pk_bf16_f32 v229, v94, v95
v_max_f32 v40, v40, v96
v_max_f32 v41, v41, v97
v_max_f32 v42, v42, v98
v_max_f32 v43, v43, v99
v_max_f32 v44, v44, v100
v_max_f32 v45, v45, v101
v_max_f32 v46, v46, v102
v_max_f32 v47, v47, v103
v_max_f32 v48, v48, v104
v_max_f32 v49, v49, v105
v_max_f32 v50, v50, v106
v_max_f32 v51, v51, v107
v_max_f32 v52, v52, v108
v_max_f32 v53, v53, v109
v_max_f32 v54, v54, v110
v_max_f32 v55, v55, v111
v_max3_f32 v246, v40, v41, v42
v_max3_f32 v247, v44, v45, v46
v_max3_f32 v248, v48, v49, v50
v_max3_f32 v249, v52, v53, v54
v_max_f32 v246, v246, v43
v_max_f32 v247, v247, v47
v_max_f32 v248, v248, v51
v_max_f32 v249, v249, v55
v_permlane16_swap_b32 v246, v247
s_nop 0
v_permlane16_swap_b32 v248, v249
v_max_f32 v246, v246, v247
Lpage2:
s_cbranch_execz Ltour0
v_max_f32 v248, v248, v249
s_nop 1
v_permlane32_swap_b32 v246, v248
v_max_f32 v246, v246, v248
v_mov_b32 v248, v246
s_nop 1
v_permlane32_swap_b32 v246, v248
v_mov_b32 v247, v246
v_mov_b32 v249, v248
s_nop 0
v_permlane16_swap_b32 v246, v247
v_permlane16_swap_b32 v248, v249
v_mul_f32 v195, v246, v194
v_mul_f32 v197, v247, v196
v_mul_f32 v199, v248, v198
v_mul_f32 v201, v249, v200
v_pk_fma_f32 v[40:41], v[40:41], v[194:195], v[194:195] op_sel:[0,0,1] op_sel_hi:[1,0,1] neg_lo:[0,0,1] neg_hi:[0,0,1]
v_pk_fma_f32 v[42:43], v[42:43], v[194:195], v[194:195] op_sel:[0,0,1] op_sel_hi:[1,0,1] neg_lo:[0,0,1] neg_hi:[0,0,1]
v_pk_fma_f32 v[44:45], v[44:45], v[196:197], v[196:197] op_sel:[0,0,1] op_sel_hi:[1,0,1] neg_lo:[0,0,1] neg_hi:[0,0,1]
v_pk_fma_f32 v[46:47], v[46:47], v[196:197], v[196:197] op_sel:[0,0,1] op_sel_hi:[1,0,1] neg_lo:[0,0,1] neg_hi:[0,0,1]
v_pk_fma_f32 v[48:49], v[48:49], v[198:199], v[198:199] op_sel:[0,0,1] op_sel_hi:[1,0,1] neg_lo:[0,0,1] neg_hi:[0,0,1]
v_pk_fma_f32 v[50:51], v[50:51], v[198:199], v[198:199] op_sel:[0,0,1] op_sel_hi:[1,0,1] neg_lo:[0,0,1] neg_hi:[0,0,1]
v_pk_fma_f32 v[52:53], v[52:53], v[200:201], v[200:201] op_sel:[0,0,1] op_sel_hi:[1,0,1] neg_lo:[0,0,1] neg_hi:[0,0,1]
v_pk_fma_f32 v[54:55], v[54:55], v[200:201], v[200:201] op_sel:[0,0,1] op_sel_hi:[1,0,1] neg_lo:[0,0,1] neg_hi:[0,0,1]
v_exp_f32 v40, v40
v_exp_f32 v41, v41
v_exp_f32 v42, v42
v_exp_f32 v43, v43
v_exp_f32 v44, v44
v_exp_f32 v45, v45
v_exp_f32 v46, v46
v_exp_f32 v47, v47
v_exp_f32 v48, v48
v_exp_f32 v49, v49
v_exp_f32 v50, v50
v_exp_f32 v51, v51
v_exp_f32 v52, v52
v_exp_f32 v53, v53
v_exp_f32 v54, v54
v_exp_f32 v55, v55
v_cvt_pk_bf16_f32 v230, v40, v41
v_cvt_pk_bf16_f32 v231, v42, v43
v_and_b32 v232, v140, v230
v_and_b32 v233, v141, v231
v_xor_b32 v230, v230, v232
v_xor_b32 v231, v231, v233
v_cvt_pk_bf16_f32 v234, v44, v45
v_cvt_pk_bf16_f32 v235, v46, v47
v_and_b32 v236, v140, v234
v_and_b32 v237, v141, v235
v_xor_b32 v234, v234, v236
v_xor_b32 v235, v235, v237
v_mfma_f32_16x16x32_bf16 v[96:99], v[112:115], v[230:233], 0
v_mfma_f32_16x16x32_bf16 v[56:59], v[220:223], v[230:233], 0
v_cvt_pk_bf16_f32 v238, v48, v49
v_cvt_pk_bf16_f32 v239, v50, v51
v_and_b32 v240, v140, v238
v_and_b32 v241, v141, v239
v_xor_b32 v238, v238, v240
v_xor_b32 v239, v239, v241
v_mfma_f32_16x16x32_bf16 v[100:103], v[112:115], v[234:237], 0
v_mfma_f32_16x16x32_bf16 v[60:63], v[222:225], v[234:237], 0
v_cvt_pk_bf16_f32 v242, v52, v53
v_cvt_pk_bf16_f32 v243, v54, v55
v_and_b32 v244, v140, v242
v_and_b32 v245, v141, v243
v_xor_b32 v242, v242, v244
v_xor_b32 v243, v243, v245
v_mfma_f32_16x16x32_bf16 v[104:107], v[112:115], v[238:241], 0
v_mfma_f32_16x16x32_bf16 v[64:67], v[224:227], v[238:241], 0
v_rcp_f32 v96, v96
v_mfma_f32_16x16x32_bf16 v[108:111], v[112:115], v[242:245], 0
v_mfma_f32_16x16x32_bf16 v[68:71], v[226:229], v[242:245], 0
v_rcp_f32 v100, v100
v_mul_f32 v56, v96, v56
v_mul_f32 v57, v96, v57
v_mul_f32 v58, v96, v58
v_mul_f32 v59, v96, v59
v_rcp_f32 v104, v104
v_mul_f32 v60, v100, v60
v_mul_f32 v61, v100, v61
v_mul_f32 v62, v100, v62
v_mul_f32 v63, v100, v63
v_rcp_f32 v108, v108
v_mul_f32 v64, v104, v64
v_mul_f32 v65, v104, v65
v_mul_f32 v66, v104, v66
v_mul_f32 v67, v104, v67
v_mul_f32 v68, v108, v68
v_mul_f32 v69, v108, v69
v_mul_f32 v70, v108, v70
v_mul_f32 v71, v108, v71
v_cvt_pk_bf16_f32 v230, v56, v57
v_cvt_pk_bf16_f32 v231, v58, v59
v_cvt_pk_bf16_f32 v232, v60, v61
v_cvt_pk_bf16_f32 v233, v62, v63
v_cvt_pk_bf16_f32 v234, v64, v65
v_cvt_pk_bf16_f32 v235, v66, v67
v_cvt_pk_bf16_f32 v236, v68, v69
v_cvt_pk_bf16_f32 v237, v70, v71
v_permlane16_swap_b32 v230, v232
v_permlane16_swap_b32 v231, v233
v_permlane16_swap_b32 v234, v236
v_permlane16_swap_b32 v235, v237
s_cmp_lg_u32 s37, 0
s_cbranch_scc1 Lalt1_b
buffer_store_dwordx4 v[230:233], v1, s[28:31], s79 offen
buffer_store_dwordx4 v[234:237], v1, s[28:31], s80 offen
Lalt1_e:
s_mov_b64 exec, 0
s_cmp_eq_u32 s36, 0
s_cbranch_scc1 Lpage5
s_cmp_eq_u32 s36, 1
s_cbranch_scc1 Lpage6
s_cmp_eq_u32 s36, 2
s_cbranch_scc1 Lpage7
s_branch Lpage8
Ltour1:
s_mov_b64 exec, -1
s_add_u32 s91, s81, 1
v_mov_b32 v38, s91
s_waitcnt vmcnt(0)
s_cmp_lg_u32 s37, 0
s_cbranch_scc1 Lalt2_b
buffer_store_dword v38, v15, s[28:31], 0 offen
Lalt2_e:
s_barrier
ds_read_b64_tr_b16 v[92:93], v127 offset:0
ds_read_b64_tr_b16 v[94:95], v127 offset:512
ds_read_b64_tr_b16 v[88:89], v126 offset:0
ds_read_b64_tr_b16 v[90:91], v126 offset:512
ds_read_b64_tr_b16 v[100:101], v127 offset:2048
ds_read_b64_tr_b16 v[102:103], v127 offset:2560
ds_read_b64_tr_b16 v[96:97], v126 offset:2048
ds_read_b64_tr_b16 v[98:99], v126 offset:2560
ds_read_b64_tr_b16 v[76:77], v127 offset:4096
ds_read_b64_tr_b16 v[78:79], v127 offset:4608
ds_read_b64_tr_b16 v[72:73], v126 offset:4096
ds_read_b64_tr_b16 v[74:75], v126 offset:4608
v_lshlrev_b32 v40, 16, v16
v_and_b32 v41, 0xffff0000, v16
v_lshlrev_b32 v42, 16, v17
v_and_b32 v43, 0xffff0000, v17
v_lshlrev_b32 v44, 16, v18
v_and_b32 v45, 0xffff0000, v18
v_lshlrev_b32 v46, 16, v19
v_and_b32 v47, 0xffff0000, v19
v_lshlrev_b32 v48, 16, v20
v_and_b32 v49, 0xffff0000, v20
v_lshlrev_b32 v50, 16, v21
v_and_b32 v51, 0xffff0000, v21
v_lshlrev_b32 v52, 16, v22
v_and_b32 v53, 0xffff0000, v22
v_lshlrev_b32 v54, 16, v23
v_and_b32 v55, 0xffff0000, v23
v_add_u32 v212, 49152, v37
v_add_u32 v213, 98304, v37
v_lshrrev_b32 v220, 2, v0
v_lshrrev_b32 v221, 4, v0
v_xor_b32 v220, v220, v221
v_and_b32 v220, 1, v220
v_cmp_eq_u32 vcc, 0, v220
v_mov_b32 v221, 0x3f803f80
s_nop 0
v_cndmask_b32 v220, 0, v221, vcc
v_mov_b32 v221, v220
v_mov_b32 v222, v220
v_mov_b32 v223, v220
ds_read_b64_tr_b16 a[0:1], v37 offset:16384
ds_read_b64_tr_b16 a[2:3], v37 offset:16896
ds_read_b64_tr_b16 a[4:5], v37 offset:17408
ds_read_b64_tr_b16 a[6:7], v37 offset:17920
ds_read_b64_tr_b16 a[8:9], v37 offset:18432
ds_read_b64_tr_b16 a[10:11], v37 offset:18944
ds_read_b64_tr_b16 a[12:13], v37 offset:19456
ds_read_b64_tr_b16 a[14:15], v37 offset:19968
s_waitcnt lgkmcnt(6)
v_mfma_f32_16x16x32_bf16 v[216:219], v[220:223], a[0:3], 0
ds_read_b64_tr_b16 a[16:17], v37 offset:32768
ds_read_b64_tr_b16 a[18:19], v37 offset:33280
s_waitcnt lgkmcnt(6)
v_mfma_f32_16x16x32_bf16 v[216:219], v[220:223], a[4:7], v[216:219]
ds_read_b64_tr_b16 a[20:21], v37 offset:33792
ds_read_b64_tr_b16 a[22:23], v37 offset:34304
s_waitcnt lgkmcnt(6)
v_mfma_f32_16x16x32_bf16 v[216:219], v[220:223], a[8:11], v[216:219]
ds_read_b64_tr_b16 a[24:25], v37 offset:34816
ds_read_b64_tr_b16 a[26:27], v37 offset:35328
s_waitcnt lgkmcnt(6)
v_mfma_f32_16x16x32_bf16 v[216:219], v[220:223], a[12:15], v[216:219]
ds_read_b64_tr_b16 a[28:29], v37 offset:35840
ds_read_b64_tr_b16 a[30:31], v37 offset:36352
s_waitcnt lgkmcnt(6)
v_mfma_f32_16x16x32_bf16 v[216:219], v[220:223], a[16:19], v[216:219]
ds_read_b64_tr_b16 a[32:33], v212 offset:0
ds_read_b64_tr_b16 a[34:35], v212 offset:512
s_waitcnt lgkmcnt(6)
v_mfma_f32_16x16x32_bf16 v[216:219], v[220:223], a[20:23], v[216:219]
ds_read_b64_tr_b16 a[36:37], v212 offset:1024
ds_read_b64_tr_b16 a[38:39], v212 offset:1536
s_waitcnt lgkmcnt(6)
v_mfma_f32_16x16x32_bf16 v[216:219], v[220:223], a[24:27], v[216:219]
ds_read_b64_tr_b16 a[40:41], v212 offset:2048
ds_read_b64_tr_b16 a[42:43], v212 offset:2560
s_waitcnt lgkmcnt(6)
v_mfma_f32_16x16x32_bf16 v[216:219], v[220:223], a[28:31], v[216:219]
ds_read_b64_tr_b16 a[44:45], v212 offset:3072
ds_read_b64_tr_b16 a[46:47], v212 offset:3584
s_waitcnt lgkmcnt(6)
v_mfma_f32_16x16x32_bf16 v[216:219], v[220:223], a[32:35], v[216:219]
ds_read_b64_tr_b16 a[48:49], v212 offset:16384
ds_read_b64_tr_b16 a[50:51], v212 offset:16896
s_waitcnt lgkmcnt(6)
v_mfma_f32_16x16x32_bf16 v[216:219], v[220:223], a[36:39], v[216:219]
ds_read_b64_tr_b16 a[52:53], v212 offset:17408
ds_read_b64_tr_b16 a[54:55], v212 offset:17920
s_waitcnt lgkmcnt(6)
v_mfma_f32_16x16x32_bf16 v[216:219], v[220:223], a[40:43], v[216:219]
ds_read_b64_tr_b16 a[56:57], v212 offset:18432
ds_read_b64_tr_b16 a[58:59], v212 offset:18944
s_waitcnt lgkmcnt(6)
v_mfma_f32_16x16x32_bf16 v[216:219], v[220:223], a[44:47], v[216:219]
ds_read_b64_tr_b16 a[60:61], v212 offset:19456
ds_read_b64_tr_b16 a[62:63], v212 offset:19968
s_waitcnt lgkmcnt(6)
v_mfma_f32_16x16x32_bf16 v[216:219], v[220:223], a[48:51], v[216:219]
s_waitcnt lgkmcnt(4)
v_mfma_f32_16x16x32_bf16 v[216:219], v[220:223], a[52:55], v[216:219]
s_waitcnt lgkmcnt(2)
v_mfma_f32_16x16x32_bf16 v[216:219], v[220:223], a[56:59], v[216:219]
s_waitcnt lgkmcnt(0)
v_mfma_f32_16x16x32_bf16 v[216:219], v[220:223], a[60:63], v[216:219]
s_barrier
s_add_u32 s91, s81, 1
s_mov_b32 s58, 30000
Lpl4:
buffer_load_dword v38, v14, s[28:31], 0 offen sc1
s_sub_u32 s58, s58, 1
s_cmp_eq_u32 s58, 0
s_cselect_b64 s[88:89], 0, s[50:51]
s_waitcnt vmcnt(0)
v_subrev_u32 v33, s91, v38
v_cmp_lt_u32 vcc, 7, v33
s_nop 0
s_and_b64 vcc, vcc, s[88:89]
s_cbranch_scc1 Lpl4
buffer_load_dwordx4 v[128:131], v1, s[28:31], s40 offen offset:0 sc1
buffer_load_dwordx4 v[132:135], v1, s[28:31], s40 offen offset:1024 sc1
buffer_load_dwordx4 v[136:139], v1, s[28:31], s40 offen offset:2048 sc1
buffer_load_dwordx4 v[140:143], v1, s[28:31], s40 offen offset:3072 sc1
buffer_load_dwordx4 v[144:147], v1, s[28:31], s67 offen offset:0 sc1
buffer_load_dwordx4 v[148:151], v1, s[28:31], s67 offen offset:1024 sc1
buffer_load_dwordx4 v[152:155], v1, s[28:31], s67 offen offset:2048 sc1
buffer_load_dwordx4 v[156:159], v1, s[28:31], s67 offen offset:3072 sc1
buffer_load_dwordx4 v[160:163], v1, s[28:31], s68 offen offset:0 sc1
buffer_load_dwordx4 v[164:167], v1, s[28:31], s68 offen offset:1024 sc1
s_waitcnt vmcnt(9)
v_mfma_f32_32x32x16_bf16 v[104:119], v[92:95], v[128:131], 0
buffer_load_dwordx4 v[168:171], v1, s[28:31], s68 offen offset:2048 sc1
ds_read_b64_tr_b16 v[84:85], v127 offset:6144
ds_read_b64_tr_b16 v[80:81], v126 offset:6144
ds_read_b64_tr_b16 v[86:87], v127 offset:6656
v_mfma_f32_32x32x16_bf16 v[40:55], v[88:91], v[128:131], v[40:55]
buffer_load_dwordx4 v[172:175], v1, s[28:31], s68 offen offset:3072 sc1
ds_read_b64_tr_b16 v[82:83], v126 offset:6656
ds_read_b64_tr_b16 v[92:93], v127 offset:8192
ds_read_b64_tr_b16 v[94:95], v127 offset:8704
s_waitcnt vmcnt(10)
v_mfma_f32_32x32x16_bf16 v[104:119], v[100:103], v[132:135], v[104:119]
buffer_load_dwordx4 v[176:179], v1, s[28:31], s77 offen offset:0 sc1
ds_read_b64_tr_b16 v[88:89], v126 offset:8192
v_add_u32 v208, s64, v9
ds_read_b64_tr_b16 v[90:91], v126 offset:8704
v_mfma_f32_32x32x16_bf16 v[40:55], v[96:99], v[132:135], v[40:55]
buffer_load_dwordx4 v[180:183], v1, s[28:31], s77 offen offset:1024 sc1
v_add_u32 v209, 7168, v208
ds_read_b64_tr_b16 v[100:101], v127 offset:10240
v_add_u32 v210, 14336, v208
s_waitcnt vmcnt(11)
v_mfma_f32_32x32x16_bf16 v[104:119], v[76:79], v[136:139], v[104:119]
ds_read_b64_tr_b16 v[102:103], v127 offset:10752
v_add_u32 v211, 21504, v208
ds_read_b64_tr_b16 v[96:97], v126 offset:10240
v_add_u32 v124, 65536, v1
ds_read_b64_tr_b16 v[98:99], v126 offset:10752
v_mfma_f32_32x32x16_bf16 v[40:55], v[72:75], v[136:139], v[40:55]
buffer_load_dwordx4 v[184:187], v1, s[28:31], s77 offen offset:2048 sc1
v_and_b32 v125, 31, v0
ds_read_b64_tr_b16 v[76:77], v127 offset:12288
s_waitcnt lgkmcnt(9)
s_waitcnt vmcnt(11)
v_mfma_f32_32x32x16_bf16 v[104:119], v[84:87], v[140:143], v[104:119]
v_lshlrev_b32 v125, 4, v125
ds_read_b64_tr_b16 v[78:79], v127 offset:12800
v_add_u32 v125, 159744, v125
ds_read_b64_tr_b16 v[72:73], v126 offset:12288
v_lshlrev_b32 v206, 3, v0
v_mfma_f32_32x32x16_bf16 v[40:55], v[80:83], v[140:143], v[40:55]
buffer_load_dwordx4 v[188:191], v1, s[28:31], s77 offen offset:3072 sc1
ds_read_b64_tr_b16 v[74:75], v126 offset:12800
s_lshl_b32 s88, s36, 9
s_waitcnt lgkmcnt(8)
s_waitcnt vmcnt(11)
v_mfma_f32_32x32x16_bf16 v[104:119], v[92:95], v[144:147], v[104:119]
s_add_u32 m0, s46, 16384
s_xor_b32 s95, s87, 4
s_mul_i32 s95, s95, 229376
s_add_u32 s88, s88, 161792
ds_read_b64_tr_b16 v[84:85], v127 offset:14336
v_mfma_f32_32x32x16_bf16 v[40:55], v[88:91], v[144:147], v[40:55]
buffer_load_dwordx4 v36, s[16:19], s95 offen offset:0 lds
v_add_u32 v206, s88, v206
ds_read_b64_tr_b16 v[86:87], v127 offset:14848
s_waitcnt lgkmcnt(6)
s_waitcnt vmcnt(11)
v_mfma_f32_32x32x16_bf16 v[104:119], v[100:103], v[148:151], v[104:119]
s_lshl_b32 s92, s42, 2
ds_read_b64_tr_b16 v[80:81], v126 offset:14336
s_add_u32 s92, s92, s36
ds_read_b64_tr_b16 v[82:83], v126 offset:14848
s_lshl_b32 s92, s92, 12
v_mfma_f32_32x32x16_bf16 v[40:55], v[96:99], v[148:151], v[40:55]
buffer_load_dwordx4 v252, s[16:19], s95 offen offset:1024 lds
ds_read_b64_tr_b16 v[92:93], v127 offset:16384
s_mul_i32 s76, s42, 458752
s_waitcnt lgkmcnt(5)
s_waitcnt vmcnt(11)
v_mfma_f32_32x32x16_bf16 v[104:119], v[76:79], v[152:155], v[104:119]
ds_read_b64_tr_b16 v[94:95], v127 offset:16896
s_lshl_b32 s88, s43, 13
ds_read_b64_tr_b16 v[88:89], v126 offset:16384
s_add_u32 s76, s76, s88
ds_read_b64_tr_b16 v[90:91], v126 offset:16896
v_mfma_f32_32x32x16_bf16 v[40:55], v[72:75], v[152:155], v[40:55]
buffer_load_dwordx4 v253, s[16:19], s95 offen offset:2048 lds
s_add_u32 s76, s76, s45
ds_read_b64_tr_b16 v[100:101], v127 offset:18432
s_waitcnt lgkmcnt(5)
s_waitcnt vmcnt(11)
v_mfma_f32_32x32x16_bf16 v[104:119], v[84:87], v[156:159], v[104:119]
s_add_u32 s76, s76, 16777216
ds_read_b64_tr_b16 v[102:103], v127 offset:18944
s_cmp_lg_u32 s49, 0
s_cselect_b32 s76, 0x7fe00000, s76
ds_read_b64_tr_b16 v[96:97], v126 offset:18432
v_mfma_f32_32x32x16_bf16 v[40:55], v[80:83], v[156:159], v[40:55]
buffer_load_dwordx4 v254, s[16:19], s95 offen offset:3072 lds
ds_read_b64_tr_b16 v[98:99], v126 offset:18944
s_lshl_b32 s79, s57, 15
s_waitcnt lgkmcnt(4)
s_waitcnt vmcnt(11)
v_mfma_f32_32x32x16_bf16 v[104:119], v[92:95], v[160:163], v[104:119]
s_add_u32 m0, s46, 32768
s_xor_b32 s95, s87, 5
s_mul_i32 s95, s95, 229376
ds_read_b64_tr_b16 v[76:77], v127 offset:20480
s_lshl_b32 s89, s44, 12
v_mfma_f32_32x32x16_bf16 v[40:55], v[88:91], v[160:163], v[40:55]
ds_read_b64_tr_b16 v[78:79], v127 offset:20992
buffer_load_dwordx4 v36, s[16:19], s95 offen offset:0 lds
s_add_u32 s79, s79, s89
s_waitcnt lgkmcnt(2)
s_waitcnt vmcnt(11)
v_mfma_f32_32x32x16_bf16 v[104:119], v[100:103], v[164:167], v[104:119]
ds_read_b64_tr_b16 v[72:73], v126 offset:20480
ds_read_b64_tr_b16 v[74:75], v126 offset:20992
s_and_b32 s89, s45, 2048
s_add_u32 s79, s79, s89
ds_read_b64_tr_b16 v[84:85], v127 offset:22528
v_mfma_f32_32x32x16_bf16 v[40:55], v[96:99], v[164:167], v[40:55]
ds_read_b64_tr_b16 v[86:87], v127 offset:23040
buffer_load_dwordx4 v252, s[16:19], s95 offen offset:1024 lds
s_add_u32 s79, s79, 4194304
s_lshl_b32 s80, s57, 12
s_waitcnt lgkmcnt(2)
s_waitcnt vmcnt(11)
v_mfma_f32_32x32x16_bf16 v[104:119], v[76:79], v[168:171], v[104:119]
ds_read_b64_tr_b16 v[92:93], v127 offset:24576
ds_read_b64_tr_b16 v[94:95], v127 offset:25088
s_lshl_b32 s89, s44, 9
s_add_u32 s80, s80, s89
s_lshr_b32 s89, s36, 1
v_mfma_f32_32x32x16_bf16 v[40:55], v[72:75], v[168:171], v[40:55]
ds_read_b64_tr_b16 v[100:101], v127 offset:26624
ds_read_b64_tr_b16 v[102:103], v127 offset:27136
buffer_load_dwordx4 v253, s[16:19], s95 offen offset:2048 lds
s_lshl_b32 s89, s89, 8
s_waitcnt vmcnt(11) lgkmcnt(4)
v_mfma_f32_32x32x16_bf16 v[104:119], v[84:87], v[172:175], v[104:119]
s_add_u32 s80, s80, s89
s_add_u32 s80, s80, 10485760
v_add_u32 v122, s46, v1
v_xor_b32 v123, 8192, v122
v_and_b32 v207, 31, v0
v_lshlrev_b32 v207, 3, v207
ds_read_b64_tr_b16 v[76:77], v127 offset:28672
v_lshrrev_b32 v33, 5, v0
ds_read_b64_tr_b16 v[78:79], v127 offset:29184
v_lshl_add_u32 v207, v33, 2, v207
s_waitcnt vmcnt(10) lgkmcnt(4)
v_mfma_f32_32x32x16_bf16 v[104:119], v[92:95], v[176:179], v[104:119]
ds_read_b64_tr_b16 v[84:85], v127 offset:30720
ds_read_b64_tr_b16 v[86:87], v127 offset:31232
buffer_load_dwordx4 v254, s[16:19], s95 offen offset:3072 lds
ds_read_b64_tr_b16 v[80:81], v126 offset:22528
ds_read_b64_tr_b16 v[82:83], v126 offset:23040
s_waitcnt vmcnt(10) lgkmcnt(6)
v_mfma_f32_32x32x16_bf16 v[104:119], v[100:103], v[180:183], v[104:119]
s_add_u32 m0, s46, 49152
s_xor_b32 s95, s87, 6
s_mul_i32 s95, s95, 229376
buffer_load_dwordx4 v36, s[16:19], s95 offen offset:0 lds
ds_read_b64_tr_b16 v[88:89], v126 offset:24576
s_waitcnt vmcnt(10) lgkmcnt(5)
v_mfma_f32_32x32x16_bf16 v[104:119], v[76:79], v[184:187], v[104:119]
ds_read_b64_tr_b16 v[90:91], v126 offset:25088
ds_read_b64_tr_b16 v[96:97], v126 offset:26624
ds_read_b64_tr_b16 v[98:99], v126 offset:27136
ds_read_b64_tr_b16 v[72:73], v126 offset:28672
s_waitcnt vmcnt(9) lgkmcnt(7)
v_mfma_f32_32x32x16_bf16 v[104:119], v[84:87], v[188:191], v[104:119]
buffer_load_dwordx4 v252, s[16:19], s95 offen offset:1024 lds
ds_read_b64_tr_b16 v[74:75], v126 offset:29184
s_waitcnt lgkmcnt(6)
v_mfma_f32_32x32x16_bf16 v[40:55], v[80:83], v[172:175], v[40:55]
s_waitcnt lgkmcnt(4)
v_mfma_f32_32x32x16_bf16 v[40:55], v[88:91], v[176:179], v[40:55]
ds_read_b64_tr_b16 v[80:81], v126 offset:30720
ds_read_b64_tr_b16 v[82:83], v126 offset:31232
buffer_load_dwordx4 v253, s[16:19], s95 offen offset:2048 lds
s_nop 2
ds_write_b128 v122, v[104:107] offset:0
s_waitcnt lgkmcnt(5)
v_mfma_f32_32x32x16_bf16 v[40:55], v[96:99], v[180:183], v[40:55]
s_waitcnt lgkmcnt(3)
v_mfma_f32_32x32x16_bf16 v[40:55], v[72:75], v[184:187], v[40:55]
buffer_load_dwordx4 v254, s[16:19], s95 offen offset:3072 lds
ds_write_b128 v122, v[108:111] offset:1024
s_waitcnt lgkmcnt(2)
v_mfma_f32_32x32x16_bf16 v[40:55], v[80:83], v[188:191], v[40:55]
ds_write_b128 v122, v[112:115] offset:2048
ds_write_b128 v122, v[116:119] offset:3072
s_waitcnt lgkmcnt(0)
s_barrier
ds_read_b128 v[56:59], v123 offset:0
ds_read_b128 v[60:63], v123 offset:1024
ds_read_b128 v[64:67], v123 offset:2048
ds_read_b128 v[68:71], v123 offset:3072
s_waitcnt lgkmcnt(3)
s_nop 2
v_pk_add_f32 v[40:41], v[40:41], v[56:57]
v_pk_add_f32 v[42:43], v[42:43], v[58:59]
v_cvt_pk_bf16_f32 v16, v40, v41
v_cvt_pk_bf16_f32 v17, v42, v43
s_waitcnt lgkmcnt(2)
v_pk_add_f32 v[44:45], v[44:45], v[60:61]
v_pk_add_f32 v[46:47], v[46:47], v[62:63]
v_cvt_pk_bf16_f32 v18, v44, v45
v_cvt_pk_bf16_f32 v19, v46, v47
s_waitcnt lgkmcnt(1)
v_pk_add_f32 v[48:49], v[48:49], v[64:65]
v_pk_add_f32 v[50:51], v[50:51], v[66:67]
v_cvt_pk_bf16_f32 v20, v48, v49
v_cvt_pk_bf16_f32 v21, v50, v51
s_waitcnt lgkmcnt(0)
v_pk_add_f32 v[52:53], v[52:53], v[68:69]
v_pk_add_f32 v[54:55], v[54:55], v[70:71]
v_cvt_pk_bf16_f32 v22, v52, v53
v_cvt_pk_bf16_f32 v23, v54, v55
s_cmp_lg_u32 s37, 0
s_cbranch_scc1 Lalt3_b
buffer_store_dwordx4 v[16:19], v1, s[28:31], s79 offen
buffer_store_dwordx4 v[20:23], v1, s[28:31], s79 offen offset:1024
Lalt3_e:
v_pk_add_f32 v[88:89], v[40:41], v[42:43]
v_pk_mul_f32 v[90:91], v[40:41], v[40:41]
v_pk_fma_f32 v[90:91], v[42:43], v[42:43], v[90:91]
v_pk_add_f32 v[88:89], v[88:89], v[44:45]
v_pk_fma_f32 v[90:91], v[44:45], v[44:45], v[90:91]
v_pk_add_f32 v[88:89], v[88:89], v[46:47]
v_pk_fma_f32 v[90:91], v[46:47], v[46:47], v[90:91]
v_pk_add_f32 v[88:89], v[88:89], v[48:49]
v_pk_fma_f32 v[90:91], v[48:49], v[48:49], v[90:91]
v_pk_add_f32 v[88:89], v[88:89], v[50:51]
v_pk_fma_f32 v[90:91], v[50:51], v[50:51], v[90:91]
v_pk_add_f32 v[88:89], v[88:89], v[52:53]
v_pk_fma_f32 v[90:91], v[52:53], v[52:53], v[90:91]
v_pk_add_f32 v[88:89], v[88:89], v[54:55]
v_pk_fma_f32 v[90:91], v[54:55], v[54:55], v[90:91]
v_add_f32 v88, v88, v89
v_add_f32 v90, v90, v91
s_nop 1
v_permlane32_swap_b32 v88, v90
v_add_f32 v88, v88, v90
s_cmp_lg_u32 s37, 0
s_cbranch_scc1 Lalt4_b
buffer_store_dword v88, v207, s[28:31], s80 offen
Lalt4_e:
s_add_u32 m0, s46, 98304
s_xor_b32 s95, s87, 7
s_mul_i32 s95, s95, 229376
buffer_load_dwordx4 v36, s[16:19], s95 offen offset:0 lds
buffer_load_dwordx4 v252, s[16:19], s95 offen offset:1024 lds
buffer_load_dwordx4 v253, s[16:19], s95 offen offset:2048 lds
buffer_load_dwordx4 v254, s[16:19], s95 offen offset:3072 lds
s_add_u32 m0, s46, 114688
s_xor_b32 s95, s87, 0
s_mul_i32 s95, s95, 229376
s_add_u32 s95, s95, 128
buffer_load_dwordx4 v36, s[16:19], s95 offen offset:0 lds
buffer_load_dwordx4 v252, s[16:19], s95 offen offset:1024 lds
buffer_load_dwordx4 v253, s[16:19], s95 offen offset:2048 lds
buffer_load_dwordx4 v254, s[16:19], s95 offen offset:3072 lds
s_add_u32 s91, s81, 2
v_mov_b32 v38, s91
s_waitcnt vmcnt(8)
s_cmp_lg_u32 s37, 0
s_cbranch_scc1 Lalt5_b
buffer_store_dword v38, v15, s[28:31], 0 offen
Lalt5_e:
s_barrier
ds_read_b64_tr_b16 a[64:65], v37 offset:16384
ds_read_b64_tr_b16 a[66:67], v37 offset:16896
ds_read_b64_tr_b16 a[68:69], v37 offset:17408
ds_read_b64_tr_b16 a[70:71], v37 offset:17920
ds_read_b64_tr_b16 a[72:73], v37 offset:18432
ds_read_b64_tr_b16 a[74:75], v37 offset:18944
ds_read_b64_tr_b16 a[76:77], v37 offset:19456
ds_read_b64_tr_b16 a[78:79], v37 offset:19968
s_waitcnt lgkmcnt(6)
v_mfma_f32_16x16x32_bf16 v[216:219], v[220:223], a[64:67], v[216:219]
ds_read_b64_tr_b16 a[80:81], v37 offset:32768
ds_read_b64_tr_b16 a[82:83], v37 offset:33280
s_waitcnt lgkmcnt(6)
v_mfma_f32_16x16x32_bf16 v[216:219], v[220:223], a[68:71], v[216:219]
ds_read_b64_tr_b16 a[84:85], v37 offset:33792
ds_read_b64_tr_b16 a[86:87], v37 offset:34304
s_waitcnt lgkmcnt(6)
v_mfma_f32_16x16x32_bf16 v[216:219], v[220:223], a[72:75], v[216:219]
ds_read_b64_tr_b16 a[88:89], v37 offset:34816
ds_read_b64_tr_b16 a[90:91], v37 offset:35328
s_waitcnt lgkmcnt(6)
v_mfma_f32_16x16x32_bf16 v[216:219], v[220:223], a[76:79], v[216:219]
ds_read_b64_tr_b16 a[92:93], v37 offset:35840
ds_read_b64_tr_b16 a[94:95], v37 offset:36352
s_waitcnt lgkmcnt(6)
v_mfma_f32_16x16x32_bf16 v[216:219], v[220:223], a[80:83], v[216:219]
ds_read_b64_tr_b16 a[96:97], v212 offset:0
ds_read_b64_tr_b16 a[98:99], v212 offset:512
s_waitcnt lgkmcnt(6)
v_mfma_f32_16x16x32_bf16 v[216:219], v[220:223], a[84:87], v[216:219]
ds_read_b64_tr_b16 a[100:101], v212 offset:1024
ds_read_b64_tr_b16 a[102:103], v212 offset:1536
s_waitcnt lgkmcnt(6)
v_mfma_f32_16x16x32_bf16 v[216:219], v[220:223], a[88:91], v[216:219]
ds_read_b64_tr_b16 a[104:105], v212 offset:2048
ds_read_b64_tr_b16 a[106:107], v212 offset:2560
s_waitcnt lgkmcnt(6)
v_mfma_f32_16x16x32_bf16 v[216:219], v[220:223], a[92:95], v[216:219]
ds_read_b64_tr_b16 a[108:109], v212 offset:3072
ds_read_b64_tr_b16 a[110:111], v212 offset:3584
s_waitcnt lgkmcnt(6)
v_mfma_f32_16x16x32_bf16 v[216:219], v[220:223], a[96:99], v[216:219]
s_waitcnt lgkmcnt(4)
v_mfma_f32_16x16x32_bf16 v[216:219], v[220:223], a[100:103], v[216:219]
s_waitcnt lgkmcnt(2)
v_mfma_f32_16x16x32_bf16 v[216:219], v[220:223], a[104:107], v[216:219]
s_waitcnt lgkmcnt(0)
v_mfma_f32_16x16x32_bf16 v[216:219], v[220:223], a[108:111], v[216:219]
s_waitcnt lgkmcnt(0)
s_barrier
s_cmp_lg_u32 s49, 0
s_cbranch_scc1 Lp3skip5
s_add_u32 s91, s81, 2
s_mov_b32 s58, 30000
Lpl6:
buffer_load_dword v38, v14, s[28:31], 0 offen sc1
s_sub_u32 s58, s58, 1
s_cmp_eq_u32 s58, 0
s_cselect_b64 s[88:89], 0, exec
s_waitcnt vmcnt(0)
v_subrev_u32 v33, s91, v38
v_cmp_lt_u32 vcc, 7, v33
s_nop 0
s_and_b64 vcc, vcc, s[88:89]
s_cbranch_scc1 Lpl6
s_add_u32 m0, s46, 0
s_add_u32 s38, s65, 4194304
buffer_load_dwordx4 v1, s[28:31], s38 offen offset:0 sc1 lds
buffer_load_dwordx4 v1, s[28:31], s38 offen offset:1024 sc1 lds
buffer_load_dwordx4 v1, s[28:31], s38 offen offset:2048 sc1 lds
buffer_load_dwordx4 v1, s[28:31], s38 offen offset:3072 sc1 lds
s_add_u32 m0, s46, 16384
s_add_u32 s38, s66, 4194304
buffer_load_dwordx4 v1, s[28:31], s38 offen offset:0 sc1 lds
buffer_load_dwordx4 v1, s[28:31], s38 offen offset:1024 sc1 lds
buffer_load_dwordx4 v1, s[28:31], s38 offen offset:2048 sc1 lds
buffer_load_dwordx4 v1, s[28:31], s38 offen offset:3072 sc1 lds
s_waitcnt vmcnt(4)
s_barrier
ds_read_b128 v[72:75], v1 offset:0
ds_read_b128 v[76:79], v1 offset:1024
ds_read_b128 v[80:83], v1 offset:2048
ds_read_b128 v[84:87], v1 offset:3072
ds_read_b128 v[88:91], v1 offset:4096
ds_read_b128 v[92:95], v1 offset:5120
ds_read_b128 v[96:99], v1 offset:6144
ds_read_b128 v[100:103], v1 offset:7168
s_waitcnt lgkmcnt(4)
v_mfma_f32_32x32x16_bf16 v[40:55], a[0:3], v[72:75], 0
s_add_u32 s38, s92, 10485760
buffer_load_dwordx4 v[224:227], v1, s[28:31], s38 offen offset:0 sc1
ds_read_b128 v[104:107], v1 offset:8192
ds_read_b128 v[108:111], v1 offset:9216
v_mfma_f32_32x32x16_bf16 v[40:55], a[4:7], v[76:79], v[40:55]
buffer_load_dwordx4 v[228:231], v1, s[28:31], s38 offen offset:1024 sc1
ds_read_b128 v[112:115], v1 offset:10240
ds_read_b128 v[116:119], v1 offset:11264
v_mfma_f32_32x32x16_bf16 v[40:55], a[8:11], v[80:83], v[40:55]
ds_read_b128 v[72:75], v1 offset:12288
ds_read_b128 v[76:79], v1 offset:13312
v_mfma_f32_32x32x16_bf16 v[40:55], a[12:15], v[84:87], v[40:55]
buffer_load_dwordx4 v[232:235], v1, s[28:31], s38 offen offset:2048 sc1
ds_read_b128 v[80:83], v1 offset:14336
s_waitcnt lgkmcnt(7)
v_mfma_f32_32x32x16_bf16 v[40:55], a[16:19], v[88:91], v[40:55]
ds_read_b128 v[84:87], v1 offset:15360
v_mfma_f32_32x32x16_bf16 v[40:55], a[20:23], v[92:95], v[40:55]
buffer_load_dwordx4 v[236:239], v1, s[28:31], s38 offen offset:3072 sc1
s_add_u32 m0, s46, 32768
s_add_u32 s38, s65, 4227072
v_mfma_f32_32x32x16_bf16 v[40:55], a[24:27], v[96:99], v[40:55]
buffer_load_dwordx4 v1, s[28:31], s38 offen offset:0 sc1 lds
v_mfma_f32_32x32x16_bf16 v[40:55], a[28:31], v[100:103], v[40:55]
s_waitcnt vmcnt(5)
s_barrier
ds_read_b128 v[88:91], v1 offset:16384
s_waitcnt lgkmcnt(5)
v_mfma_f32_32x32x16_bf16 v[40:55], a[32:35], v[104:107], v[40:55]
buffer_load_dwordx4 v1, s[28:31], s38 offen offset:1024 sc1 lds
ds_read_b128 v[92:95], v1 offset:17408
ds_read_b128 v[96:99], v1 offset:18432
v_mfma_f32_32x32x16_bf16 v[40:55], a[36:39], v[108:111], v[40:55]
ds_read_b64_tr_b16 a[112:113], v213 offset:0
ds_read_b128 v[100:103], v1 offset:19456
v_mfma_f32_32x32x16_bf16 v[40:55], a[40:43], v[112:115], v[40:55]
Lpage3:
s_cbranch_execz Ltour0
buffer_load_dwordx4 v1, s[28:31], s38 offen offset:2048 sc1 lds
ds_read_b64_tr_b16 a[114:115], v213 offset:512
ds_read_b128 v[104:107], v1 offset:20480
s_waitcnt vmcnt(5)
v_add_f32 v224, v224, v228
v_mfma_f32_32x32x16_bf16 v[40:55], a[44:47], v[116:119], v[40:55]
buffer_load_dwordx4 v1, s[28:31], s38 offen offset:3072 sc1 lds
s_add_u32 m0, s46, 131072
s_xor_b32 s95, s87, 1
s_waitcnt lgkmcnt(7)
v_mfma_f32_32x32x16_bf16 v[40:55], a[48:51], v[72:75], v[40:55]
s_mul_i32 s95, s95, 229376
s_add_u32 s95, s95, 128
ds_read_b64_tr_b16 a[116:117], v213 offset:1024
ds_read_b128 v[108:111], v1 offset:21504
v_add_f32 v225, v225, v229
v_mfma_f32_32x32x16_bf16 v[40:55], a[52:55], v[76:79], v[40:55]
buffer_load_dwordx4 v36, s[16:19], s95 offen offset:0 lds
v_add_f32 v226, v226, v230
ds_read_b64_tr_b16 a[118:119], v213 offset:1536
ds_read_b128 v[112:115], v1 offset:22528
v_mfma_f32_32x32x16_bf16 v[40:55], a[56:59], v[80:83], v[40:55]
v_add_f32 v227, v227, v231
s_waitcnt vmcnt(5)
v_add_f32 v232, v232, v236
v_add_f32 v233, v233, v237
ds_read_b128 v[116:119], v1 offset:23552
v_add_f32 v234, v234, v238
v_mfma_f32_32x32x16_bf16 v[40:55], a[60:63], v[84:87], v[40:55]
buffer_load_dwordx4 v252, s[16:19], s95 offen offset:1024 lds
ds_read_b64_tr_b16 a[120:121], v213 offset:2048
v_add_f32 v235, v235, v239
s_waitcnt lgkmcnt(8)
v_mfma_f32_32x32x16_bf16 v[40:55], a[64:67], v[88:91], v[40:55]
v_add_f32 v224, v224, v232
ds_read_b128 v[72:75], v1 offset:24576
v_add_f32 v225, v225, v233
v_add_f32 v226, v226, v234
ds_read_b64_tr_b16 a[122:123], v213 offset:2560
v_mfma_f32_32x32x16_bf16 v[40:55], a[68:71], v[92:95], v[40:55]
buffer_load_dwordx4 v253, s[16:19], s95 offen offset:2048 lds
ds_read_b64_tr_b16 a[124:125], v213 offset:3072
ds_read_b64_tr_b16 a[126:127], v213 offset:3584
v_add_f32 v227, v227, v235
v_permlane16_swap_b32 v224, v226
v_mfma_f32_32x32x16_bf16 v[40:55], a[72:75], v[96:99], v[40:55]
buffer_load_dwordx4 v254, s[16:19], s95 offen offset:3072 lds
s_add_u32 m0, s46, 49152
s_add_u32 s38, s66, 4227072
ds_read_b128 v[76:79], v1 offset:25600
v_permlane16_swap_b32 v225, v227
v_mfma_f32_32x32x16_bf16 v[40:55], a[76:79], v[100:103], v[40:55]
v_add_f32 v224, v224, v226
v_add_f32 v225, v225, v227
ds_read_b128 v[80:83], v1 offset:26624
s_nop 0
v_permlane32_swap_b32 v224, v225
v_add_f32 v224, v224, v225
v_mov_b32 v225, v224
s_waitcnt lgkmcnt(13)
v_mfma_f32_16x16x32_bf16 v[216:219], v[220:223], a[112:115], v[216:219]
buffer_load_dwordx4 v1, s[28:31], s38 offen offset:0 sc1 lds
ds_read_b128 v[84:87], v1 offset:27648
s_waitcnt lgkmcnt(10)
v_mfma_f32_16x16x32_bf16 v[216:219], v[220:223], a[116:119], v[216:219]
v_permlane32_swap_b32 v224, v225
v_mul_f32 v224, 0xbb000000, v224
v_mul_f32 v225, 0x3b000000, v225
s_waitcnt lgkmcnt(5)
v_mfma_f32_16x16x32_bf16 v[216:219], v[220:223], a[120:123], v[216:219]
buffer_load_dwordx4 v1, s[28:31], s38 offen offset:1024 sc1 lds
ds_read_b128 v[88:91], v1 offset:28672
s_waitcnt lgkmcnt(4)
v_mfma_f32_16x16x32_bf16 v[216:219], v[220:223], a[124:127], v[216:219]
buffer_load_dwordx4 v1, s[28:31], s38 offen offset:2048 sc1 lds
v_mfma_f32_32x32x16_bf16 v[40:55], a[80:83], v[104:107], v[40:55]
v_fma_f32 v225, -v224, v224, v225
v_max_f32 v225, 0, v225
v_cvt_pk_bf16_f32 v225, v225, v225
ds_read_b128 v[92:95], v1 offset:29696
v_and_b32 v225, 0xffff0000, v225
v_add_f32 v225, 0x3727c5ac, v225
v_mfma_f32_32x32x16_bf16 v[40:55], a[84:87], v[108:111], v[40:55]
v_cvt_pk_bf16_f32 v225, v225, v225
v_and_b32 v225, 0xffff0000, v225
v_sqrt_f32 v226, v225
v_cvt_pk_bf16_f32 v224, v224, v224
v_and_b32 v224, 0xffff0000, v224
v_cvt_pk_bf16_f32 v226, v226, v226
v_and_b32 v226, 0xffff0000, v226
buffer_load_dwordx4 v1, s[28:31], s38 offen offset:3072 sc1 lds
v_rcp_f32 v225, v226
s_nop 0
v_mul_f32 v227, 0xbfb8aa3b, v225
v_cvt_pk_bf16_f32 v224, v224, v224
v_mov_b32 v225, v224
v_and_b32 v228, 15, v0
v_lshlrev_b32 v228, 5, v228
v_bfe_u32 v229, v0, 4, 1
v_lshl_add_u32 v228, v229, 4, v228
s_lshl_b32 s88, s36, 9
s_add_u32 s88, s88, 159744
v_add_u32 v228, s88, v228
ds_write_b128 v228, v[224:227]
v_mfma_f32_32x32x16_bf16 v[40:55], a[88:91], v[112:115], v[40:55]
ds_read_b128 v[96:99], v1 offset:30720
s_add_u32 m0, s46, 98304
s_xor_b32 s95, s87, 2
s_mul_i32 s95, s95, 229376
s_add_u32 s95, s95, 128
v_mfma_f32_32x32x16_bf16 v[40:55], a[92:95], v[116:119], v[40:55]
s_waitcnt vmcnt(8) lgkmcnt(1)
s_barrier
ds_read_b128 v[100:103], v1 offset:31744
v_mfma_f32_32x32x16_bf16 v[40:55], a[96:99], v[72:75], v[40:55]
buffer_load_dwordx4 v36, s[16:19], s95 offen offset:0 lds
ds_read_b128 v[104:107], v1 offset:32768
ds_read_b128 v[108:111], v1 offset:33792
v_cvt_pk_bf16_f32 v217, v216, v216
v_mfma_f32_32x32x16_bf16 v[40:55], a[100:103], v[76:79], v[40:55]
buffer_load_dwordx4 v252, s[16:19], s95 offen offset:1024 lds
ds_read_b128 v[112:115], v1 offset:34816
v_and_b32 v218, 0xffff0000, v217
ds_read_b64_tr_b16 a[128:129], v213 offset:16384
v_mfma_f32_32x32x16_bf16 v[40:55], a[104:107], v[80:83], v[40:55]
v_sub_f32 v216, v216, v218
ds_read_b128 v[116:119], v1 offset:35840
v_cvt_pk_bf16_f32 v218, v216, v216
v_and_b32 v127, 7, v0
v_and_b32 v219, 0xffff0000, v218
v_mfma_f32_32x32x16_bf16 v[40:55], a[108:111], v[84:87], v[40:55]
buffer_load_dwordx4 v253, s[16:19], s95 offen offset:2048 lds
ds_read_b128 v[72:75], v1 offset:36864
v_sub_f32 v216, v216, v219
s_waitcnt lgkmcnt(6)
v_mfma_f32_32x32x16_bf16 v[40:55], a[112:115], v[88:91], v[40:55]
ds_read_b128 v[240:243], v125 offset:0
ds_read_b64_tr_b16 a[130:131], v213 offset:16896
v_and_b32 v217, 0xffff, v217
v_lshlrev_b32 v127, 7, v127
v_or_b32 v218, v219, v217
v_mfma_f32_32x32x16_bf16 v[40:55], a[116:119], v[92:95], v[40:55]
buffer_load_dwordx4 v254, s[16:19], s95 offen offset:3072 lds
v_cvt_pk_bf16_f32 v219, v216, 0
v_lshlrev_b32 v217, 3, v0
s_lshl_b32 s90, s36, 9
s_add_u32 s90, s90, 161792
v_add_u32 v217, s90, v217
s_mov_b64 exec, 0xffffffff
ds_write_b64 v217, v[218:219]
s_mov_b64 exec, -1
v_mov_b32 v120, 0
v_mov_b32 v121, 0
s_mov_b64 exec, 0xffffffff
ds_read_b64 v[120:121], v206 offset:0
s_mov_b64 exec, -1
v_mfma_f32_32x32x16_bf16 v[40:55], a[120:123], v[96:99], v[40:55]
s_add_u32 m0, s46, 65536
s_add_u32 s38, s65, 4259840
buffer_load_dwordx4 v1, s[28:31], s38 offen offset:0 sc1 lds
v_and_b32 v34, 8, v0
v_lshl_add_u32 v127, v34, 9, v127
v_mfma_f32_32x32x16_bf16 v[40:55], a[124:127], v[100:103], v[40:55]
ds_read_b128 v[76:79], v1 offset:37888
ds_read_b128 v[80:83], v1 offset:38912
ds_read_b64_tr_b16 a[132:133], v213 offset:17408
s_waitcnt lgkmcnt(3)
v_mfma_f32_32x32x8_bf16 v[40:55], v[120:121], v[240:241], v[40:55]
buffer_load_dwordx4 v1, s[28:31], s38 offen offset:1024 sc1 lds
ds_read_b128 v[84:87], v1 offset:39936
ds_read_b64_tr_b16 a[134:135], v213 offset:17920
v_mfma_f32_32x32x16_bf16 v[56:71], a[0:3], v[104:107], 0
ds_read_b128 v[88:91], v1 offset:40960
ds_read_b128 v[92:95], v1 offset:41984
v_mfma_f32_32x32x16_bf16 v[56:71], a[4:7], v[108:111], v[56:71]
buffer_load_dwordx4 v1, s[28:31], s38 offen offset:2048 sc1 lds
ds_read_b64_tr_b16 a[136:137], v213 offset:18432
ds_read_b128 v[96:99], v1 offset:43008
v_mfma_f32_32x32x16_bf16 v[56:71], a[8:11], v[112:115], v[56:71]
buffer_load_dwordx4 v1, s[28:31], s38 offen offset:3072 sc1 lds
ds_read_b64_tr_b16 a[138:139], v213 offset:18944
ds_read_b128 v[100:103], v1 offset:44032
v_mfma_f32_32x32x16_bf16 v[56:71], a[12:15], v[116:119], v[56:71]
ds_read_b128 v[104:107], v1 offset:45056
ds_read_b64_tr_b16 a[140:141], v213 offset:19456
ds_read_b128 v[108:111], v1 offset:46080
v_mul_f32 v40, v243, v40
s_waitcnt lgkmcnt(10)
v_mfma_f32_32x32x16_bf16 v[56:71], a[16:19], v[72:75], v[56:71]
ds_read_b128 v[112:115], v1 offset:47104
ds_read_b64_tr_b16 a[142:143], v213 offset:19968
v_mul_f32 v41, v243, v41
v_exp_f32 v40, v40
v_mfma_f32_32x32x16_bf16 v[56:71], a[20:23], v[76:79], v[56:71]
ds_read_b128 v[116:119], v1 offset:48128
s_lshr_b32 s88, s36, 1
v_mul_f32 v42, v243, v42
v_exp_f32 v41, v41
v_mfma_f32_32x32x16_bf16 v[56:71], a[24:27], v[80:83], v[56:71]
s_add_u32 m0, s46, 114688
s_xor_b32 s95, s87, 3
s_mul_i32 s95, s95, 229376
s_add_u32 s95, s95, 128
v_mul_f32 v43, v243, v43
v_mfma_f32_32x32x16_bf16 v[56:71], a[28:31], v[84:87], v[56:71]
s_waitcnt vmcnt(8) lgkmcnt(1)
s_barrier
s_lshl_b32 s89, s88, 13
v_mfma_f32_32x32x16_bf16 v[56:71], a[32:35], v[88:91], v[56:71]
buffer_load_dwordx4 v36, s[16:19], s95 offen offset:0 lds
v_exp_f32 v42, v42
v_mul_f32 v48, v243, v48
v_mfma_f32_32x32x16_bf16 v[56:71], a[36:39], v[92:95], v[56:71]
buffer_load_dwordx4 v252, s[16:19], s95 offen offset:1024 lds
v_exp_f32 v43, v43
v_add_u32 v200, s89, v11
v_mfma_f32_32x32x16_bf16 v[56:71], a[40:43], v[96:99], v[56:71]
ds_read_b128 v[72:75], v1 offset:49152
ds_read_b128 v[76:79], v1 offset:50176
v_mul_f32 v49, v243, v49
v_exp_f32 v48, v48
v_mfma_f32_32x32x16_bf16 v[56:71], a[44:47], v[100:103], v[56:71]
buffer_load_dwordx4 v253, s[16:19], s95 offen offset:2048 lds
ds_read_b128 v[80:83], v1 offset:51200
ds_read_b64_tr_b16 a[144:145], v213 offset:32768
v_add_u32 v201, s89, v12
s_waitcnt lgkmcnt(4)
v_mfma_f32_32x32x16_bf16 v[56:71], a[48:51], v[104:107], v[56:71]
ds_read_b128 v[84:87], v1 offset:52224
v_mul_f32 v50, v243, v50
v_exp_f32 v49, v49
ds_read_b128 v[88:91], v1 offset:53248
v_mfma_f32_32x32x16_bf16 v[56:71], a[52:55], v[108:111], v[56:71]
buffer_load_dwordx4 v254, s[16:19], s95 offen offset:3072 lds
s_add_u32 m0, s46, 81920
s_add_u32 s38, s66, 4259840
v_mul_f32 v51, v243, v51
v_add_u32 v202, 65536, v200
v_mfma_f32_32x32x16_bf16 v[56:71], a[56:59], v[112:115], v[56:71]
buffer_load_dwordx4 v1, s[28:31], s38 offen offset:0 sc1 lds
ds_read_b64_tr_b16 a[146:147], v213 offset:33280
v_exp_f32 v50, v50
ds_read_b128 v[92:95], v1 offset:54272
v_mfma_f32_32x32x16_bf16 v[56:71], a[60:63], v[116:119], v[56:71]
v_exp_f32 v51, v51
v_add_u32 v203, 65536, v201
v_fma_f32 v40, v40, v242, v242
v_fma_f32 v41, v41, v242, v242
s_waitcnt lgkmcnt(3)
v_mfma_f32_32x32x16_bf16 v[56:71], a[64:67], v[72:75], v[56:71]
buffer_load_dwordx4 v1, s[28:31], s38 offen offset:1024 sc1 lds
ds_read_b64_tr_b16 a[148:149], v213 offset:33792
ds_read_b128 v[96:99], v1 offset:55296
v_fma_f32 v42, v42, v242, v242
v_add_u32 v204, 131072, v200
v_mfma_f32_32x32x16_bf16 v[56:71], a[68:71], v[76:79], v[56:71]
ds_read_b128 v[100:103], v1 offset:56320
v_fma_f32 v43, v43, v242, v242
v_fma_f32 v48, v48, v242, v242
ds_read_b64_tr_b16 a[150:151], v213 offset:34304
v_fma_f32 v49, v49, v242, v242
v_add_u32 v205, 131072, v201
v_mfma_f32_32x32x16_bf16 v[56:71], a[72:75], v[80:83], v[56:71]
buffer_load_dwordx4 v1, s[28:31], s38 offen offset:2048 sc1 lds
ds_read_b128 v[104:107], v1 offset:57344
v_fma_f32 v50, v50, v242, v242
v_fma_f32 v51, v51, v242, v242
s_mul_i32 s88, s88, 57344
v_mfma_f32_32x32x16_bf16 v[56:71], a[76:79], v[84:87], v[56:71]
buffer_load_dwordx4 v1, s[28:31], s38 offen offset:3072 sc1 lds
ds_read_b128 v[108:111], v1 offset:58368
v_rcp_f32 v40, v40
s_waitcnt lgkmcnt(3)
v_mfma_f32_32x32x16_bf16 v[56:71], a[80:83], v[88:91], v[56:71]
s_mul_i32 s79, s57, 114688
s_add_u32 s79, s79, s88
s_add_u32 s79, s79, 16777216
s_add_u32 s80, s79, 4096
ds_read_b64_tr_b16 a[152:153], v213 offset:34816
ds_read_b128 v[112:115], v1 offset:59392
v_mfma_f32_32x32x16_bf16 v[56:71], a[84:87], v[92:95], v[56:71]
ds_read_b64_tr_b16 a[154:155], v213 offset:35328
ds_read_b128 v[116:119], v1 offset:60416
ds_read_b64_tr_b16 a[156:157], v213 offset:35840
ds_read_b64_tr_b16 a[158:159], v213 offset:36352
v_rcp_f32 v41, v41
v_mfma_f32_32x32x16_bf16 v[56:71], a[88:91], v[96:99], v[56:71]
v_mul_f32 v40, v40, v44
v_rcp_f32 v42, v42
v_mul_f32 v41, v41, v45
v_rcp_f32 v43, v43
v_mfma_f32_32x32x16_bf16 v[56:71], a[92:95], v[100:103], v[56:71]
s_waitcnt vmcnt(8) lgkmcnt(0)
s_barrier
v_mul_f32 v42, v42, v46
ds_read_b128 v[72:75], v1 offset:61440
v_mfma_f32_32x32x16_bf16 v[56:71], a[96:99], v[104:107], v[56:71]
v_rcp_f32 v48, v48
v_mul_f32 v43, v43, v47
s_add_u32 m0, s46, 131072
s_xor_b32 s95, s87, 4
s_mul_i32 s95, s95, 229376
s_add_u32 s95, s95, 128
v_rcp_f32 v49, v49
v_mul_f32 v48, v48, v52
v_rcp_f32 v50, v50
v_mul_f32 v49, v49, v53
v_rcp_f32 v51, v51
buffer_load_dwordx4 v36, s[16:19], s95 offen offset:0 lds
v_mul_f32 v50, v50, v54
s_add_u32 s94, s76, 0
v_mul_f32 v51, v51, v55
v_cvt_pk_bf16_f32 v192, v40, v41
v_cvt_pk_bf16_f32 v193, v42, v43
v_cvt_pk_bf16_f32 v194, v48, v49
v_cvt_pk_bf16_f32 v195, v50, v51
s_cmp_lg_u32 s37, 0
s_cbranch_scc1 Lalt6_b
buffer_store_dwordx4 v[192:195], v1, s[28:31], s94 offen
Lalt6_e:
v_mfma_f32_32x32x16_bf16 v[56:71], a[100:103], v[108:111], v[56:71]
ds_read_b128 v[76:79], v1 offset:62464
ds_read_b128 v[80:83], v1 offset:63488
ds_read_b128 v[84:87], v1 offset:64512
buffer_load_dwordx4 v252, s[16:19], s95 offen offset:1024 lds
v_mfma_f32_32x32x16_bf16 v[56:71], a[104:107], v[112:115], v[56:71]
ds_read_b128 v[88:91], v124 offset:0
v_mfma_f32_32x32x16_bf16 v[56:71], a[108:111], v[116:119], v[56:71]
buffer_load_dwordx4 v253, s[16:19], s95 offen offset:2048 lds
ds_read_b128 v[92:95], v124 offset:1024
ds_read_b128 v[96:99], v124 offset:2048
ds_read_b64_tr_b16 a[160:161], v213 offset:0
s_waitcnt lgkmcnt(4)
v_mfma_f32_32x32x16_bf16 v[56:71], a[112:115], v[72:75], v[56:71]
ds_read_b128 v[244:247], v125 offset:512
ds_read_b128 v[100:103], v124 offset:3072
v_mfma_f32_32x32x16_bf16 v[56:71], a[116:119], v[76:79], v[56:71]
buffer_load_dwordx4 v254, s[16:19], s95 offen offset:3072 lds
s_add_u32 m0, s46, 0
s_add_u32 s38, s65, 4292608
ds_read_b128 v[104:107], v124 offset:4096
ds_read_b64_tr_b16 a[162:163], v213 offset:512
v_mfma_f32_32x32x16_bf16 v[56:71], a[120:123], v[80:83], v[56:71]
buffer_load_dwordx4 v1, s[28:31], s38 offen offset:0 sc1 lds
ds_read_b128 v[108:111], v124 offset:5120
ds_read_b128 v[112:115], v124 offset:6144
v_mfma_f32_32x32x16_bf16 v[56:71], a[124:127], v[84:87], v[56:71]
ds_read_b64_tr_b16 a[164:165], v213 offset:1024
ds_read_b128 v[116:119], v124 offset:7168
s_waitcnt lgkmcnt(7)
v_mfma_f32_32x32x8_bf16 v[56:71], v[120:121], v[244:245], v[56:71]
buffer_load_dwordx4 v1, s[28:31], s38 offen offset:1024 sc1 lds
ds_read_b64_tr_b16 a[166:167], v213 offset:1536
ds_read_b128 v[72:75], v124 offset:8192
s_waitcnt lgkmcnt(8)
v_mfma_f32_32x32x16_bf16 v[40:55], a[0:3], v[88:91], 0
ds_read_b128 v[76:79], v124 offset:9216
ds_read_b64_tr_b16 a[168:169], v213 offset:2048
ds_read_b128 v[80:83], v124 offset:10240
v_mfma_f32_32x32x16_bf16 v[40:55], a[4:7], v[92:95], v[40:55]
buffer_load_dwordx4 v1, s[28:31], s38 offen offset:2048 sc1 lds
ds_read_b64_tr_b16 a[170:171], v213 offset:2560
ds_read_b128 v[84:87], v124 offset:11264
v_mfma_f32_32x32x16_bf16 v[40:55], a[8:11], v[96:99], v[40:55]
buffer_load_dwordx4 v1, s[28:31], s38 offen offset:3072 sc1 lds
ds_read_b128 v[88:91], v124 offset:12288
ds_read_b64_tr_b16 a[172:173], v213 offset:3072
v_mfma_f32_32x32x16_bf16 v[40:55], a[12:15], v[100:103], v[40:55]
ds_read_b128 v[92:95], v124 offset:13312
ds_read_b128 v[96:99], v124 offset:14336
v_mul_f32 v56, v247, v56
s_waitcnt lgkmcnt(11)
v_mfma_f32_32x32x16_bf16 v[40:55], a[16:19], v[104:107], v[40:55]
ds_read_b64_tr_b16 a[174:175], v213 offset:3584
v_mul_f32 v57, v247, v57
ds_read_b128 v[100:103], v124 offset:15360
v_exp_f32 v56, v56
v_mfma_f32_32x32x16_bf16 v[40:55], a[20:23], v[108:111], v[40:55]
v_mul_f32 v58, v247, v58
v_exp_f32 v57, v57
v_mul_f32 v59, v247, v59
v_mfma_f32_32x32x16_bf16 v[40:55], a[24:27], v[112:115], v[40:55]
s_add_u32 m0, s46, 98304
s_xor_b32 s95, s87, 5
s_mul_i32 s95, s95, 229376
s_add_u32 s95, s95, 128
v_mfma_f32_32x32x16_bf16 v[40:55], a[28:31], v[116:119], v[40:55]
s_waitcnt vmcnt(9) lgkmcnt(1)
s_barrier
ds_read_b128 v[104:107], v124 offset:16384
v_mfma_f32_32x32x16_bf16 v[40:55], a[32:35], v[72:75], v[40:55]
buffer_load_dwordx4 v36, s[16:19], s95 offen offset:0 lds
v_exp_f32 v58, v58
v_mul_f32 v64, v247, v64
v_mfma_f32_32x32x16_bf16 v[40:55], a[36:39], v[76:79], v[40:55]
buffer_load_dwordx4 v252, s[16:19], s95 offen offset:1024 lds
v_exp_f32 v59, v59
ds_read_b128 v[108:111], v124 offset:17408
v_mfma_f32_32x32x16_bf16 v[40:55], a[40:43], v[80:83], v[40:55]
ds_read_b128 v[112:115], v124 offset:18432
v_mul_f32 v65, v247, v65
ds_read_b64_tr_b16 a[176:177], v213 offset:16384
v_exp_f32 v64, v64
v_mfma_f32_32x32x16_bf16 v[40:55], a[44:47], v[84:87], v[40:55]
buffer_load_dwordx4 v253, s[16:19], s95 offen offset:2048 lds
ds_read_b128 v[116:119], v124 offset:19456
v_mul_f32 v66, v247, v66
s_waitcnt lgkmcnt(5)
v_mfma_f32_32x32x16_bf16 v[40:55], a[48:51], v[88:91], v[40:55]
v_exp_f32 v65, v65
ds_read_b128 v[72:75], v124 offset:20480
v_mul_f32 v67, v247, v67
ds_read_b64_tr_b16 a[178:179], v213 offset:16896
v_mfma_f32_32x32x16_bf16 v[40:55], a[52:55], v[92:95], v[40:55]
buffer_load_dwordx4 v254, s[16:19], s95 offen offset:3072 lds
s_add_u32 m0, s46, 16384
s_add_u32 s38, s66, 4292608
v_exp_f32 v66, v66
v_mfma_f32_32x32x16_bf16 v[40:55], a[56:59], v[96:99], v[40:55]
buffer_load_dwordx4 v1, s[28:31], s38 offen offset:0 sc1 lds
v_exp_f32 v67, v67
ds_read_b128 v[76:79], v124 offset:21504
v_fma_f32 v56, v56, v246, v246
v_mfma_f32_32x32x16_bf16 v[40:55], a[60:63], v[100:103], v[40:55]
v_fma_f32 v57, v57, v246, v246
ds_read_b64_tr_b16 a[180:181], v213 offset:17408
ds_read_b128 v[80:83], v124 offset:22528
v_fma_f32 v58, v58, v246, v246
v_fma_f32 v59, v59, v246, v246
s_waitcnt lgkmcnt(5)
v_mfma_f32_32x32x16_bf16 v[40:55], a[64:67], v[104:107], v[40:55]
buffer_load_dwordx4 v1, s[28:31], s38 offen offset:1024 sc1 lds
ds_read_b128 v[84:87], v124 offset:23552
v_fma_f32 v64, v64, v246, v246
ds_read_b64_tr_b16 a[182:183], v213 offset:17920
v_fma_f32 v65, v65, v246, v246
v_mfma_f32_32x32x16_bf16 v[40:55], a[68:71], v[108:111], v[40:55]
ds_read_b128 v[88:91], v124 offset:24576
v_fma_f32 v66, v66, v246, v246
v_fma_f32 v67, v67, v246, v246
ds_read_b128 v[92:95], v124 offset:25600
v_mfma_f32_32x32x16_bf16 v[40:55], a[72:75], v[112:115], v[40:55]
buffer_load_dwordx4 v1, s[28:31], s38 offen offset:2048 sc1 lds
v_rcp_f32 v56, v56
ds_read_b64_tr_b16 a[184:185], v213 offset:18432
v_mfma_f32_32x32x16_bf16 v[40:55], a[76:79], v[116:119], v[40:55]
buffer_load_dwordx4 v1, s[28:31], s38 offen offset:3072 sc1 lds
v_rcp_f32 v57, v57
v_mul_f32 v56, v56, v60
s_waitcnt lgkmcnt(4)
v_mfma_f32_32x32x16_bf16 v[40:55], a[80:83], v[72:75], v[40:55]
ds_read_b128 v[96:99], v124 offset:26624
v_rcp_f32 v58, v58
v_mul_f32 v57, v57, v61
ds_read_b64_tr_b16 a[186:187], v213 offset:18944
ds_read_b128 v[100:103], v124 offset:27648
v_mfma_f32_32x32x16_bf16 v[40:55], a[84:87], v[76:79], v[40:55]
ds_read_b64_tr_b16 a[188:189], v213 offset:19456
ds_read_b64_tr_b16 a[190:191], v213 offset:19968
v_rcp_f32 v59, v59
v_mul_f32 v58, v58, v62
ds_read_b128 v[104:107], v124 offset:28672
v_mfma_f32_32x32x16_bf16 v[40:55], a[88:91], v[80:83], v[40:55]
v_rcp_f32 v64, v64
v_mul_f32 v59, v59, v63
s_add_u32 m0, s46, 114688
s_xor_b32 s95, s87, 6
ds_read_b128 v[108:111], v124 offset:29696
v_mfma_f32_32x32x16_bf16 v[40:55], a[92:95], v[84:87], v[40:55]
s_waitcnt vmcnt(8) lgkmcnt(2)
s_barrier
s_mul_i32 s95, s95, 229376
ds_read_b128 v[112:115], v124 offset:30720
v_mfma_f32_32x32x16_bf16 v[40:55], a[96:99], v[88:91], v[40:55]
s_add_u32 s95, s95, 128
v_rcp_f32 v65, v65
v_mul_f32 v64, v64, v68
v_rcp_f32 v66, v66
v_mul_f32 v65, v65, v69
v_rcp_f32 v67, v67
buffer_load_dwordx4 v36, s[16:19], s95 offen offset:0 lds
v_mul_f32 v66, v66, v70
s_add_u32 s94, s76, 114688
v_mul_f32 v67, v67, v71
v_cvt_pk_bf16_f32 v196, v56, v57
v_cvt_pk_bf16_f32 v197, v58, v59
v_cvt_pk_bf16_f32 v198, v64, v65
v_cvt_pk_bf16_f32 v199, v66, v67
s_cmp_lg_u32 s37, 0
s_cbranch_scc1 Lalt7_b
buffer_store_dwordx4 v[196:199], v1, s[28:31], s94 offen
Lalt7_e:
v_mfma_f32_32x32x16_bf16 v[40:55], a[100:103], v[92:95], v[40:55]
ds_read_b128 v[116:119], v124 offset:31744
buffer_load_dwordx4 v252, s[16:19], s95 offen offset:1024 lds
ds_read_b128 v[72:75], v1 offset:0
v_mfma_f32_32x32x16_bf16 v[40:55], a[104:107], v[96:99], v[40:55]
ds_read_b128 v[76:79], v1 offset:1024
ds_read_b128 v[80:83], v1 offset:2048
v_mfma_f32_32x32x16_bf16 v[40:55], a[108:111], v[100:103], v[40:55]
buffer_load_dwordx4 v253, s[16:19], s95 offen offset:2048 lds
ds_read_b64_tr_b16 a[192:193], v213 offset:32768
ds_read_b128 v[84:87], v1 offset:3072
s_waitcnt lgkmcnt(5)
v_mfma_f32_32x32x16_bf16 v[40:55], a[112:115], v[104:107], v[40:55]
ds_read_b128 v[240:243], v125 offset:1024
ds_read_b128 v[88:91], v1 offset:4096
v_mfma_f32_32x32x16_bf16 v[40:55], a[116:119], v[108:111], v[40:55]
buffer_load_dwordx4 v254, s[16:19], s95 offen offset:3072 lds
ds_read_b64_tr_b16 a[194:195], v213 offset:33280
ds_read_b128 v[92:95], v1 offset:5120
v_mfma_f32_32x32x16_bf16 v[40:55], a[120:123], v[112:115], v[40:55]
ds_read_b128 v[96:99], v1 offset:6144
ds_read_b64_tr_b16 a[196:197], v213 offset:33792
ds_read_b128 v[100:103], v1 offset:7168
v_mfma_f32_32x32x16_bf16 v[40:55], a[124:127], v[116:119], v[40:55]
ds_read_b64_tr_b16 a[198:199], v213 offset:34304
ds_read_b128 v[104:107], v1 offset:8192
s_waitcnt lgkmcnt(8)
v_mfma_f32_32x32x8_bf16 v[40:55], v[120:121], v[240:241], v[40:55]
ds_read_b128 v[108:111], v1 offset:9216
ds_read_b64_tr_b16 a[200:201], v213 offset:34816
ds_read_b128 v[112:115], v1 offset:10240
v_mfma_f32_32x32x16_bf16 v[56:71], a[0:3], v[72:75], 0
ds_read_b64_tr_b16 a[202:203], v213 offset:35328
ds_read_b128 v[116:119], v1 offset:11264
v_mfma_f32_32x32x16_bf16 v[56:71], a[4:7], v[76:79], v[56:71]
ds_read_b128 v[72:75], v1 offset:12288
ds_read_b64_tr_b16 a[204:205], v213 offset:35840
ds_read_b64_tr_b16 a[206:207], v213 offset:36352
v_mfma_f32_32x32x16_bf16 v[56:71], a[8:11], v[80:83], v[56:71]
ds_read_b128 v[76:79], v1 offset:13312
v_mfma_f32_32x32x16_bf16 v[56:71], a[12:15], v[84:87], v[56:71]
ds_read_b128 v[80:83], v1 offset:14336
v_mul_f32 v40, v243, v40
s_waitcnt lgkmcnt(12)
v_mfma_f32_32x32x16_bf16 v[56:71], a[16:19], v[88:91], v[56:71]
v_mul_f32 v41, v243, v41
ds_read_b128 v[84:87], v1 offset:15360
v_exp_f32 v40, v40
v_mul_f32 v42, v243, v42
v_mfma_f32_32x32x16_bf16 v[56:71], a[20:23], v[92:95], v[56:71]
v_exp_f32 v41, v41
v_mul_f32 v43, v243, v43
v_mfma_f32_32x32x16_bf16 v[56:71], a[24:27], v[96:99], v[56:71]
s_add_u32 m0, s46, 131072
s_xor_b32 s95, s87, 7
s_mul_i32 s95, s95, 229376
s_add_u32 s95, s95, 128
v_mfma_f32_32x32x16_bf16 v[56:71], a[28:31], v[100:103], v[56:71]
s_waitcnt vmcnt(5) lgkmcnt(3)
s_barrier
ds_read_b128 v[88:91], v1 offset:16384
v_mfma_f32_32x32x16_bf16 v[56:71], a[32:35], v[104:107], v[56:71]
buffer_load_dwordx4 v36, s[16:19], s95 offen offset:0 lds
v_exp_f32 v42, v42
v_mul_f32 v48, v243, v48
v_mfma_f32_32x32x16_bf16 v[56:71], a[36:39], v[108:111], v[56:71]
buffer_load_dwordx4 v252, s[16:19], s95 offen offset:1024 lds
v_exp_f32 v43, v43
ds_read_b128 v[92:95], v1 offset:17408
v_mfma_f32_32x32x16_bf16 v[56:71], a[40:43], v[112:115], v[56:71]
ds_read_b128 v[96:99], v1 offset:18432
v_mul_f32 v49, v243, v49
ds_read_b64_tr_b16 a[208:209], v213 offset:0
v_exp_f32 v48, v48
v_mfma_f32_32x32x16_bf16 v[56:71], a[44:47], v[116:119], v[56:71]
buffer_load_dwordx4 v253, s[16:19], s95 offen offset:2048 lds
ds_read_b128 v[100:103], v1 offset:19456
v_mul_f32 v50, v243, v50
s_waitcnt lgkmcnt(5)
v_mfma_f32_32x32x16_bf16 v[56:71], a[48:51], v[72:75], v[56:71]
v_exp_f32 v49, v49
ds_read_b128 v[104:107], v1 offset:20480
v_mul_f32 v51, v243, v51
ds_read_b64_tr_b16 a[210:211], v213 offset:512
v_mfma_f32_32x32x16_bf16 v[56:71], a[52:55], v[76:79], v[56:71]
buffer_load_dwordx4 v254, s[16:19], s95 offen offset:3072 lds
v_exp_f32 v50, v50
v_exp_f32 v51, v51
v_mfma_f32_32x32x16_bf16 v[56:71], a[56:59], v[80:83], v[56:71]
ds_read_b128 v[108:111], v1 offset:21504
v_fma_f32 v40, v40, v242, v242
v_fma_f32 v41, v41, v242, v242
ds_read_b64_tr_b16 a[212:213], v213 offset:1024
ds_read_b128 v[112:115], v1 offset:22528
v_mfma_f32_32x32x16_bf16 v[56:71], a[60:63], v[84:87], v[56:71]
v_fma_f32 v42, v42, v242, v242
v_fma_f32 v43, v43, v242, v242
ds_read_b128 v[116:119], v1 offset:23552
v_fma_f32 v48, v48, v242, v242
s_waitcnt lgkmcnt(6)
v_mfma_f32_32x32x16_bf16 v[56:71], a[64:67], v[88:91], v[56:71]
ds_read_b64_tr_b16 a[214:215], v213 offset:1536
v_fma_f32 v49, v49, v242, v242
ds_read_b128 v[72:75], v1 offset:24576
v_fma_f32 v50, v50, v242, v242
v_fma_f32 v51, v51, v242, v242
v_mfma_f32_32x32x16_bf16 v[56:71], a[68:71], v[92:95], v[56:71]
ds_read_b128 v[76:79], v1 offset:25600
v_rcp_f32 v40, v40
ds_read_b64_tr_b16 a[216:217], v213 offset:2048
ds_read_b128 v[80:83], v1 offset:26624
Lpage4:
s_cbranch_execz Ltour0
v_mfma_f32_32x32x16_bf16 v[56:71], a[72:75], v[96:99], v[56:71]
v_rcp_f32 v41, v41
v_mul_f32 v40, v40, v44
v_rcp_f32 v42, v42
v_mfma_f32_32x32x16_bf16 v[56:71], a[76:79], v[100:103], v[56:71]
v_mul_f32 v41, v41, v45
ds_read_b64_tr_b16 a[218:219], v213 offset:2560
ds_read_b128 v[84:87], v1 offset:27648
s_add_u32 s89, s76, 0
s_waitcnt lgkmcnt(7)
v_mfma_f32_32x32x16_bf16 v[56:71], a[80:83], v[104:107], v[56:71]
buffer_load_dword v34, v127, s[28:31], s89 offen sc1
v_rcp_f32 v43, v43
v_mul_f32 v42, v42, v46
v_mfma_f32_32x32x16_bf16 v[56:71], a[84:87], v[108:111], v[56:71]
ds_read_b64_tr_b16 a[220:221], v213 offset:3072
ds_read_b64_tr_b16 a[222:223], v213 offset:3584
ds_read_b128 v[88:91], v1 offset:28672
v_rcp_f32 v48, v48
v_mul_f32 v43, v43, v47
v_mfma_f32_32x32x16_bf16 v[56:71], a[88:91], v[112:115], v[56:71]
ds_read_b128 v[92:95], v1 offset:29696
v_rcp_f32 v49, v49
v_mul_f32 v48, v48, v52
ds_read_b128 v[96:99], v1 offset:30720
v_mfma_f32_32x32x16_bf16 v[56:71], a[92:95], v[116:119], v[56:71]
s_waitcnt vmcnt(5) lgkmcnt(3)
s_barrier
v_rcp_f32 v50, v50
v_mfma_f32_32x32x16_bf16 v[56:71], a[96:99], v[72:75], v[56:71]
v_mul_f32 v49, v49, v53
v_rcp_f32 v51, v51
v_mul_f32 v50, v50, v54
s_add_u32 s94, s76, 229376
v_mul_f32 v51, v51, v55
v_cvt_pk_bf16_f32 v192, v40, v41
v_cvt_pk_bf16_f32 v193, v42, v43
v_cvt_pk_bf16_f32 v194, v48, v49
v_cvt_pk_bf16_f32 v195, v50, v51
s_cmp_lg_u32 s37, 0
s_cbranch_scc1 Lalt8_b
buffer_store_dwordx4 v[192:195], v1, s[28:31], s94 offen
Lalt8_e:
v_mfma_f32_32x32x16_bf16 v[56:71], a[100:103], v[76:79], v[56:71]
ds_read_b128 v[100:103], v1 offset:31744
ds_read_b128 v[104:107], v1 offset:32768
v_mfma_f32_32x32x16_bf16 v[56:71], a[104:107], v[80:83], v[56:71]
ds_read_b128 v[108:111], v1 offset:33792
ds_read_b128 v[112:115], v1 offset:34816
s_add_u32 s89, s76, 114688
v_mfma_f32_32x32x16_bf16 v[56:71], a[108:111], v[84:87], v[56:71]
ds_read_b64_tr_b16 a[224:225], v213 offset:16384
ds_read_b128 v[116:119], v1 offset:35840
ds_read_b128 v[72:75], v1 offset:36864
s_waitcnt lgkmcnt(6)
v_mfma_f32_32x32x16_bf16 v[56:71], a[112:115], v[88:91], v[56:71]
ds_read_b128 v[244:247], v125 offset:1536
ds_read_b64_tr_b16 a[226:227], v213 offset:16896
buffer_load_dword v34, v127, s[28:31], s89 offen sc1
v_mfma_f32_32x32x16_bf16 v[56:71], a[116:119], v[92:95], v[56:71]
ds_read_b128 v[76:79], v1 offset:37888
ds_read_b128 v[80:83], v1 offset:38912
v_mfma_f32_32x32x16_bf16 v[56:71], a[120:123], v[96:99], v[56:71]
ds_read_b64_tr_b16 a[228:229], v213 offset:17408
ds_read_b128 v[84:87], v1 offset:39936
ds_read_b64_tr_b16 a[230:231], v213 offset:17920
v_mfma_f32_32x32x16_bf16 v[56:71], a[124:127], v[100:103], v[56:71]
ds_read_b128 v[88:91], v1 offset:40960
ds_read_b128 v[92:95], v1 offset:41984
s_waitcnt lgkmcnt(8)
v_mfma_f32_32x32x8_bf16 v[56:71], v[120:121], v[244:245], v[56:71]
ds_read_b64_tr_b16 a[232:233], v213 offset:18432
ds_read_b128 v[96:99], v1 offset:43008
ds_read_b64_tr_b16 a[234:235], v213 offset:18944
v_mfma_f32_32x32x16_bf16 v[40:55], a[128:131], v[104:107], 0
ds_read_b128 v[100:103], v1 offset:44032
ds_read_b64_tr_b16 a[236:237], v213 offset:19456
ds_read_b64_tr_b16 a[238:239], v213 offset:19968
v_mfma_f32_32x32x16_bf16 v[40:55], a[132:135], v[108:111], v[40:55]
ds_read_b128 v[104:107], v1 offset:45056
v_mfma_f32_32x32x16_bf16 v[40:55], a[136:139], v[112:115], v[40:55]
ds_read_b128 v[108:111], v1 offset:46080
v_mfma_f32_32x32x16_bf16 v[40:55], a[140:143], v[116:119], v[40:55]
ds_read_b128 v[112:115], v1 offset:47104
v_mul_f32 v56, v247, v56
s_waitcnt lgkmcnt(12)
v_mfma_f32_32x32x16_bf16 v[40:55], a[144:147], v[72:75], v[40:55]
ds_read_b128 v[116:119], v1 offset:48128
v_mul_f32 v57, v247, v57
s_add_u32 s89, s76, 229376
v_mfma_f32_32x32x16_bf16 v[40:55], a[148:151], v[76:79], v[40:55]
ds_read_b128 v[72:75], v1 offset:49152
v_mfma_f32_32x32x16_bf16 v[40:55], a[152:155], v[80:83], v[40:55]
v_exp_f32 v56, v56
ds_read_b128 v[76:79], v1 offset:50176
buffer_load_dword v34, v127, s[28:31], s89 offen sc1
v_mfma_f32_32x32x16_bf16 v[40:55], a[156:159], v[84:87], v[40:55]
s_waitcnt vmcnt(4) lgkmcnt(6)
s_barrier
v_mul_f32 v58, v247, v58
v_mfma_f32_32x32x16_bf16 v[40:55], a[160:163], v[88:91], v[40:55]
ds_read_b128 v[80:83], v1 offset:51200
ds_read_b64_tr_b16 a[240:241], v213 offset:32768
v_exp_f32 v57, v57
ds_read_b128 v[84:87], v1 offset:52224
v_mfma_f32_32x32x16_bf16 v[40:55], a[164:167], v[92:95], v[40:55]
ds_read_b64_tr_b16 a[242:243], v213 offset:33280
ds_read_b128 v[88:91], v1 offset:53248
v_mul_f32 v59, v247, v59
v_mfma_f32_32x32x16_bf16 v[40:55], a[168:171], v[96:99], v[40:55]
ds_read_b64_tr_b16 a[244:245], v213 offset:33792
ds_read_b128 v[92:95], v1 offset:54272
v_exp_f32 v58, v58
ds_read_b64_tr_b16 a[246:247], v213 offset:34304
v_mfma_f32_32x32x16_bf16 v[40:55], a[172:175], v[100:103], v[40:55]
ds_read_b128 v[96:99], v1 offset:55296
v_mul_f32 v64, v247, v64
ds_read_b64_tr_b16 a[248:249], v213 offset:34816
ds_read_b64_tr_b16 a[250:251], v213 offset:35328
s_waitcnt lgkmcnt(13)
v_mfma_f32_32x32x16_bf16 v[40:55], a[176:179], v[104:107], v[40:55]
ds_read_b128 v[100:103], v1 offset:56320
ds_read_b64_tr_b16 a[252:253], v213 offset:35840
ds_read_b64_tr_b16 a[254:255], v213 offset:36352
v_mfma_f32_32x32x16_bf16 v[40:55], a[180:183], v[108:111], v[40:55]
v_exp_f32 v59, v59
ds_read_b128 v[104:107], v1 offset:57344
v_mfma_f32_32x32x16_bf16 v[40:55], a[184:187], v[112:115], v[40:55]
v_mul_f32 v65, v247, v65
ds_read_b128 v[108:111], v1 offset:58368
s_add_u32 s89, s76, 344064
v_mfma_f32_32x32x16_bf16 v[40:55], a[188:191], v[116:119], v[40:55]
v_exp_f32 v64, v64
ds_read_b128 v[112:115], v1 offset:59392
s_waitcnt lgkmcnt(14)
v_mfma_f32_32x32x16_bf16 v[40:55], a[192:195], v[72:75], v[40:55]
v_mul_f32 v66, v247, v66
ds_read_b128 v[116:119], v1 offset:60416
buffer_load_dword v34, v127, s[28:31], s89 offen sc1
v_mfma_f32_32x32x16_bf16 v[40:55], a[196:199], v[76:79], v[40:55]
ds_read_b128 v[72:75], v1 offset:61440
v_exp_f32 v65, v65
v_mfma_f32_32x32x16_bf16 v[40:55], a[200:203], v[80:83], v[40:55]
ds_read_b128 v[76:79], v1 offset:62464
v_mul_f32 v67, v247, v67
v_mfma_f32_32x32x16_bf16 v[40:55], a[204:207], v[84:87], v[40:55]
s_waitcnt lgkmcnt(6)
s_barrier
s_add_u32 m0, s46, 131072
s_lshl4_add_u32 s38, s69, 0
v_mfma_f32_16x16x32_bf16 v[216:219], v[220:223], a[128:131], 0
buffer_load_dwordx4 v208, s[20:23], s38 offen offset:0 lds
v_mfma_f32_16x16x32_bf16 v[216:219], v[220:223], a[132:135], v[216:219]
ds_read_b128 v[80:83], v1 offset:63488
v_mfma_f32_16x16x32_bf16 v[216:219], v[220:223], a[136:139], v[216:219]
v_exp_f32 v66, v66
v_mfma_f32_16x16x32_bf16 v[216:219], v[220:223], a[140:143], v[216:219]
v_exp_f32 v67, v67
v_mfma_f32_16x16x32_bf16 v[216:219], v[220:223], a[144:147], v[216:219]
buffer_load_dwordx4 v209, s[20:23], s38 offen offset:1024 lds
v_mfma_f32_16x16x32_bf16 v[216:219], v[220:223], a[148:151], v[216:219]
v_fma_f32 v56, v56, v246, v246
v_fma_f32 v57, v57, v246, v246
v_mfma_f32_16x16x32_bf16 v[216:219], v[220:223], a[152:155], v[216:219]
s_add_u32 m0, s46, 131072
s_lshl4_add_u32 s38, s69, 0
v_mfma_f32_16x16x32_bf16 v[216:219], v[220:223], a[156:159], v[216:219]
v_fma_f32 v58, v58, v246, v246
v_fma_f32 v59, v59, v246, v246
v_mfma_f32_16x16x32_bf16 v[216:219], v[220:223], a[160:163], v[216:219]
buffer_load_dwordx4 v210, s[20:23], s38 offen offset:2048 lds
v_mfma_f32_16x16x32_bf16 v[216:219], v[220:223], a[164:167], v[216:219]
v_fma_f32 v64, v64, v246, v246
v_fma_f32 v65, v65, v246, v246
v_mfma_f32_16x16x32_bf16 v[216:219], v[220:223], a[168:171], v[216:219]
v_fma_f32 v66, v66, v246, v246
v_fma_f32 v67, v67, v246, v246
v_mfma_f32_16x16x32_bf16 v[216:219], v[220:223], a[172:175], v[216:219]
buffer_load_dwordx4 v211, s[20:23], s38 offen offset:3072 lds
v_mfma_f32_16x16x32_bf16 v[216:219], v[220:223], a[176:179], v[216:219]
global_load_dword v35, v10, s[100:101]
v_mfma_f32_16x16x32_bf16 v[216:219], v[220:223], a[180:183], v[216:219]
v_rcp_f32 v56, v56
v_mfma_f32_16x16x32_bf16 v[216:219], v[220:223], a[184:187], v[216:219]
s_add_u32 m0, s46, 98304
s_add_u32 s38, s65, 4194304
v_mfma_f32_16x16x32_bf16 v[216:219], v[220:223], a[188:191], v[216:219]
buffer_load_dwordx4 v1, s[28:31], s38 offen offset:0 sc1 lds
v_mfma_f32_16x16x32_bf16 v[216:219], v[220:223], a[192:195], v[216:219]
v_rcp_f32 v57, v57
v_mfma_f32_16x16x32_bf16 v[216:219], v[220:223], a[196:199], v[216:219]
v_mul_f32 v56, v56, v60
v_mfma_f32_16x16x32_bf16 v[216:219], v[220:223], a[200:203], v[216:219]
v_rcp_f32 v58, v58
v_mfma_f32_16x16x32_bf16 v[216:219], v[220:223], a[204:207], v[216:219]
buffer_load_dwordx4 v1, s[28:31], s38 offen offset:1024 sc1 lds
v_mul_f32 v57, v57, v61
v_mfma_f32_16x16x32_bf16 v[216:219], v[220:223], a[208:211], v[216:219]
v_rcp_f32 v59, v59
v_mfma_f32_16x16x32_bf16 v[216:219], v[220:223], a[212:215], v[216:219]
v_mul_f32 v58, v58, v62
v_mfma_f32_16x16x32_bf16 v[216:219], v[220:223], a[216:219], v[216:219]
v_rcp_f32 v64, v64
v_mfma_f32_16x16x32_bf16 v[216:219], v[220:223], a[220:223], v[216:219]
buffer_load_dwordx4 v1, s[28:31], s38 offen offset:2048 sc1 lds
v_mul_f32 v59, v59, v63
v_mfma_f32_16x16x32_bf16 v[216:219], v[220:223], a[224:227], v[216:219]
v_rcp_f32 v65, v65
v_mfma_f32_16x16x32_bf16 v[216:219], v[220:223], a[228:231], v[216:219]
v_mul_f32 v64, v64, v68
v_mfma_f32_16x16x32_bf16 v[216:219], v[220:223], a[232:235], v[216:219]
buffer_load_dwordx4 v1, s[28:31], s38 offen offset:3072 sc1 lds
v_mfma_f32_16x16x32_bf16 v[216:219], v[220:223], a[236:239], v[216:219]
v_rcp_f32 v66, v66
v_mfma_f32_16x16x32_bf16 v[216:219], v[220:223], a[240:243], v[216:219]
v_mul_f32 v65, v65, v69
s_add_u32 m0, s46, 114688
v_mfma_f32_16x16x32_bf16 v[216:219], v[220:223], a[244:247], v[216:219]
v_rcp_f32 v67, v67
v_mfma_f32_16x16x32_bf16 v[216:219], v[220:223], a[248:251], v[216:219]
s_add_u32 s38, s66, 4194304
v_mul_f32 v66, v66, v70
v_mfma_f32_16x16x32_bf16 v[216:219], v[220:223], a[252:255], v[216:219]
buffer_load_dwordx4 v1, s[28:31], s38 offen offset:0 sc1 lds
v_mfma_f32_32x32x16_bf16 v[40:55], a[208:211], v[88:91], v[40:55]
s_add_u32 s94, s76, 344064
v_mul_f32 v67, v67, v71
v_cvt_pk_bf16_f32 v196, v56, v57
v_cvt_pk_bf16_f32 v197, v58, v59
ds_read_b128 v[84:87], v1 offset:64512
v_mfma_f32_32x32x16_bf16 v[40:55], a[212:215], v[92:95], v[40:55]
v_cvt_pk_bf16_f32 v198, v64, v65
ds_read_b128 v[88:91], v124 offset:0
v_mfma_f32_32x32x16_bf16 v[40:55], a[216:219], v[96:99], v[40:55]
buffer_load_dwordx4 v1, s[28:31], s38 offen offset:1024 sc1 lds
v_cvt_pk_bf16_f32 v199, v66, v67
ds_read_b128 v[92:95], v124 offset:1024
v_mfma_f32_32x32x16_bf16 v[40:55], a[220:223], v[100:103], v[40:55]
s_cmp_lg_u32 s37, 0
s_cbranch_scc1 Lalt9_b
buffer_store_dwordx4 v[196:199], v1, s[28:31], s94 offen
Lalt9_e:
s_waitcnt lgkmcnt(6)
v_mfma_f32_32x32x16_bf16 v[40:55], a[224:227], v[104:107], v[40:55]
ds_read_b128 v[96:99], v124 offset:2048
v_cvt_pk_bf16_f32 v217, v216, v216
v_and_b32 v218, 0xffff0000, v217
v_sub_f32 v216, v216, v218
ds_read_b128 v[100:103], v124 offset:3072
v_mfma_f32_32x32x16_bf16 v[40:55], a[228:231], v[108:111], v[40:55]
v_cvt_pk_bf16_f32 v218, v216, v216
v_and_b32 v219, 0xffff0000, v218
ds_read_b128 v[104:107], v124 offset:4096
v_sub_f32 v216, v216, v219
v_and_b32 v217, 0xffff, v217
v_mfma_f32_32x32x16_bf16 v[40:55], a[232:235], v[112:115], v[40:55]
buffer_load_dwordx4 v1, s[28:31], s38 offen offset:2048 sc1 lds
ds_read_b128 v[240:243], v125 offset:512
v_or_b32 v218, v219, v217
ds_read_b128 v[108:111], v124 offset:5120
v_mfma_f32_32x32x16_bf16 v[40:55], a[236:239], v[116:119], v[40:55]
v_cvt_pk_bf16_f32 v219, v216, 0
v_lshlrev_b32 v217, 3, v0
ds_read_b128 v[112:115], v124 offset:6144
s_lshl_b32 s90, s36, 9
s_waitcnt lgkmcnt(8)
v_mfma_f32_32x32x16_bf16 v[40:55], a[240:243], v[72:75], v[40:55]
s_add_u32 s90, s90, 162048
v_add_u32 v217, s90, v217
ds_read_b128 v[116:119], v124 offset:7168
v_mfma_f32_32x32x16_bf16 v[40:55], a[244:247], v[76:79], v[40:55]
s_mov_b64 exec, 0xffffffff
ds_write_b64 v217, v[218:219]
s_mov_b64 exec, -1
v_mov_b32 v122, 0
v_mov_b32 v123, 0
s_mov_b64 exec, 0xffffffff
ds_read_b64 v[122:123], v206 offset:256
s_mov_b64 exec, -1
v_mfma_f32_32x32x16_bf16 v[40:55], a[248:251], v[80:83], v[40:55]
buffer_load_dwordx4 v1, s[28:31], s38 offen offset:3072 sc1 lds
ds_read_b128 v[72:75], v124 offset:8192
ds_read_b128 v[76:79], v124 offset:9216
v_mfma_f32_32x32x16_bf16 v[40:55], a[252:255], v[84:87], v[40:55]
ds_read_b128 v[80:83], v124 offset:10240
s_waitcnt lgkmcnt(3)
v_mfma_f32_32x32x8_bf16 v[40:55], v[122:123], v[240:241], v[40:55]
v_mfma_f32_32x32x16_bf16 v[56:71], a[128:131], v[88:91], 0
s_add_u32 m0, s46, 32768
s_lshl4_add_u32 s38, s70, 0
ds_read_b128 v[84:87], v124 offset:11264
v_mfma_f32_32x32x16_bf16 v[56:71], a[132:135], v[92:95], v[56:71]
s_barrier
ds_read_b128 v[88:91], v124 offset:12288
v_mfma_f32_32x32x16_bf16 v[56:71], a[136:139], v[96:99], v[56:71]
buffer_load_dwordx4 v208, s[20:23], s38 offen offset:0 lds
ds_read_b128 v[92:95], v124 offset:13312
v_mfma_f32_32x32x16_bf16 v[56:71], a[140:143], v[100:103], v[56:71]
buffer_load_dwordx4 v209, s[20:23], s38 offen offset:1024 lds
s_add_u32 m0, s46, 32768
s_lshl4_add_u32 s38, s70, 0
v_mfma_f32_32x32x16_bf16 v[56:71], a[144:147], v[104:107], v[56:71]
s_add_u32 s91, s81, 3
v_mov_b32 v38, s91
s_waitcnt vmcnt(4)
s_cmp_lg_u32 s37, 0
s_cbranch_scc1 Lalt14_b
buffer_store_dword v38, v15, s[28:31], 0 offen
Lalt14_e:
v_mfma_f32_32x32x16_bf16 v[56:71], a[148:151], v[108:111], v[56:71]
buffer_load_dwordx4 v210, s[20:23], s38 offen offset:2048 lds
ds_read_b128 v[96:99], v124 offset:14336
v_mul_f32 v40, v243, v40
v_mul_f32 v41, v243, v41
v_mfma_f32_32x32x16_bf16 v[56:71], a[152:155], v[112:115], v[56:71]
buffer_load_dwordx4 v211, s[20:23], s38 offen offset:3072 lds
s_add_u32 m0, s46, 49152
s_lshl4_add_u32 s38, s71, 0
ds_read_b128 v[100:103], v124 offset:15360
v_mfma_f32_32x32x16_bf16 v[56:71], a[156:159], v[116:119], v[56:71]
v_exp_f32 v40, v40
v_mul_f32 v42, v243, v42
ds_read_b128 v[104:107], v124 offset:16384
s_waitcnt lgkmcnt(5)
v_mfma_f32_32x32x16_bf16 v[56:71], a[160:163], v[72:75], v[56:71]
buffer_load_dwordx4 v208, s[20:23], s38 offen offset:0 lds
v_exp_f32 v41, v41
v_mul_f32 v43, v243, v43
v_mfma_f32_32x32x16_bf16 v[56:71], a[164:167], v[76:79], v[56:71]
buffer_load_dwordx4 v209, s[20:23], s38 offen offset:1024 lds
s_add_u32 m0, s46, 49152
s_lshl4_add_u32 s38, s71, 0
v_exp_f32 v42, v42
v_mfma_f32_32x32x16_bf16 v[56:71], a[168:171], v[80:83], v[56:71]
ds_read_b128 v[108:111], v124 offset:17408
v_mul_f32 v48, v243, v48
v_exp_f32 v43, v43
ds_read_b128 v[112:115], v124 offset:18432
v_mfma_f32_32x32x16_bf16 v[56:71], a[172:175], v[84:87], v[56:71]
buffer_load_dwordx4 v210, s[20:23], s38 offen offset:2048 lds
v_mul_f32 v49, v243, v49
v_exp_f32 v48, v48
s_waitcnt lgkmcnt(3)
v_mfma_f32_32x32x16_bf16 v[56:71], a[176:179], v[88:91], v[56:71]
buffer_load_dwordx4 v211, s[20:23], s38 offen offset:3072 lds
ds_read_b128 v[116:119], v124 offset:19456
v_mul_f32 v50, v243, v50
v_exp_f32 v49, v49
v_mfma_f32_32x32x16_bf16 v[56:71], a[180:183], v[92:95], v[56:71]
ds_read_b128 v[72:75], v124 offset:20480
v_mul_f32 v51, v243, v51
v_exp_f32 v50, v50
v_exp_f32 v51, v51
v_mfma_f32_32x32x16_bf16 v[56:71], a[184:187], v[96:99], v[56:71]
ds_read_b128 v[76:79], v124 offset:21504
v_fma_f32 v40, v40, v242, v242
v_fma_f32 v41, v41, v242, v242
ds_read_b128 v[80:83], v124 offset:22528
v_fma_f32 v42, v42, v242, v242
v_mfma_f32_32x32x16_bf16 v[56:71], a[188:191], v[100:103], v[56:71]
v_fma_f32 v43, v43, v242, v242
ds_read_b128 v[84:87], v124 offset:23552
v_fma_f32 v48, v48, v242, v242
v_fma_f32 v49, v49, v242, v242
s_waitcnt lgkmcnt(4)
v_mfma_f32_32x32x16_bf16 v[56:71], a[192:195], v[104:107], v[56:71]
ds_read_b128 v[88:91], v124 offset:24576
v_fma_f32 v50, v50, v242, v242
v_fma_f32 v51, v51, v242, v242
ds_read_b128 v[92:95], v124 offset:25600
v_mfma_f32_32x32x16_bf16 v[56:71], a[196:199], v[108:111], v[56:71]
v_rcp_f32 v40, v40
v_rcp_f32 v41, v41
v_mul_f32 v40, v40, v44
v_mfma_f32_32x32x16_bf16 v[56:71], a[200:203], v[112:115], v[56:71]
ds_read_b128 v[96:99], v124 offset:26624
v_rcp_f32 v42, v42
v_mul_f32 v41, v41, v45
ds_read_b128 v[100:103], v124 offset:27648
v_mfma_f32_32x32x16_bf16 v[56:71], a[204:207], v[116:119], v[56:71]
v_rcp_f32 v43, v43
v_mul_f32 v42, v42, v46
ds_read_b128 v[104:107], v124 offset:28672
s_waitcnt lgkmcnt(5)
v_mfma_f32_32x32x16_bf16 v[56:71], a[208:211], v[72:75], v[56:71]
buffer_load_dword v38, v14, s[28:31], 0 offen sc1
v_rcp_f32 v48, v48
v_mul_f32 v43, v43, v47
v_mfma_f32_32x32x16_bf16 v[56:71], a[212:215], v[76:79], v[56:71]
ds_read_b128 v[108:111], v124 offset:29696
v_rcp_f32 v49, v49
v_mul_f32 v48, v48, v52
ds_read_b128 v[112:115], v124 offset:30720
v_mfma_f32_32x32x16_bf16 v[56:71], a[216:219], v[80:83], v[56:71]
v_rcp_f32 v50, v50
v_mul_f32 v49, v49, v53
v_rcp_f32 v51, v51
v_mfma_f32_32x32x16_bf16 v[56:71], a[220:223], v[84:87], v[56:71]
ds_read_b128 v[116:119], v124 offset:31744
v_mul_f32 v50, v50, v54
s_add_u32 s94, s76, 118784
ds_read_b128 v[72:75], v1 offset:0
s_waitcnt lgkmcnt(5)
v_mfma_f32_32x32x16_bf16 v[56:71], a[224:227], v[88:91], v[56:71]
v_mul_f32 v51, v51, v55
v_cvt_pk_bf16_f32 v192, v40, v41
v_cvt_pk_bf16_f32 v193, v42, v43
v_cvt_pk_bf16_f32 v194, v48, v49
v_cvt_pk_bf16_f32 v195, v50, v51
s_cmp_lg_u32 s37, 0
s_cbranch_scc1 Lalt10_b
buffer_store_dwordx4 v[192:195], v1, s[28:31], s94 offen
Lalt10_e:
v_mfma_f32_32x32x16_bf16 v[56:71], a[228:231], v[92:95], v[56:71]
ds_read_b128 v[76:79], v1 offset:1024
ds_read_b128 v[80:83], v1 offset:2048
v_mfma_f32_32x32x16_bf16 v[56:71], a[232:235], v[96:99], v[56:71]
ds_read_b128 v[84:87], v1 offset:3072
ds_read_b128 v[88:91], v1 offset:4096
v_mfma_f32_32x32x16_bf16 v[56:71], a[236:239], v[100:103], v[56:71]
ds_read_b128 v[244:247], v125 offset:1024
ds_read_b128 v[92:95], v1 offset:5120
s_waitcnt lgkmcnt(7)
v_mfma_f32_32x32x16_bf16 v[56:71], a[240:243], v[104:107], v[56:71]
ds_read_b128 v[96:99], v1 offset:6144
ds_read_b128 v[100:103], v1 offset:7168
v_mfma_f32_32x32x16_bf16 v[56:71], a[244:247], v[108:111], v[56:71]
ds_read_b128 v[104:107], v1 offset:8192
v_mfma_f32_32x32x16_bf16 v[56:71], a[248:251], v[112:115], v[56:71]
ds_read_b128 v[108:111], v1 offset:9216
v_mfma_f32_32x32x16_bf16 v[56:71], a[252:255], v[116:119], v[56:71]
ds_read_b128 v[112:115], v1 offset:10240
s_waitcnt lgkmcnt(6)
v_mfma_f32_32x32x8_bf16 v[56:71], v[122:123], v[244:245], v[56:71]
v_mfma_f32_32x32x16_bf16 v[40:55], a[128:131], v[72:75], 0
s_add_u32 s77, s79, s69
ds_read_b128 v[116:119], v1 offset:11264
v_mfma_f32_32x32x16_bf16 v[40:55], a[132:135], v[76:79], v[40:55]
s_waitcnt vmcnt(11)
s_barrier
s_add_u32 s91, s81, 3
s_waitcnt vmcnt(1)
v_subrev_u32 v33, s91, v38
v_cmp_lt_u32 vcc, 7, v33
s_nop 0
s_and_b64 vcc, vcc, s[52:53]
s_cbranch_scc1 Ls7
Lb8:
v_mfma_f32_32x32x16_bf16 v[40:55], a[136:139], v[80:83], v[40:55]
buffer_load_dwordx4 v[128:131], v1, s[28:31], s77 offen offset:0 sc1
ds_read_b128 v[72:75], v1 offset:12288
ds_read_b128 v[76:79], v1 offset:13312
s_lshl_b32 s88, s57, 15
v_mfma_f32_32x32x16_bf16 v[40:55], a[140:143], v[84:87], v[40:55]
buffer_load_dwordx4 v[132:135], v1, s[28:31], s77 offen offset:1024 sc1
ds_read_b128 v[80:83], v1 offset:14336
v_mul_f32 v56, v247, v56
s_waitcnt lgkmcnt(7)
v_mfma_f32_32x32x16_bf16 v[40:55], a[144:147], v[88:91], v[40:55]
s_lshl_b32 s89, s44, 12
v_mul_f32 v57, v247, v57
ds_read_b128 v[84:87], v1 offset:15360
v_exp_f32 v56, v56
v_mfma_f32_32x32x16_bf16 v[40:55], a[148:151], v[92:95], v[40:55]
buffer_load_dwordx4 v[136:139], v1, s[28:31], s77 offen offset:2048 sc1
v_mul_f32 v58, v247, v58
s_add_u32 s88, s88, s89
ds_read_b128 v[88:91], v1 offset:16384
v_mfma_f32_32x32x16_bf16 v[40:55], a[152:155], v[96:99], v[40:55]
buffer_load_dwordx4 v[140:143], v1, s[28:31], s77 offen offset:3072 sc1
s_add_u32 s77, s79, s70
v_exp_f32 v57, v57
v_mfma_f32_32x32x16_bf16 v[40:55], a[156:159], v[100:103], v[40:55]
v_mul_f32 v59, v247, v59
s_and_b32 s89, s45, 2048
v_exp_f32 v58, v58
s_waitcnt lgkmcnt(5)
v_mfma_f32_32x32x16_bf16 v[40:55], a[160:163], v[104:107], v[40:55]
buffer_load_dwordx4 v[144:147], v1, s[28:31], s77 offen offset:0 sc1
ds_read_b128 v[92:95], v1 offset:17408
v_mul_f32 v64, v247, v64
s_add_u32 s88, s88, s89
v_mfma_f32_32x32x16_bf16 v[40:55], a[164:167], v[108:111], v[40:55]
buffer_load_dwordx4 v[148:151], v1, s[28:31], s77 offen offset:1024 sc1
v_exp_f32 v59, v59
ds_read_b128 v[96:99], v1 offset:18432
v_mfma_f32_32x32x16_bf16 v[40:55], a[168:171], v[112:115], v[40:55]
v_mul_f32 v65, v247, v65
v_exp_f32 v64, v64
s_add_u32 s88, s88, 4194304
ds_read_b128 v[100:103], v1 offset:19456
v_mfma_f32_32x32x16_bf16 v[40:55], a[172:175], v[116:119], v[40:55]
buffer_load_dwordx4 v[152:155], v1, s[28:31], s77 offen offset:2048 sc1
v_mul_f32 v66, v247, v66
v_lshlrev_b32 v127, 7, v0
s_waitcnt lgkmcnt(4)
v_mfma_f32_32x32x16_bf16 v[40:55], a[176:179], v[72:75], v[40:55]
buffer_load_dwordx4 v[156:159], v1, s[28:31], s77 offen offset:3072 sc1
s_add_u32 s77, s79, s71
v_exp_f32 v65, v65
v_mfma_f32_32x32x16_bf16 v[40:55], a[180:183], v[76:79], v[40:55]
ds_read_b128 v[104:107], v1 offset:20480
v_mul_f32 v67, v247, v67
v_exp_f32 v66, v66
v_exp_f32 v67, v67
v_mfma_f32_32x32x16_bf16 v[40:55], a[184:187], v[80:83], v[40:55]
buffer_load_dwordx4 v[160:163], v1, s[28:31], s77 offen offset:0 sc1
ds_read_b128 v[108:111], v1 offset:21504
v_fma_f32 v56, v56, v246, v246
v_fma_f32 v57, v57, v246, v246
v_mfma_f32_32x32x16_bf16 v[40:55], a[188:191], v[84:87], v[40:55]
buffer_load_dwordx4 v[164:167], v1, s[28:31], s77 offen offset:1024 sc1
ds_read_b128 v[112:115], v1 offset:22528
s_add_u32 m0, s46, 65536
v_fma_f32 v58, v58, v246, v246
s_waitcnt lgkmcnt(3)
v_mfma_f32_32x32x16_bf16 v[40:55], a[192:195], v[88:91], v[40:55]
s_lshl4_add_u32 s38, s72, 0
v_fma_f32 v59, v59, v246, v246
ds_read_b128 v[116:119], v1 offset:23552
v_fma_f32 v64, v64, v246, v246
v_fma_f32 v65, v65, v246, v246
v_mfma_f32_32x32x16_bf16 v[40:55], a[196:199], v[92:95], v[40:55]
buffer_load_dwordx4 v208, s[20:23], s38 offen offset:0 lds
ds_read_b128 v[72:75], v1 offset:24576
v_fma_f32 v66, v66, v246, v246
v_fma_f32 v67, v67, v246, v246
v_mfma_f32_32x32x16_bf16 v[40:55], a[200:203], v[96:99], v[40:55]
buffer_load_dwordx4 v209, s[20:23], s38 offen offset:1024 lds
ds_read_b128 v[76:79], v1 offset:25600
s_add_u32 m0, s46, 65536
s_lshl4_add_u32 s38, s72, 0
v_mfma_f32_32x32x16_bf16 v[40:55], a[204:207], v[100:103], v[40:55]
v_rcp_f32 v56, v56
v_rcp_f32 v57, v57
v_mul_f32 v56, v56, v60
s_waitcnt lgkmcnt(2)
v_mfma_f32_32x32x16_bf16 v[40:55], a[208:211], v[104:107], v[40:55]
s_mov_b64 exec, 65535
buffer_load_dword v34, v127, s[28:31], s88 offen sc1
s_mov_b64 exec, -1
s_lshl_b32 s88, s57, 12
s_lshl_b32 s89, s44, 9
s_add_u32 s88, s88, s89
s_lshr_b32 s89, s36, 1
s_lshl_b32 s89, s89, 8
buffer_load_dwordx4 v210, s[20:23], s38 offen offset:2048 lds
s_add_u32 s88, s88, s89
s_add_u32 s88, s88, 10485760
s_mov_b64 exec, 3
buffer_load_dword v34, v127, s[28:31], s88 offen sc1
s_mov_b64 exec, -1
v_mfma_f32_32x32x16_bf16 v[40:55], a[212:215], v[108:111], v[40:55]
ds_read_b128 v[80:83], v1 offset:26624
ds_read_b128 v[84:87], v1 offset:27648
buffer_load_dwordx4 v211, s[20:23], s38 offen offset:3072 lds
v_rcp_f32 v58, v58
v_mfma_f32_32x32x16_bf16 v[40:55], a[216:219], v[112:115], v[40:55]
v_mul_f32 v57, v57, v61
v_rcp_f32 v59, v59
v_mul_f32 v58, v58, v62
ds_read_b128 v[88:91], v1 offset:28672
ds_read_b128 v[92:95], v1 offset:29696
v_mfma_f32_32x32x16_bf16 v[40:55], a[220:223], v[116:119], v[40:55]
buffer_load_dwordx4 v[168:171], v1, s[28:31], s77 offen offset:2048 sc1
v_rcp_f32 v64, v64
v_mul_f32 v59, v59, v63
s_waitcnt lgkmcnt(2)
v_mfma_f32_32x32x16_bf16 v[40:55], a[224:227], v[72:75], v[40:55]
v_rcp_f32 v65, v65
v_mul_f32 v64, v64, v68
v_rcp_f32 v66, v66
v_mul_f32 v65, v65, v69
v_rcp_f32 v67, v67
buffer_load_dwordx4 v[172:175], v1, s[28:31], s77 offen offset:3072 sc1
v_mul_f32 v66, v66, v70
s_add_u32 s94, s76, 233472
v_mul_f32 v67, v67, v71
v_cvt_pk_bf16_f32 v196, v56, v57
v_cvt_pk_bf16_f32 v197, v58, v59
v_cvt_pk_bf16_f32 v198, v64, v65
v_cvt_pk_bf16_f32 v199, v66, v67
s_cmp_lg_u32 s37, 0
s_cbranch_scc1 Lalt11_b
buffer_store_dwordx4 v[196:199], v1, s[28:31], s94 offen
Lalt11_e:
v_mfma_f32_32x32x16_bf16 v[40:55], a[228:231], v[76:79], v[40:55]
ds_read_b128 v[96:99], v1 offset:30720
ds_read_b128 v[100:103], v1 offset:31744
s_add_u32 s77, s79, s72
ds_read_b128 v[104:107], v124 offset:32768
v_mfma_f32_32x32x16_bf16 v[40:55], a[232:235], v[80:83], v[40:55]
buffer_load_dwordx4 v[176:179], v1, s[28:31], s77 offen offset:0 sc1
ds_read_b128 v[108:111], v124 offset:33792
v_mfma_f32_32x32x16_bf16 v[40:55], a[236:239], v[84:87], v[40:55]
buffer_load_dwordx4 v[180:183], v1, s[28:31], s77 offen offset:1024 sc1
ds_read_b128 v[112:115], v124 offset:34816
s_add_u32 m0, s46, 81920
s_waitcnt lgkmcnt(3)
v_mfma_f32_32x32x16_bf16 v[40:55], a[240:243], v[88:91], v[40:55]
ds_read_b128 v[240:243], v125 offset:1536
s_lshl4_add_u32 s38, s73, 0
ds_read_b128 v[116:119], v124 offset:35840
v_mfma_f32_32x32x16_bf16 v[40:55], a[244:247], v[92:95], v[40:55]
buffer_load_dwordx4 v208, s[20:23], s38 offen offset:0 lds
ds_read_b128 v[72:75], v124 offset:36864
ds_read_b128 v[76:79], v124 offset:37888
v_mfma_f32_32x32x16_bf16 v[40:55], a[248:251], v[96:99], v[40:55]
buffer_load_dwordx4 v209, s[20:23], s38 offen offset:1024 lds
s_add_u32 m0, s46, 81920
s_lshl4_add_u32 s38, s73, 0
ds_read_b128 v[80:83], v124 offset:38912
v_mfma_f32_32x32x16_bf16 v[40:55], a[252:255], v[100:103], v[40:55]
ds_read_b128 v[84:87], v124 offset:39936
ds_read_b128 v[88:91], v124 offset:40960
s_waitcnt lgkmcnt(6)
v_mfma_f32_32x32x8_bf16 v[40:55], v[122:123], v[240:241], v[40:55]
buffer_load_dwordx4 v210, s[20:23], s38 offen offset:2048 lds
ds_read_b128 v[92:95], v124 offset:41984
Lpage5:
s_cbranch_execz Ltour1
ds_read_b128 v[96:99], v124 offset:43008
s_waitcnt lgkmcnt(7)
v_mfma_f32_32x32x16_bf16 v[56:71], a[128:131], v[104:107], 0
buffer_load_dwordx4 v211, s[20:23], s38 offen offset:3072 lds
ds_read_b128 v[100:103], v124 offset:44032
v_mfma_f32_32x32x16_bf16 v[56:71], a[132:135], v[108:111], v[56:71]
s_barrier
ds_read_b128 v[104:107], v124 offset:45056
v_mfma_f32_32x32x16_bf16 v[56:71], a[136:139], v[112:115], v[56:71]
buffer_load_dwordx4 v[184:187], v1, s[28:31], s77 offen offset:2048 sc1
ds_read_b128 v[108:111], v124 offset:46080
v_mfma_f32_32x32x16_bf16 v[56:71], a[140:143], v[116:119], v[56:71]
buffer_load_dwordx4 v[188:191], v1, s[28:31], s77 offen offset:3072 sc1
s_add_u32 s77, s79, s73
ds_read_b128 v[112:115], v124 offset:47104
s_waitcnt lgkmcnt(7)
v_mfma_f32_32x32x16_bf16 v[56:71], a[144:147], v[72:75], v[56:71]
v_mul_f32 v40, v243, v40
v_mul_f32 v41, v243, v41
ds_read_b128 v[116:119], v124 offset:48128
v_exp_f32 v40, v40
v_mfma_f32_32x32x16_bf16 v[56:71], a[148:151], v[76:79], v[56:71]
buffer_load_dwordx4 v[224:227], v1, s[28:31], s77 offen offset:0 sc1
v_mul_f32 v42, v243, v42
v_exp_f32 v41, v41
v_mfma_f32_32x32x16_bf16 v[56:71], a[152:155], v[80:83], v[56:71]
buffer_load_dwordx4 v[228:231], v1, s[28:31], s77 offen offset:1024 sc1
s_add_u32 m0, s46, 0
s_lshl4_add_u32 s38, s74, 0
ds_read_b128 v[72:75], v124 offset:49152
v_mfma_f32_32x32x16_bf16 v[56:71], a[156:159], v[84:87], v[56:71]
v_mul_f32 v43, v243, v43
v_exp_f32 v42, v42
ds_read_b128 v[76:79], v124 offset:50176
s_waitcnt lgkmcnt(6)
v_mfma_f32_32x32x16_bf16 v[56:71], a[160:163], v[88:91], v[56:71]
buffer_load_dwordx4 v208, s[20:23], s38 offen offset:0 lds
v_mul_f32 v48, v243, v48
v_exp_f32 v43, v43
v_mfma_f32_32x32x16_bf16 v[56:71], a[164:167], v[92:95], v[56:71]
buffer_load_dwordx4 v209, s[20:23], s38 offen offset:1024 lds
s_add_u32 m0, s46, 0
s_lshl4_add_u32 s38, s74, 0
ds_read_b128 v[80:83], v124 offset:51200
v_mfma_f32_32x32x16_bf16 v[56:71], a[168:171], v[96:99], v[56:71]
v_mul_f32 v49, v243, v49
v_exp_f32 v48, v48
ds_read_b128 v[84:87], v124 offset:52224
v_mul_f32 v50, v243, v50
v_mfma_f32_32x32x16_bf16 v[56:71], a[172:175], v[100:103], v[56:71]
buffer_load_dwordx4 v210, s[20:23], s38 offen offset:2048 lds
v_exp_f32 v49, v49
s_waitcnt lgkmcnt(4)
v_mfma_f32_32x32x16_bf16 v[56:71], a[176:179], v[104:107], v[56:71]
buffer_load_dwordx4 v211, s[20:23], s38 offen offset:3072 lds
ds_read_b128 v[88:91], v124 offset:53248
v_mul_f32 v51, v243, v51
ds_read_b128 v[92:95], v124 offset:54272
v_mfma_f32_32x32x16_bf16 v[56:71], a[180:183], v[108:111], v[56:71]
v_exp_f32 v50, v50
v_exp_f32 v51, v51
v_fma_f32 v40, v40, v242, v242
v_mfma_f32_32x32x16_bf16 v[56:71], a[184:187], v[112:115], v[56:71]
buffer_load_dwordx4 v[232:235], v1, s[28:31], s77 offen offset:2048 sc1
v_fma_f32 v41, v41, v242, v242
ds_read_b128 v[96:99], v124 offset:55296
v_fma_f32 v42, v42, v242, v242
v_mfma_f32_32x32x16_bf16 v[56:71], a[188:191], v[116:119], v[56:71]
buffer_load_dwordx4 v[236:239], v1, s[28:31], s77 offen offset:3072 sc1
s_add_u32 s77, s79, s74
v_fma_f32 v43, v43, v242, v242
s_waitcnt lgkmcnt(3)
v_mfma_f32_32x32x16_bf16 v[56:71], a[192:195], v[72:75], v[56:71]
ds_read_b128 v[100:103], v124 offset:56320
v_fma_f32 v48, v48, v242, v242
v_fma_f32 v49, v49, v242, v242
ds_read_b128 v[104:107], v124 offset:57344
v_fma_f32 v50, v50, v242, v242
v_mfma_f32_32x32x16_bf16 v[56:71], a[196:199], v[76:79], v[56:71]
buffer_load_dwordx4 v[248:251], v1, s[28:31], s77 offen offset:0 sc1
v_fma_f32 v51, v51, v242, v242
ds_read_b128 v[108:111], v124 offset:58368
ds_read_b128 v[112:115], v124 offset:59392
v_mfma_f32_32x32x16_bf16 v[56:71], a[200:203], v[80:83], v[56:71]
buffer_load_dwordx4 v[252:255], v1, s[28:31], s77 offen offset:1024 sc1
s_add_u32 m0, s46, 16384
s_lshl4_add_u32 s38, s75, 0
v_rcp_f32 v40, v40
v_mfma_f32_32x32x16_bf16 v[56:71], a[204:207], v[84:87], v[56:71]
v_rcp_f32 v41, v41
v_mul_f32 v40, v40, v44
v_rcp_f32 v42, v42
s_waitcnt lgkmcnt(3)
v_mfma_f32_32x32x16_bf16 v[56:71], a[208:211], v[88:91], v[56:71]
buffer_load_dwordx4 v208, s[20:23], s38 offen offset:0 lds
v_mul_f32 v41, v41, v45
ds_read_b128 v[116:119], v124 offset:60416
v_rcp_f32 v43, v43
v_mfma_f32_32x32x16_bf16 v[56:71], a[212:215], v[92:95], v[56:71]
buffer_load_dwordx4 v209, s[20:23], s38 offen offset:1024 lds
v_mul_f32 v42, v42, v46
ds_read_b128 v[72:75], v124 offset:61440
s_add_u32 m0, s46, 16384
v_mfma_f32_32x32x16_bf16 v[56:71], a[216:219], v[96:99], v[56:71]
s_lshl4_add_u32 s38, s75, 0
v_rcp_f32 v48, v48
v_mul_f32 v43, v43, v47
ds_read_b128 v[76:79], v124 offset:62464
v_mfma_f32_32x32x16_bf16 v[56:71], a[220:223], v[100:103], v[56:71]
buffer_load_dwordx4 v210, s[20:23], s38 offen offset:2048 lds
v_rcp_f32 v49, v49
v_mul_f32 v48, v48, v52
s_waitcnt lgkmcnt(2)
v_mfma_f32_32x32x16_bf16 v[56:71], a[224:227], v[104:107], v[56:71]
v_rcp_f32 v50, v50
v_mul_f32 v49, v49, v53
v_rcp_f32 v51, v51
buffer_load_dwordx4 v211, s[20:23], s38 offen offset:3072 lds
v_mul_f32 v50, v50, v54
s_add_u32 s94, s76, 348160
v_mul_f32 v51, v51, v55
v_cvt_pk_bf16_f32 v192, v40, v41
v_cvt_pk_bf16_f32 v193, v42, v43
v_cvt_pk_bf16_f32 v194, v48, v49
v_cvt_pk_bf16_f32 v195, v50, v51
s_cmp_lg_u32 s37, 0
s_cbranch_scc1 Lalt12_b
buffer_store_dwordx4 v[192:195], v1, s[28:31], s94 offen
Lalt12_e:
v_mfma_f32_32x32x16_bf16 v[56:71], a[228:231], v[108:111], v[56:71]
ds_read_b128 v[80:83], v124 offset:63488
ds_read_b128 v[84:87], v124 offset:64512
v_mfma_f32_32x32x16_bf16 v[56:71], a[232:235], v[112:115], v[56:71]
ds_read_b64_tr_b16 v[92:93], v205 offset:0
ds_read_b64_tr_b16 v[94:95], v205 offset:512
ds_read_b64_tr_b16 v[88:89], v204 offset:0
ds_read_b64_tr_b16 v[90:91], v204 offset:512
v_lshlrev_b32 v40, 16, v16
v_mfma_f32_32x32x16_bf16 v[56:71], a[236:239], v[116:119], v[56:71]
ds_read_b64_tr_b16 v[100:101], v205 offset:2048
ds_read_b64_tr_b16 v[102:103], v205 offset:2560
ds_read_b128 v[244:247], v125 offset:0
v_and_b32 v41, 0xffff0000, v16
s_waitcnt lgkmcnt(7)
v_mfma_f32_32x32x16_bf16 v[56:71], a[240:243], v[72:75], v[56:71]
ds_read_b64_tr_b16 v[96:97], v204 offset:2048
ds_read_b64_tr_b16 v[98:99], v204 offset:2560
v_lshlrev_b32 v42, 16, v17
v_and_b32 v43, 0xffff0000, v17
v_lshlrev_b32 v44, 16, v18
v_mfma_f32_32x32x16_bf16 v[56:71], a[244:247], v[76:79], v[56:71]
v_and_b32 v45, 0xffff0000, v18
v_lshlrev_b32 v46, 16, v19
v_and_b32 v47, 0xffff0000, v19
v_lshlrev_b32 v48, 16, v20
v_and_b32 v49, 0xffff0000, v20
v_mfma_f32_32x32x16_bf16 v[56:71], a[248:251], v[80:83], v[56:71]
v_lshlrev_b32 v50, 16, v21
v_and_b32 v51, 0xffff0000, v21
v_lshlrev_b32 v52, 16, v22
v_and_b32 v53, 0xffff0000, v22
v_lshlrev_b32 v54, 16, v23
v_mfma_f32_32x32x16_bf16 v[56:71], a[252:255], v[84:87], v[56:71]
v_and_b32 v55, 0xffff0000, v23
s_waitcnt lgkmcnt(2)
v_mfma_f32_32x32x8_bf16 v[56:71], v[122:123], v[244:245], v[56:71]
Lp3join9:
s_waitcnt vmcnt(41)
v_mfma_f32_32x32x16_bf16 v[104:119], v[92:95], v[128:131], 0
s_barrier
v_mfma_f32_32x32x16_bf16 v[40:55], v[88:91], v[128:131], v[40:55]
s_add_u32 m0, s46, 98304
s_lshl4_add_u32 s38, s69, 65536
buffer_load_dwordx4 v208, s[20:23], s38 offen offset:0 lds
ds_read_b64_tr_b16 v[76:77], v205 offset:4096
ds_read_b64_tr_b16 v[78:79], v205 offset:4608
s_waitcnt vmcnt(41)
v_mfma_f32_32x32x16_bf16 v[104:119], v[100:103], v[132:135], v[104:119]
buffer_load_dwordx4 v209, s[20:23], s38 offen offset:1024 lds
ds_read_b64_tr_b16 v[72:73], v204 offset:4096
ds_read_b64_tr_b16 v[74:75], v204 offset:4608
s_add_u32 m0, s46, 98304
s_waitcnt lgkmcnt(4)
v_mfma_f32_32x32x16_bf16 v[40:55], v[96:99], v[132:135], v[40:55]
ds_read_b64_tr_b16 v[84:85], v205 offset:6144
ds_read_b64_tr_b16 v[86:87], v205 offset:6656
s_lshl4_add_u32 s38, s69, 65536
ds_read_b64_tr_b16 v[92:93], v201 offset:32768
s_waitcnt lgkmcnt(3)
s_waitcnt vmcnt(41)
v_mfma_f32_32x32x16_bf16 v[104:119], v[76:79], v[136:139], v[104:119]
buffer_load_dwordx4 v210, s[20:23], s38 offen offset:2048 lds
ds_read_b64_tr_b16 v[80:81], v204 offset:6144
ds_read_b64_tr_b16 v[82:83], v204 offset:6656
ds_read_b64_tr_b16 v[94:95], v201 offset:33280
v_mfma_f32_32x32x16_bf16 v[40:55], v[72:75], v[136:139], v[40:55]
buffer_load_dwordx4 v211, s[20:23], s38 offen offset:3072 lds
ds_read_b64_tr_b16 v[88:89], v200 offset:32768
v_mul_f32 v56, v247, v56
s_waitcnt lgkmcnt(2)
s_waitcnt vmcnt(42)
v_mfma_f32_32x32x16_bf16 v[104:119], v[84:87], v[140:143], v[104:119]
ds_read_b64_tr_b16 v[90:91], v200 offset:33280
v_mul_f32 v57, v247, v57
v_exp_f32 v56, v56
v_mul_f32 v58, v247, v58
v_mfma_f32_32x32x16_bf16 v[40:55], v[80:83], v[140:143], v[40:55]
buffer_load_dwordx4 v[128:131], v1, s[28:31], s77 offen offset:2048 sc1
ds_read_b64_tr_b16 v[100:101], v201 offset:34816
ds_read_b64_tr_b16 v[102:103], v201 offset:35328
s_waitcnt lgkmcnt(2)
s_waitcnt vmcnt(42)
v_mfma_f32_32x32x16_bf16 v[104:119], v[92:95], v[144:147], v[104:119]
buffer_load_dwordx4 v[132:135], v1, s[28:31], s77 offen offset:3072 sc1
ds_read_b64_tr_b16 v[96:97], v200 offset:34816
ds_read_b64_tr_b16 v[98:99], v200 offset:35328
v_exp_f32 v57, v57
v_mfma_f32_32x32x16_bf16 v[40:55], v[88:91], v[144:147], v[40:55]
ds_read_b64_tr_b16 v[76:77], v201 offset:36864
ds_read_b64_tr_b16 v[78:79], v201 offset:37376
v_mul_f32 v59, v247, v59
v_exp_f32 v58, v58
s_waitcnt lgkmcnt(2)
s_waitcnt vmcnt(42)
v_mfma_f32_32x32x16_bf16 v[104:119], v[100:103], v[148:151], v[104:119]
v_mul_f32 v64, v247, v64
v_exp_f32 v59, v59
v_mul_f32 v65, v247, v65
v_exp_f32 v64, v64
v_mul_f32 v66, v247, v66
s_add_u32 s77, s79, s75
v_exp_f32 v65, v65
v_mul_f32 v67, v247, v67
v_exp_f32 v66, v66
v_exp_f32 v67, v67
v_fma_f32 v56, v56, v246, v246
v_fma_f32 v57, v57, v246, v246
v_fma_f32 v58, v58, v246, v246
v_fma_f32 v59, v59, v246, v246
v_fma_f32 v64, v64, v246, v246
v_fma_f32 v65, v65, v246, v246
v_fma_f32 v66, v66, v246, v246
buffer_load_dwordx4 v[136:139], v1, s[28:31], s77 offen offset:0 sc1
ds_read_b64_tr_b16 v[72:73], v200 offset:36864
v_fma_f32 v67, v67, v246, v246
v_rcp_f32 v56, v56
v_rcp_f32 v57, v57
ds_read_b64_tr_b16 v[74:75], v200 offset:37376
v_mul_f32 v56, v56, v60
v_rcp_f32 v58, v58
v_mul_f32 v57, v57, v61
v_rcp_f32 v59, v59
v_mul_f32 v58, v58, v62
v_rcp_f32 v64, v64
v_mul_f32 v59, v59, v63
v_rcp_f32 v65, v65
v_mul_f32 v64, v64, v68
v_rcp_f32 v66, v66
v_mul_f32 v65, v65, v69
v_rcp_f32 v67, v67
v_mul_f32 v66, v66, v70
s_add_u32 s94, s76, 4096
v_mul_f32 v67, v67, v71
v_cvt_pk_bf16_f32 v196, v56, v57
v_cvt_pk_bf16_f32 v197, v58, v59
v_cvt_pk_bf16_f32 v198, v64, v65
v_cvt_pk_bf16_f32 v199, v66, v67
s_cmp_lg_u32 s37, 0
s_cbranch_scc1 Lalt13_b
buffer_store_dwordx4 v[196:199], v1, s[28:31], s94 offen
Lalt13_e:
v_mfma_f32_32x32x16_bf16 v[40:55], v[96:99], v[148:151], v[40:55]
buffer_load_dwordx4 v[140:143], v1, s[28:31], s77 offen offset:1024 sc1
ds_read_b64_tr_b16 v[84:85], v201 offset:38912
ds_read_b64_tr_b16 v[86:87], v201 offset:39424
s_waitcnt lgkmcnt(2)
s_waitcnt vmcnt(44)
v_mfma_f32_32x32x16_bf16 v[104:119], v[76:79], v[152:155], v[104:119]
ds_read_b64_tr_b16 v[80:81], v200 offset:38912
ds_read_b64_tr_b16 v[82:83], v200 offset:39424
ds_read_b64_tr_b16 v[92:93], v201 offset:49152
ds_read_b64_tr_b16 v[94:95], v201 offset:49664
v_mfma_f32_32x32x16_bf16 v[40:55], v[72:75], v[152:155], v[40:55]
buffer_load_dwordx4 v[144:147], v1, s[28:31], s77 offen offset:2048 sc1
ds_read_b64_tr_b16 v[88:89], v200 offset:49152
ds_read_b64_tr_b16 v[90:91], v200 offset:49664
s_waitcnt lgkmcnt(4)
s_waitcnt vmcnt(44)
v_mfma_f32_32x32x16_bf16 v[104:119], v[84:87], v[156:159], v[104:119]
buffer_load_dwordx4 v[148:151], v1, s[28:31], s77 offen offset:3072 sc1
s_add_u32 m0, s46, 114688
s_lshl4_add_u32 s38, s70, 65536
ds_read_b64_tr_b16 v[100:101], v201 offset:51200
v_mfma_f32_32x32x16_bf16 v[40:55], v[80:83], v[156:159], v[40:55]
ds_read_b64_tr_b16 v[102:103], v201 offset:51712
ds_read_b64_tr_b16 v[96:97], v200 offset:51200
ds_read_b64_tr_b16 v[98:99], v200 offset:51712
ds_read_b64_tr_b16 v[76:77], v201 offset:53248
s_waitcnt lgkmcnt(5)
s_waitcnt vmcnt(44)
v_mfma_f32_32x32x16_bf16 v[104:119], v[92:95], v[160:163], v[104:119]
buffer_load_dwordx4 v208, s[20:23], s38 offen offset:0 lds
ds_read_b64_tr_b16 v[78:79], v201 offset:53760
ds_read_b64_tr_b16 v[72:73], v200 offset:53248
ds_read_b64_tr_b16 v[74:75], v200 offset:53760
v_mfma_f32_32x32x16_bf16 v[40:55], v[88:91], v[160:163], v[40:55]
buffer_load_dwordx4 v209, s[20:23], s38 offen offset:1024 lds
s_add_u32 s91, s81, 4
v_mov_b32 v38, s91
s_waitcnt vmcnt(5)
s_cmp_lg_u32 s37, 0
s_cbranch_scc1 Lalt15_b
buffer_store_dword v38, v15, s[28:31], 0 offen
Lalt15_e:
s_waitcnt lgkmcnt(4)
v_mfma_f32_32x32x16_bf16 v[104:119], v[100:103], v[164:167], v[104:119]
s_barrier
s_add_u32 m0, s46, 114688
s_lshl4_add_u32 s38, s70, 65536
v_mfma_f32_32x32x16_bf16 v[40:55], v[96:99], v[164:167], v[40:55]
buffer_load_dwordx4 v210, s[20:23], s38 offen offset:2048 lds
ds_read_b64_tr_b16 v[84:85], v201 offset:55296
ds_read_b64_tr_b16 v[86:87], v201 offset:55808
s_waitcnt lgkmcnt(2)
v_mfma_f32_32x32x16_bf16 v[104:119], v[76:79], v[168:171], v[104:119]
buffer_load_dwordx4 v211, s[20:23], s38 offen offset:3072 lds
ds_read_b64_tr_b16 v[80:81], v200 offset:55296
ds_read_b64_tr_b16 v[82:83], v200 offset:55808
s_add_u32 m0, s46, 131072
v_mfma_f32_32x32x16_bf16 v[40:55], v[72:75], v[168:171], v[40:55]
ds_read_b64_tr_b16 v[92:93], v203 offset:0
ds_read_b64_tr_b16 v[94:95], v203 offset:512
s_lshl4_add_u32 s38, s71, 65536
ds_read_b64_tr_b16 v[88:89], v202 offset:0
s_waitcnt lgkmcnt(3)
v_mfma_f32_32x32x16_bf16 v[104:119], v[84:87], v[172:175], v[104:119]
buffer_load_dwordx4 v208, s[20:23], s38 offen offset:0 lds
ds_read_b64_tr_b16 v[90:91], v202 offset:512
ds_read_b64_tr_b16 v[100:101], v203 offset:2048
ds_read_b64_tr_b16 v[102:103], v203 offset:2560
v_mfma_f32_32x32x16_bf16 v[40:55], v[80:83], v[172:175], v[40:55]
buffer_load_dwordx4 v209, s[20:23], s38 offen offset:1024 lds
s_add_u32 m0, s46, 131072
s_lshl4_add_u32 s38, s71, 65536
s_waitcnt lgkmcnt(2)
v_mfma_f32_32x32x16_bf16 v[104:119], v[92:95], v[176:179], v[104:119]
ds_read_b64_tr_b16 v[96:97], v202 offset:2048
ds_read_b64_tr_b16 v[98:99], v202 offset:2560
ds_read_b64_tr_b16 v[76:77], v203 offset:4096
ds_read_b64_tr_b16 v[78:79], v203 offset:4608
v_mfma_f32_32x32x16_bf16 v[40:55], v[88:91], v[176:179], v[40:55]
buffer_load_dwordx4 v210, s[20:23], s38 offen offset:2048 lds
ds_read_b64_tr_b16 v[72:73], v202 offset:4096
ds_read_b64_tr_b16 v[74:75], v202 offset:4608
s_waitcnt lgkmcnt(4)
v_mfma_f32_32x32x16_bf16 v[104:119], v[100:103], v[180:183], v[104:119]
s_barrier
buffer_load_dwordx4 v211, s[20:23], s38 offen offset:3072 lds
v_mfma_f32_32x32x16_bf16 v[40:55], v[96:99], v[180:183], v[40:55]
ds_read_b64_tr_b16 v[84:85], v203 offset:6144
ds_read_b64_tr_b16 v[86:87], v203 offset:6656
s_add_u32 m0, s46, 32768
s_lshl4_add_u32 s38, s72, 65536
s_waitcnt lgkmcnt(2)
v_mfma_f32_32x32x16_bf16 v[104:119], v[76:79], v[184:187], v[104:119]
buffer_load_dwordx4 v208, s[20:23], s38 offen offset:0 lds
ds_read_b64_tr_b16 v[80:81], v202 offset:6144
ds_read_b64_tr_b16 v[82:83], v202 offset:6656
ds_read_b64_tr_b16 v[92:93], v203 offset:16384
v_mfma_f32_32x32x16_bf16 v[40:55], v[72:75], v[184:187], v[40:55]
buffer_load_dwordx4 v209, s[20:23], s38 offen offset:1024 lds
ds_read_b64_tr_b16 v[94:95], v203 offset:16896
s_add_u32 m0, s46, 32768
s_waitcnt lgkmcnt(2)
v_mfma_f32_32x32x16_bf16 v[104:119], v[84:87], v[188:191], v[104:119]
ds_read_b64_tr_b16 v[88:89], v202 offset:16384
ds_read_b64_tr_b16 v[90:91], v202 offset:16896
s_lshl4_add_u32 s38, s72, 65536
ds_read_b64_tr_b16 v[100:101], v203 offset:18432
ds_read_b64_tr_b16 v[102:103], v203 offset:18944
v_mfma_f32_32x32x16_bf16 v[40:55], v[80:83], v[188:191], v[40:55]
buffer_load_dwordx4 v210, s[20:23], s38 offen offset:2048 lds
ds_read_b64_tr_b16 v[96:97], v202 offset:18432
ds_read_b64_tr_b16 v[98:99], v202 offset:18944
s_waitcnt lgkmcnt(4)
v_mfma_f32_32x32x16_bf16 v[104:119], v[92:95], v[224:227], v[104:119]
buffer_load_dwordx4 v211, s[20:23], s38 offen offset:3072 lds
ds_read_b64_tr_b16 v[76:77], v203 offset:20480
ds_read_b64_tr_b16 v[78:79], v203 offset:20992
ds_read_b64_tr_b16 v[72:73], v202 offset:20480
v_mfma_f32_32x32x16_bf16 v[40:55], v[88:91], v[224:227], v[40:55]
ds_read_b64_tr_b16 v[74:75], v202 offset:20992
ds_read_b64_tr_b16 v[84:85], v203 offset:22528
ds_read_b64_tr_b16 v[86:87], v203 offset:23040
ds_read_b64_tr_b16 v[80:81], v202 offset:22528
s_waitcnt lgkmcnt(7)
v_mfma_f32_32x32x16_bf16 v[104:119], v[100:103], v[228:231], v[104:119]
s_barrier
buffer_load_dword v127, v14, s[28:31], 0 offen sc1
v_mfma_f32_32x32x16_bf16 v[40:55], v[96:99], v[228:231], v[40:55]
s_add_u32 m0, s46, 49152
s_lshl4_add_u32 s38, s73, 65536
buffer_load_dwordx4 v208, s[20:23], s38 offen offset:0 lds
s_waitcnt lgkmcnt(3)
v_mfma_f32_32x32x16_bf16 v[104:119], v[76:79], v[232:235], v[104:119]
ds_read_b64_tr_b16 v[82:83], v202 offset:23040
ds_read_b64_tr_b16 v[92:93], v201 offset:0
ds_read_b64_tr_b16 v[88:89], v200 offset:0
ds_read_b64_tr_b16 v[94:95], v201 offset:512
v_mfma_f32_32x32x16_bf16 v[40:55], v[72:75], v[232:235], v[40:55]
buffer_load_dwordx4 v209, s[20:23], s38 offen offset:1024 lds
s_add_u32 m0, s46, 49152
s_lshl4_add_u32 s38, s73, 65536
s_waitcnt lgkmcnt(3)
v_mfma_f32_32x32x16_bf16 v[104:119], v[84:87], v[236:239], v[104:119]
buffer_load_dwordx4 v210, s[20:23], s38 offen offset:2048 lds
ds_read_b64_tr_b16 v[90:91], v200 offset:512
ds_read_b64_tr_b16 v[100:101], v201 offset:2048
ds_read_b64_tr_b16 v[102:103], v201 offset:2560
v_mfma_f32_32x32x16_bf16 v[40:55], v[80:83], v[236:239], v[40:55]
ds_read_b64_tr_b16 v[96:97], v200 offset:2048
ds_read_b64_tr_b16 v[98:99], v200 offset:2560
ds_read_b64_tr_b16 v[76:77], v201 offset:4096
ds_read_b64_tr_b16 v[78:79], v201 offset:4608
s_waitcnt lgkmcnt(6)
v_mfma_f32_32x32x16_bf16 v[104:119], v[92:95], v[248:251], v[104:119]
buffer_load_dwordx4 v211, s[20:23], s38 offen offset:3072 lds
s_add_u32 m0, s46, 65536
s_lshl4_add_u32 s38, s74, 65536
ds_read_b64_tr_b16 v[72:73], v200 offset:4096
v_mfma_f32_32x32x16_bf16 v[40:55], v[88:91], v[248:251], v[40:55]
buffer_load_dwordx4 v208, s[20:23], s38 offen offset:0 lds
ds_read_b64_tr_b16 v[74:75], v200 offset:4608
ds_read_b64_tr_b16 v[84:85], v201 offset:6144
s_waitcnt lgkmcnt(5)
v_mfma_f32_32x32x16_bf16 v[104:119], v[100:103], v[252:255], v[104:119]
s_barrier
ds_read_b64_tr_b16 v[86:87], v201 offset:6656
ds_read_b64_tr_b16 v[80:81], v200 offset:6144
v_mfma_f32_32x32x16_bf16 v[40:55], v[96:99], v[252:255], v[40:55]
buffer_load_dwordx4 v209, s[20:23], s38 offen offset:1024 lds
s_add_u32 s91, s81, 4
s_waitcnt vmcnt(6)
v_subrev_u32 v33, s91, v127
v_cmp_lt_u32 vcc, 7, v33
s_nop 0
s_and_b64 vcc, vcc, s[52:53]
s_cbranch_scc1 Ls10
Lb11:
s_waitcnt lgkmcnt(3)
v_mfma_f32_32x32x16_bf16 v[104:119], v[76:79], v[128:131], v[104:119]
s_add_u32 m0, s46, 65536
s_lshl4_add_u32 s38, s74, 65536
buffer_load_dwordx4 v210, s[20:23], s38 offen offset:2048 lds
ds_read_b64_tr_b16 v[82:83], v200 offset:6656
v_mfma_f32_32x32x16_bf16 v[40:55], v[72:75], v[128:131], v[40:55]
ds_read_b64_tr_b16 v[92:93], v201 offset:16384
ds_read_b64_tr_b16 v[94:95], v201 offset:16896
ds_read_b64_tr_b16 v[88:89], v200 offset:16384
ds_read_b64_tr_b16 v[90:91], v200 offset:16896
s_waitcnt lgkmcnt(4)
v_mfma_f32_32x32x16_bf16 v[104:119], v[84:87], v[132:135], v[104:119]
buffer_load_dwordx4 v211, s[20:23], s38 offen offset:3072 lds
s_add_u32 s77, s80, s69
ds_read_b64_tr_b16 v[100:101], v201 offset:18432
ds_read_b64_tr_b16 v[102:103], v201 offset:18944
v_mfma_f32_32x32x16_bf16 v[40:55], v[80:83], v[132:135], v[40:55]
buffer_load_dwordx4 v[152:155], v1, s[28:31], s77 offen offset:0 sc1
ds_read_b64_tr_b16 v[96:97], v200 offset:18432
ds_read_b64_tr_b16 v[98:99], v200 offset:18944
s_waitcnt lgkmcnt(4)
v_mfma_f32_32x32x16_bf16 v[104:119], v[92:95], v[136:139], v[104:119]
ds_read_b64_tr_b16 v[76:77], v201 offset:20480
ds_read_b64_tr_b16 v[78:79], v201 offset:20992
ds_read_b64_tr_b16 v[72:73], v200 offset:20480
ds_read_b64_tr_b16 v[74:75], v200 offset:20992
v_mfma_f32_32x32x16_bf16 v[40:55], v[88:91], v[136:139], v[40:55]
buffer_load_dwordx4 v[156:159], v1, s[28:31], s77 offen offset:1024 sc1
ds_read_b64_tr_b16 v[84:85], v201 offset:22528
ds_read_b64_tr_b16 v[86:87], v201 offset:23040
s_waitcnt lgkmcnt(6)
v_mfma_f32_32x32x16_bf16 v[104:119], v[100:103], v[140:143], v[104:119]
s_barrier
buffer_load_dwordx4 v[160:163], v1, s[28:31], s77 offen offset:2048 sc1
v_mfma_f32_32x32x16_bf16 v[40:55], v[96:99], v[140:143], v[40:55]
ds_read_b64_tr_b16 v[80:81], v200 offset:22528
ds_read_b64_tr_b16 v[82:83], v200 offset:23040
ds_read_b64_tr_b16 v[92:93], v203 offset:32768
ds_read_b64_tr_b16 v[88:89], v202 offset:32768
s_waitcnt lgkmcnt(6)
v_mfma_f32_32x32x16_bf16 v[104:119], v[76:79], v[144:147], v[104:119]
buffer_load_dwordx4 v[164:167], v1, s[28:31], s77 offen offset:3072 sc1
s_add_u32 s77, s80, s70
ds_read_b64_tr_b16 v[94:95], v203 offset:33280
ds_read_b64_tr_b16 v[90:91], v202 offset:33280
v_mfma_f32_32x32x16_bf16 v[40:55], v[72:75], v[144:147], v[40:55]
buffer_load_dwordx4 v[168:171], v1, s[28:31], s77 offen offset:0 sc1
ds_read_b64_tr_b16 v[100:101], v203 offset:34816
ds_read_b64_tr_b16 v[102:103], v203 offset:35328
s_waitcnt lgkmcnt(6)
v_mfma_f32_32x32x16_bf16 v[104:119], v[84:87], v[148:151], v[104:119]
ds_read_b64_tr_b16 v[96:97], v202 offset:34816
ds_read_b64_tr_b16 v[98:99], v202 offset:35328
ds_read_b64_tr_b16 v[76:77], v203 offset:36864
ds_read_b64_tr_b16 v[78:79], v203 offset:37376
v_mfma_f32_32x32x16_bf16 v[40:55], v[80:83], v[148:151], v[40:55]
buffer_load_dwordx4 v[172:175], v1, s[28:31], s77 offen offset:1024 sc1
ds_read_b64_tr_b16 v[72:73], v202 offset:36864
ds_read_b64_tr_b16 v[74:75], v202 offset:37376
s_waitcnt lgkmcnt(8)
s_waitcnt vmcnt(5)
v_mfma_f32_32x32x16_bf16 v[104:119], v[92:95], v[152:155], v[104:119]
buffer_load_dwordx4 v[176:179], v1, s[28:31], s77 offen offset:2048 sc1
ds_read_b64_tr_b16 v[84:85], v203 offset:38912
ds_read_b64_tr_b16 v[86:87], v203 offset:39424
ds_read_b64_tr_b16 v[80:81], v202 offset:38912
v_mfma_f32_32x32x16_bf16 v[40:55], v[88:91], v[152:155], v[40:55]
ds_read_b64_tr_b16 v[82:83], v202 offset:39424
s_waitcnt lgkmcnt(8)
s_waitcnt vmcnt(5)
v_mfma_f32_32x32x16_bf16 v[104:119], v[100:103], v[156:159], v[104:119]
s_barrier
buffer_load_dwordx4 v[180:183], v1, s[28:31], s77 offen offset:3072 sc1
v_mfma_f32_32x32x16_bf16 v[40:55], v[96:99], v[156:159], v[40:55]
s_add_u32 s77, s80, s71
buffer_load_dwordx4 v[184:187], v1, s[28:31], s77 offen offset:0 sc1
ds_read_b64_tr_b16 v[92:93], v203 offset:49152
s_waitcnt lgkmcnt(5)
s_waitcnt vmcnt(6)
v_mfma_f32_32x32x16_bf16 v[104:119], v[76:79], v[160:163], v[104:119]
ds_read_b64_tr_b16 v[88:89], v202 offset:49152
ds_read_b64_tr_b16 v[94:95], v203 offset:49664
ds_read_b64_tr_b16 v[90:91], v202 offset:49664
ds_read_b64_tr_b16 v[100:101], v203 offset:51200
v_mfma_f32_32x32x16_bf16 v[40:55], v[72:75], v[160:163], v[40:55]
buffer_load_dwordx4 v[188:191], v1, s[28:31], s77 offen offset:1024 sc1
ds_read_b64_tr_b16 v[102:103], v203 offset:51712
ds_read_b64_tr_b16 v[96:97], v202 offset:51200
s_waitcnt lgkmcnt(7)
s_waitcnt vmcnt(6)
v_mfma_f32_32x32x16_bf16 v[104:119], v[84:87], v[164:167], v[104:119]
buffer_load_dwordx4 v[224:227], v1, s[28:31], s77 offen offset:2048 sc1
ds_read_b64_tr_b16 v[98:99], v202 offset:51712
ds_read_b64_tr_b16 v[76:77], v203 offset:53248
ds_read_b64_tr_b16 v[78:79], v203 offset:53760
v_mfma_f32_32x32x16_bf16 v[40:55], v[80:83], v[164:167], v[40:55]
ds_read_b64_tr_b16 v[72:73], v202 offset:53248
ds_read_b64_tr_b16 v[74:75], v202 offset:53760
ds_read_b64_tr_b16 v[84:85], v203 offset:55296
ds_read_b64_tr_b16 v[86:87], v203 offset:55808
s_waitcnt lgkmcnt(10)
s_waitcnt vmcnt(6)
v_mfma_f32_32x32x16_bf16 v[104:119], v[92:95], v[168:171], v[104:119]
buffer_load_dwordx4 v[228:231], v1, s[28:31], s77 offen offset:3072 sc1
s_add_u32 s77, s80, s72
ds_read_b64_tr_b16 v[80:81], v202 offset:55296
ds_read_b64_tr_b16 v[82:83], v202 offset:55808
v_mfma_f32_32x32x16_bf16 v[40:55], v[88:91], v[168:171], v[40:55]
buffer_load_dwordx4 v[232:235], v1, s[28:31], s77 offen offset:0 sc1
s_waitcnt lgkmcnt(8)
s_waitcnt vmcnt(7)
v_mfma_f32_32x32x16_bf16 v[104:119], v[100:103], v[172:175], v[104:119]
s_barrier
ds_read_b64_tr_b16 v[92:93], v205 offset:0
ds_read_b64_tr_b16 v[88:89], v204 offset:0
v_mfma_f32_32x32x16_bf16 v[40:55], v[96:99], v[172:175], v[40:55]
buffer_load_dwordx4 v[236:239], v1, s[28:31], s77 offen offset:1024 sc1
ds_read_b64_tr_b16 v[94:95], v205 offset:512
ds_read_b64_tr_b16 v[90:91], v204 offset:512
s_waitcnt lgkmcnt(8)
s_waitcnt vmcnt(7)
v_mfma_f32_32x32x16_bf16 v[104:119], v[76:79], v[176:179], v[104:119]
buffer_load_dwordx4 v[248:251], v1, s[28:31], s77 offen offset:2048 sc1
ds_read_b64_tr_b16 v[100:101], v205 offset:2048
ds_read_b64_tr_b16 v[102:103], v205 offset:2560
ds_read_b64_tr_b16 v[96:97], v204 offset:2048
v_mfma_f32_32x32x16_bf16 v[40:55], v[72:75], v[176:179], v[40:55]
ds_read_b64_tr_b16 v[98:99], v204 offset:2560
ds_read_b64_tr_b16 v[76:77], v205 offset:4096
ds_read_b64_tr_b16 v[78:79], v205 offset:4608
s_waitcnt lgkmcnt(10)
s_waitcnt vmcnt(7)
v_mfma_f32_32x32x16_bf16 v[104:119], v[84:87], v[180:183], v[104:119]
buffer_load_dwordx4 v[252:255], v1, s[28:31], s77 offen offset:3072 sc1
s_add_u32 s77, s80, s73
ds_read_b64_tr_b16 v[72:73], v204 offset:4096
ds_read_b64_tr_b16 v[74:75], v204 offset:4608
v_mfma_f32_32x32x16_bf16 v[40:55], v[80:83], v[180:183], v[40:55]
buffer_load_dwordx4 v[128:131], v1, s[28:31], s77 offen offset:0 sc1
v_add_u32 v122, s46, v1
ds_read_b64_tr_b16 v[84:85], v205 offset:6144
s_waitcnt lgkmcnt(9)
s_waitcnt vmcnt(8)
v_mfma_f32_32x32x16_bf16 v[104:119], v[92:95], v[184:187], v[104:119]
ds_read_b64_tr_b16 v[86:87], v205 offset:6656
ds_read_b64_tr_b16 v[80:81], v204 offset:6144
ds_read_b64_tr_b16 v[82:83], v204 offset:6656
v_xor_b32 v123, 8192, v122
v_and_b32 v207, 31, v0
v_mfma_f32_32x32x16_bf16 v[40:55], v[88:91], v[184:187], v[40:55]
buffer_load_dwordx4 v[132:135], v1, s[28:31], s77 offen offset:1024 sc1
v_lshlrev_b32 v207, 3, v207
v_lshrrev_b32 v33, 5, v0
s_waitcnt lgkmcnt(8)
s_waitcnt vmcnt(8)
v_mfma_f32_32x32x16_bf16 v[104:119], v[100:103], v[188:191], v[104:119]
s_barrier
Lpage6:
s_cbranch_execz Ltour1
buffer_load_dwordx4 v[136:139], v1, s[28:31], s77 offen offset:2048 sc1
v_mfma_f32_32x32x16_bf16 v[40:55], v[96:99], v[188:191], v[40:55]
ds_read_b64_tr_b16 v[92:93], v201 offset:32768
ds_read_b64_tr_b16 v[88:89], v200 offset:32768
ds_read_b64_tr_b16 v[94:95], v201 offset:33280
ds_read_b64_tr_b16 v[90:91], v200 offset:33280
s_waitcnt lgkmcnt(8)
s_waitcnt vmcnt(8)
v_mfma_f32_32x32x16_bf16 v[104:119], v[76:79], v[224:227], v[104:119]
buffer_load_dwordx4 v[140:143], v1, s[28:31], s77 offen offset:3072 sc1
s_add_u32 s77, s80, s74
ds_read_b64_tr_b16 v[100:101], v201 offset:34816
ds_read_b64_tr_b16 v[102:103], v201 offset:35328
v_mfma_f32_32x32x16_bf16 v[40:55], v[72:75], v[224:227], v[40:55]
buffer_load_dwordx4 v[144:147], v1, s[28:31], s77 offen offset:0 sc1
s_add_u32 m0, s46, 81920
s_lshl4_add_u32 s38, s75, 65536
s_waitcnt lgkmcnt(6)
s_waitcnt vmcnt(9)
v_mfma_f32_32x32x16_bf16 v[104:119], v[84:87], v[228:231], v[104:119]
ds_read_b64_tr_b16 v[96:97], v200 offset:34816
ds_read_b64_tr_b16 v[98:99], v200 offset:35328
ds_read_b64_tr_b16 v[76:77], v201 offset:36864
ds_read_b64_tr_b16 v[78:79], v201 offset:37376
v_lshl_add_u32 v207, v33, 2, v207
v_mfma_f32_32x32x16_bf16 v[40:55], v[80:83], v[228:231], v[40:55]
buffer_load_dwordx4 v208, s[20:23], s38 offen offset:0 lds
ds_read_b64_tr_b16 v[72:73], v200 offset:36864
ds_read_b64_tr_b16 v[74:75], v200 offset:37376
s_waitcnt lgkmcnt(8)
s_waitcnt vmcnt(9)
v_mfma_f32_32x32x16_bf16 v[104:119], v[92:95], v[232:235], v[104:119]
buffer_load_dwordx4 v209, s[20:23], s38 offen offset:1024 lds
s_add_u32 m0, s46, 81920
s_lshl4_add_u32 s38, s75, 65536
ds_read_b64_tr_b16 v[84:85], v201 offset:38912
v_mfma_f32_32x32x16_bf16 v[40:55], v[88:91], v[232:235], v[40:55]
ds_read_b64_tr_b16 v[86:87], v201 offset:39424
ds_read_b64_tr_b16 v[80:81], v200 offset:38912
ds_read_b64_tr_b16 v[82:83], v200 offset:39424
s_waitcnt lgkmcnt(8)
s_waitcnt vmcnt(9)
v_mfma_f32_32x32x16_bf16 v[104:119], v[100:103], v[236:239], v[104:119]
s_barrier
buffer_load_dwordx4 v210, s[20:23], s38 offen offset:2048 lds
v_mfma_f32_32x32x16_bf16 v[40:55], v[96:99], v[236:239], v[40:55]
buffer_load_dwordx4 v211, s[20:23], s38 offen offset:3072 lds
ds_read_b64_tr_b16 v[92:93], v201 offset:49152
ds_read_b64_tr_b16 v[88:89], v200 offset:49152
s_waitcnt lgkmcnt(6)
s_waitcnt vmcnt(10)
v_mfma_f32_32x32x16_bf16 v[104:119], v[76:79], v[248:251], v[104:119]
ds_read_b64_tr_b16 v[94:95], v201 offset:49664
ds_read_b64_tr_b16 v[90:91], v200 offset:49664
ds_read_b64_tr_b16 v[100:101], v201 offset:51200
ds_read_b64_tr_b16 v[102:103], v201 offset:51712
v_mfma_f32_32x32x16_bf16 v[40:55], v[72:75], v[248:251], v[40:55]
buffer_load_dwordx4 v[148:151], v1, s[28:31], s77 offen offset:1024 sc1
ds_read_b64_tr_b16 v[96:97], v200 offset:51200
ds_read_b64_tr_b16 v[98:99], v200 offset:51712
s_waitcnt lgkmcnt(8)
s_waitcnt vmcnt(10)
v_mfma_f32_32x32x16_bf16 v[104:119], v[84:87], v[252:255], v[104:119]
buffer_load_dwordx4 v[152:155], v1, s[28:31], s77 offen offset:2048 sc1
ds_read_b64_tr_b16 v[76:77], v201 offset:53248
ds_read_b64_tr_b16 v[78:79], v201 offset:53760
ds_read_b64_tr_b16 v[72:73], v200 offset:53248
v_mfma_f32_32x32x16_bf16 v[40:55], v[80:83], v[252:255], v[40:55]
ds_read_b64_tr_b16 v[74:75], v200 offset:53760
ds_read_b64_tr_b16 v[84:85], v201 offset:55296
ds_read_b64_tr_b16 v[86:87], v201 offset:55808
s_waitcnt lgkmcnt(10)
s_waitcnt vmcnt(10)
v_mfma_f32_32x32x16_bf16 v[104:119], v[92:95], v[128:131], v[104:119]
buffer_load_dwordx4 v[156:159], v1, s[28:31], s77 offen offset:3072 sc1
s_add_u32 s77, s80, s75
s_add_u32 s79, s39, 8388608
s_lshl_b32 s80, s57, 12
v_mfma_f32_32x32x16_bf16 v[40:55], v[88:91], v[128:131], v[40:55]
buffer_load_dwordx4 v[160:163], v1, s[28:31], s77 offen offset:0 sc1
s_lshl_b32 s89, s44, 9
ds_read_b64_tr_b16 v[80:81], v200 offset:55296
s_waitcnt lgkmcnt(7)
s_waitcnt vmcnt(11)
v_mfma_f32_32x32x16_bf16 v[104:119], v[100:103], v[132:135], v[104:119]
s_barrier
s_add_u32 s80, s80, s89
ds_read_b64_tr_b16 v[82:83], v200 offset:55808
v_mfma_f32_32x32x16_bf16 v[40:55], v[96:99], v[132:135], v[40:55]
buffer_load_dwordx4 v[164:167], v1, s[28:31], s77 offen offset:1024 sc1
s_lshr_b32 s89, s36, 1
s_lshl_b32 s89, s89, 8
s_waitcnt lgkmcnt(4)
s_waitcnt vmcnt(11)
v_mfma_f32_32x32x16_bf16 v[104:119], v[76:79], v[136:139], v[104:119]
buffer_load_dwordx4 v[168:171], v1, s[28:31], s77 offen offset:2048 sc1
ds_read_b64_tr_b16 v[92:93], v203 offset:0
ds_read_b64_tr_b16 v[88:89], v202 offset:0
ds_read_b64_tr_b16 v[94:95], v203 offset:512
v_mfma_f32_32x32x16_bf16 v[40:55], v[72:75], v[136:139], v[40:55]
ds_read_b64_tr_b16 v[90:91], v202 offset:512
s_add_u32 s80, s80, s89
ds_read_b64_tr_b16 v[100:101], v203 offset:2048
s_add_u32 s80, s80, 10485760
s_waitcnt lgkmcnt(5)
s_waitcnt vmcnt(11)
v_mfma_f32_32x32x16_bf16 v[104:119], v[84:87], v[140:143], v[104:119]
buffer_load_dwordx4 v[172:175], v1, s[28:31], s77 offen offset:3072 sc1
s_add_u32 m0, s84, 98304
s_xor_b32 s59, s85, 0
s_mul_i32 s59, s59, 196608
v_mfma_f32_32x32x16_bf16 v[40:55], v[80:83], v[140:143], v[40:55]
buffer_load_dwordx4 v4, s[8:11], s59 offen offset:0 lds
ds_read_b64_tr_b16 v[102:103], v203 offset:2560
ds_read_b64_tr_b16 v[96:97], v202 offset:2048
s_waitcnt lgkmcnt(3)
s_waitcnt vmcnt(12)
v_mfma_f32_32x32x16_bf16 v[104:119], v[92:95], v[144:147], v[104:119]
ds_read_b64_tr_b16 v[98:99], v202 offset:2560
s_lshl_b32 s79, s41, 16
s_add_u32 s79, s79, 4194304
ds_read_b64_tr_b16 v[76:77], v203 offset:4096
s_lshl_b32 s56, s36, 14
v_mfma_f32_32x32x16_bf16 v[40:55], v[88:91], v[144:147], v[40:55]
s_waitcnt vmcnt(8)
s_barrier
buffer_load_dwordx4 v4, s[8:11], s59 offen offset:1024 lds
ds_read_b64_tr_b16 v[78:79], v203 offset:4608
s_waitcnt lgkmcnt(2)
s_waitcnt vmcnt(8)
v_mfma_f32_32x32x16_bf16 v[104:119], v[100:103], v[148:151], v[104:119]
buffer_load_dwordx4 v4, s[8:11], s59 offen offset:2048 lds
ds_read_b64_tr_b16 v[72:73], v202 offset:4096
ds_read_b64_tr_b16 v[74:75], v202 offset:4608
s_add_u32 m0, s84, 110592
s_add_u32 s56, s56, s79
v_mfma_f32_32x32x16_bf16 v[40:55], v[96:99], v[148:151], v[40:55]
ds_read_b64_tr_b16 v[84:85], v203 offset:6144
ds_read_b64_tr_b16 v[86:87], v203 offset:6656
s_add_u32 s59, s59, 98304
s_lshl_b32 s78, s48, 13
s_add_u32 s78, s78, 11534336
s_waitcnt lgkmcnt(2)
s_waitcnt vmcnt(8)
v_mfma_f32_32x32x16_bf16 v[104:119], v[76:79], v[152:155], v[104:119]
buffer_load_dwordx4 v4, s[8:11], s59 offen offset:0 lds
ds_read_b64_tr_b16 v[92:93], v203 offset:16384
ds_read_b64_tr_b16 v[94:95], v203 offset:16896
s_cmp_eq_u32 s47, 0
s_cselect_b32 s78, s79, s78
v_mfma_f32_32x32x16_bf16 v[40:55], v[72:75], v[152:155], v[40:55]
buffer_load_dwordx4 v4, s[8:11], s59 offen offset:1024 lds
ds_read_b64_tr_b16 v[100:101], v203 offset:18432
ds_read_b64_tr_b16 v[102:103], v203 offset:18944
s_lshl_b32 s92, s57, 12
s_waitcnt vmcnt(9) lgkmcnt(4)
v_mfma_f32_32x32x16_bf16 v[104:119], v[84:87], v[156:159], v[104:119]
ds_read_b64_tr_b16 v[76:77], v203 offset:20480
ds_read_b64_tr_b16 v[78:79], v203 offset:20992
v_xor_b32 v127, 64, v2
ds_read_b64_tr_b16 v[80:81], v202 offset:6144
v_bfe_u32 v243, v127, 5, 2
s_waitcnt vmcnt(8) lgkmcnt(5)
v_mfma_f32_32x32x16_bf16 v[104:119], v[92:95], v[160:163], v[104:119]
buffer_load_dwordx4 v4, s[8:11], s59 offen offset:2048 lds
ds_read_b64_tr_b16 v[84:85], v203 offset:22528
ds_read_b64_tr_b16 v[86:87], v203 offset:23040
ds_read_b64_tr_b16 v[82:83], v202 offset:6656
s_waitcnt vmcnt(8) lgkmcnt(6)
v_mfma_f32_32x32x16_bf16 v[104:119], v[100:103], v[164:167], v[104:119]
s_add_u32 m0, s84, 122880
s_xor_b32 s59, s85, 1
s_mul_i32 s59, s59, 196608
buffer_load_dwordx4 v4, s[8:11], s59 offen offset:0 lds
ds_read_b64_tr_b16 v[88:89], v202 offset:16384
s_waitcnt vmcnt(8) lgkmcnt(5)
v_mfma_f32_32x32x16_bf16 v[104:119], v[76:79], v[168:171], v[104:119]
ds_read_b64_tr_b16 v[90:91], v202 offset:16896
v_and_b32 v127, 16, v127
v_lshl_add_u32 v127, v243, 8, v127
ds_read_b64_tr_b16 v[96:97], v202 offset:18432
v_lshrrev_b32 v242, 11, v2
ds_read_b64_tr_b16 v[98:99], v202 offset:18944
s_waitcnt vmcnt(7) lgkmcnt(5)
v_mfma_f32_32x32x16_bf16 v[104:119], v[84:87], v[172:175], v[104:119]
buffer_load_dwordx4 v4, s[8:11], s59 offen offset:1024 lds
ds_read_b64_tr_b16 v[72:73], v202 offset:20480
v_lshl_add_u32 v127, v242, 5, v127
ds_read_b64_tr_b16 v[74:75], v202 offset:20992
v_and_b32 v2, 127, v2
s_waitcnt lgkmcnt(6)
v_mfma_f32_32x32x16_bf16 v[40:55], v[80:83], v[156:159], v[40:55]
buffer_load_dwordx4 v4, s[8:11], s59 offen offset:2048 lds
s_add_u32 m0, s84, 135168
s_add_u32 s59, s59, 98304
v_lshl_add_u32 v2, v242, 10, v2
s_waitcnt lgkmcnt(4)
v_mfma_f32_32x32x16_bf16 v[40:55], v[88:91], v[160:163], v[40:55]
v_xor_b32 v3, 64, v2
v_add_u32 v3, 7168, v3
v_lshrrev_b32 v242, 11, v13
v_and_b32 v243, 1023, v13
v_lshl_add_u32 v242, v242, 10, v243
ds_read_b64_tr_b16 v[80:81], v202 offset:22528
ds_read_b64_tr_b16 v[82:83], v202 offset:23040
s_waitcnt lgkmcnt(4)
v_mfma_f32_32x32x16_bf16 v[40:55], v[96:99], v[164:167], v[40:55]
buffer_load_dwordx4 v4, s[8:11], s59 offen offset:0 lds
ds_write_b128 v122, v[104:107] offset:0
s_waitcnt lgkmcnt(3)
v_mfma_f32_32x32x16_bf16 v[40:55], v[72:75], v[168:171], v[40:55]
buffer_load_dwordx4 v4, s[8:11], s59 offen offset:1024 lds
ds_write_b128 v122, v[108:111] offset:1024
s_waitcnt lgkmcnt(2)
v_mfma_f32_32x32x16_bf16 v[40:55], v[80:83], v[172:175], v[40:55]
buffer_load_dwordx4 v4, s[8:11], s59 offen offset:2048 lds
ds_write_b128 v122, v[112:115] offset:2048
ds_write_b128 v122, v[116:119] offset:3072
s_waitcnt lgkmcnt(0)
s_barrier
ds_read_b128 v[56:59], v123 offset:0
ds_read_b128 v[60:63], v123 offset:1024
ds_read_b128 v[64:67], v123 offset:2048
ds_read_b128 v[68:71], v123 offset:3072
s_waitcnt lgkmcnt(3)
s_nop 1
v_pk_add_f32 v[40:41], v[40:41], v[56:57]
v_pk_add_f32 v[42:43], v[42:43], v[58:59]
v_cvt_pk_bf16_f32 v16, v40, v41
v_cvt_pk_bf16_f32 v17, v42, v43
s_waitcnt lgkmcnt(2)
v_pk_add_f32 v[44:45], v[44:45], v[60:61]
v_pk_add_f32 v[46:47], v[46:47], v[62:63]
v_cvt_pk_bf16_f32 v18, v44, v45
v_cvt_pk_bf16_f32 v19, v46, v47
s_waitcnt lgkmcnt(1)
v_pk_add_f32 v[48:49], v[48:49], v[64:65]
v_pk_add_f32 v[50:51], v[50:51], v[66:67]
v_cvt_pk_bf16_f32 v20, v48, v49
v_cvt_pk_bf16_f32 v21, v50, v51
s_waitcnt lgkmcnt(0)
v_pk_add_f32 v[52:53], v[52:53], v[68:69]
v_pk_add_f32 v[54:55], v[54:55], v[70:71]
v_cvt_pk_bf16_f32 v22, v52, v53
v_cvt_pk_bf16_f32 v23, v54, v55
s_cmp_lg_u32 s37, 0
s_cbranch_scc1 Lalt16_b
buffer_store_dwordx4 v[16:19], v242, s[28:31], s79 offen
buffer_store_dwordx4 v[20:23], v242, s[28:31], s79 offen offset:32
Lalt16_e:
v_pk_add_f32 v[88:89], v[40:41], v[42:43]
v_pk_mul_f32 v[90:91], v[40:41], v[40:41]
v_pk_fma_f32 v[90:91], v[42:43], v[42:43], v[90:91]
v_pk_add_f32 v[88:89], v[88:89], v[44:45]
v_pk_fma_f32 v[90:91], v[44:45], v[44:45], v[90:91]
v_pk_add_f32 v[88:89], v[88:89], v[46:47]
v_pk_fma_f32 v[90:91], v[46:47], v[46:47], v[90:91]
v_pk_add_f32 v[88:89], v[88:89], v[48:49]
v_pk_fma_f32 v[90:91], v[48:49], v[48:49], v[90:91]
v_pk_add_f32 v[88:89], v[88:89], v[50:51]
v_pk_fma_f32 v[90:91], v[50:51], v[50:51], v[90:91]
v_pk_add_f32 v[88:89], v[88:89], v[52:53]
v_pk_fma_f32 v[90:91], v[52:53], v[52:53], v[90:91]
v_pk_add_f32 v[88:89], v[88:89], v[54:55]
v_pk_fma_f32 v[90:91], v[54:55], v[54:55], v[90:91]
v_add_f32 v88, v88, v89
v_add_f32 v90, v90, v91
s_nop 1
v_permlane32_swap_b32 v88, v90
v_add_f32 v88, v88, v90
s_cmp_lg_u32 s37, 0
s_cbranch_scc1 Lalt17_b
buffer_store_dword v88, v207, s[28:31], s80 offen
Lalt17_e:
s_add_u32 s91, s81, 5
v_mov_b32 v38, s91
s_waitcnt vmcnt(0)
s_cmp_lg_u32 s37, 0
s_cbranch_scc1 Lalt18_b
buffer_store_dword v38, v15, s[28:31], 0 offen
Lalt18_e:
s_add_u32 m0, s84, 147456
s_xor_b32 s59, s85, 2
s_mul_i32 s59, s59, 196608
buffer_load_dwordx4 v4, s[8:11], s59 offen offset:0 lds
buffer_load_dwordx4 v4, s[8:11], s59 offen offset:1024 lds
buffer_load_dwordx4 v4, s[8:11], s59 offen offset:2048 lds
s_mov_b64 exec, 0
s_cmp_eq_u32 s36, 0
s_cbranch_scc1 Lpage9
s_cmp_eq_u32 s36, 1
s_cbranch_scc1 Lpage10
s_cmp_eq_u32 s36, 2
s_cbranch_scc1 Lpage11
s_branch Lpage12
Ltour2:
s_mov_b64 exec, -1
v_mov_b32 v120, v127
s_barrier
ds_read_b64_tr_b16 v[112:113], v5 offset:24576
ds_read_b64_tr_b16 v[114:115], v5 offset:25088
ds_read_b64_tr_b16 v[128:129], v5 offset:25600
ds_read_b64_tr_b16 v[130:131], v5 offset:26112
ds_read_b64_tr_b16 v[192:193], v5 offset:26624
ds_read_b64_tr_b16 v[194:195], v5 offset:27136
s_add_u32 s91, s81, 5
s_mov_b32 s58, 30000
Lpl13:
buffer_load_dword v38, v14, s[28:31], 0 offen sc1
s_sub_u32 s58, s58, 1
s_cmp_eq_u32 s58, 0
s_cselect_b64 s[88:89], 0, s[54:55]
s_waitcnt vmcnt(0)
v_subrev_u32 v33, s91, v38
v_cmp_lt_u32 vcc, 7, v33
s_nop 0
s_and_b64 vcc, vcc, s[88:89]
s_cbranch_scc1 Lpl13
s_add_u32 m0, s61, 0
s_xor_b32 s38, s3, 0
s_add_u32 s38, s38, s56
buffer_load_dwordx4 v2, s[28:31], s38 offen sc1 lds
buffer_load_dwordx4 v3, s[28:31], s38 offen offset:1024 sc1 lds
s_add_u32 m0, s61, 8192
s_xor_b32 s38, s3, 128
s_add_u32 s38, s38, s56
buffer_load_dwordx4 v2, s[28:31], s38 offen sc1 lds
buffer_load_dwordx4 v3, s[28:31], s38 offen offset:1024 sc1 lds
s_add_u32 s38, s92, 10485760
buffer_load_dwordx4 v[240:243], v1, s[28:31], s38 offen offset:0 sc1
buffer_load_dwordx4 v[244:247], v1, s[28:31], s38 offen offset:1024 sc1
buffer_load_dwordx4 v[248:251], v1, s[28:31], s38 offen offset:2048 sc1
buffer_load_dwordx4 v[252:255], v1, s[28:31], s38 offen offset:3072 sc1
s_add_u32 m0, s61, 16384
s_xor_b32 s38, s3, 256
s_add_u32 s38, s38, s56
buffer_load_dwordx4 v2, s[28:31], s38 offen sc1 lds
buffer_load_dwordx4 v3, s[28:31], s38 offen offset:1024 sc1 lds
s_waitcnt vmcnt(8)
s_barrier
ds_read_b128 v[96:99], v7 offset:0
ds_read_b128 v[100:103], v7 offset:2048
ds_read_b128 v[104:107], v7 offset:4096
ds_read_b128 v[108:111], v7 offset:6144
s_waitcnt lgkmcnt(3)
v_mfma_f32_16x16x32_bf16 v[40:43], v[112:115], v[96:99], 0
s_waitcnt vmcnt(6)
s_barrier
s_add_u32 m0, s61, 24576
s_xor_b32 s38, s3, 384
s_add_u32 s38, s38, s56
buffer_load_dwordx4 v2, s[28:31], s38 offen sc1 lds
v_mfma_f32_16x16x32_bf16 v[60:63], v[128:131], v[96:99], 0
v_and_b32 v121, 7, v0
ds_read_b64_tr_b16 v[116:117], v5 offset:36864
v_mfma_f32_16x16x32_bf16 v[80:83], v[96:99], v[192:195], 0
buffer_load_dwordx4 v3, s[28:31], s38 offen offset:1024 sc1 lds
s_waitcnt lgkmcnt(3)
v_mfma_f32_16x16x32_bf16 v[44:47], v[112:115], v[100:103], 0
s_add_u32 m0, s84, 73728
s_add_u32 s59, s59, 98304
v_mfma_f32_16x16x32_bf16 v[64:67], v[128:131], v[100:103], 0
v_lshlrev_b32 v121, 5, v121
ds_read_b64_tr_b16 v[118:119], v5 offset:37376
v_mfma_f32_16x16x32_bf16 v[84:87], v[100:103], v[192:195], 0
buffer_load_dwordx4 v4, s[8:11], s59 offen offset:0 lds
s_waitcnt lgkmcnt(3)
v_mfma_f32_16x16x32_bf16 v[48:51], v[112:115], v[104:107], 0
v_lshrrev_b32 v122, 5, v0
v_lshl_add_u32 v121, v122, 4, v121
v_mfma_f32_16x16x32_bf16 v[68:71], v[128:131], v[104:107], 0
ds_read_b128 v[96:99], v8 offset:0
ds_read_b64_tr_b16 v[132:133], v5 offset:37888
s_lshl_b32 s88, s41, 4
v_mfma_f32_16x16x32_bf16 v[88:91], v[104:107], v[192:195], 0
buffer_load_dwordx4 v4, s[8:11], s59 offen offset:1024 lds
ds_read_b64_tr_b16 v[134:135], v5 offset:38400
s_waitcnt lgkmcnt(5)
v_mfma_f32_16x16x32_bf16 v[52:55], v[112:115], v[108:111], 0
ds_read_b64_tr_b16 v[196:197], v5 offset:38912
ds_read_b64_tr_b16 v[198:199], v5 offset:39424
ds_read_b128 v[100:103], v8 offset:2048
v_mfma_f32_16x16x32_bf16 v[72:75], v[128:131], v[108:111], 0
buffer_load_dwordx4 v4, s[8:11], s59 offen offset:2048 lds
s_lshl_b32 s89, s44, 1
v_mfma_f32_16x16x32_bf16 v[92:95], v[108:111], v[192:195], 0
s_add_u32 s88, s88, s89
s_lshr_b32 s89, s36, 1
s_add_u32 s88, s88, s89
s_lshl_b32 s88, s88, 9
s_add_u32 s88, s88, 11534336
s_bitcmp1_b32 s36, 0
s_cbranch_scc0 Lhs14
s_mov_b32 exec_lo, 0xff000000
s_mov_b32 exec_hi, 0xff000000
buffer_store_dwordx4 v[16:19], v121, s[28:31], s88 offen sc1
buffer_store_dwordx4 v[20:23], v121, s[28:31], s88 offen offset:256 sc1
s_mov_b64 exec, -1
Lhs14:
s_waitcnt lgkmcnt(0)
v_mfma_f32_16x16x32_bf16 v[40:43], v[116:119], v[96:99], v[40:43]
s_add_u32 m0, s84, 86016
s_xor_b32 s59, s85, 3
v_mfma_f32_16x16x32_bf16 v[60:63], v[132:135], v[96:99], v[60:63]
s_mul_i32 s59, s59, 196608
buffer_load_dwordx4 v4, s[8:11], s59 offen offset:0 lds
ds_read_b128 v[104:107], v8 offset:4096
v_mfma_f32_16x16x32_bf16 v[80:83], v[96:99], v[196:199], v[80:83]
ds_read_b128 v[108:111], v8 offset:6144
s_waitcnt vmcnt(10)
v_add_f32 v240, v240, v244
v_mfma_f32_16x16x32_bf16 v[44:47], v[116:119], v[100:103], v[44:47]
v_add_f32 v241, v241, v245
ds_read_b64_tr_b16 v[112:113], v6 offset:0
v_mfma_f32_16x16x32_bf16 v[64:67], v[132:135], v[100:103], v[64:67]
buffer_load_dwordx4 v4, s[8:11], s59 offen offset:1024 lds
v_mfma_f32_16x16x32_bf16 v[84:87], v[100:103], v[196:199], v[84:87]
v_add_f32 v242, v242, v246
s_waitcnt lgkmcnt(1)
v_mfma_f32_16x16x32_bf16 v[48:51], v[116:119], v[104:107], v[48:51]
buffer_load_dwordx4 v4, s[8:11], s59 offen offset:2048 lds
ds_read_b64_tr_b16 v[114:115], v6 offset:512
v_mfma_f32_16x16x32_bf16 v[68:71], v[132:135], v[104:107], v[68:71]
ds_read_b128 v[96:99], v7 offset:8192
s_add_u32 m0, s61, 32768
v_add_f32 v243, v243, v247
v_mfma_f32_16x16x32_bf16 v[88:91], v[104:107], v[196:199], v[88:91]
s_xor_b32 s38, s3, 512
s_add_u32 s38, s38, s56
ds_read_b64_tr_b16 v[136:137], v6 offset:1024
v_mfma_f32_16x16x32_bf16 v[52:55], v[116:119], v[108:111], v[52:55]
ds_read_b64_tr_b16 v[138:139], v6 offset:1536
buffer_load_dwordx4 v2, s[28:31], s38 offen sc1 lds
ds_read_b64_tr_b16 v[200:201], v6 offset:2048
ds_read_b64_tr_b16 v[202:203], v6 offset:2560
ds_read_b128 v[100:103], v7 offset:10240
v_mfma_f32_16x16x32_bf16 v[72:75], v[132:135], v[108:111], v[72:75]
s_waitcnt vmcnt(11)
v_add_f32 v248, v248, v252
v_add_f32 v249, v249, v253
v_add_f32 v250, v250, v254
v_mfma_f32_16x16x32_bf16 v[92:95], v[108:111], v[196:199], v[92:95]
v_add_f32 v251, v251, v255
v_add_f32 v240, v240, v248
s_waitcnt lgkmcnt(0)
v_mfma_f32_16x16x32_bf16 v[40:43], v[112:115], v[96:99], v[40:43]
s_waitcnt vmcnt(9)
s_barrier
buffer_load_dwordx4 v3, s[28:31], s38 offen offset:1024 sc1 lds
v_mfma_f32_16x16x32_bf16 v[60:63], v[136:139], v[96:99], v[60:63]
ds_read_b128 v[104:107], v7 offset:12288
v_add_f32 v241, v241, v249
v_add_f32 v242, v242, v250
v_mfma_f32_16x16x32_bf16 v[80:83], v[96:99], v[200:203], v[80:83]
ds_read_b128 v[108:111], v7 offset:14336
s_add_u32 m0, s84, 98304
v_add_f32 v243, v243, v251
v_mfma_f32_16x16x32_bf16 v[44:47], v[112:115], v[100:103], v[44:47]
s_add_u32 s59, s59, 98304
buffer_load_dwordx4 v4, s[8:11], s59 offen offset:0 lds
v_mfma_f32_16x16x32_bf16 v[64:67], v[136:139], v[100:103], v[64:67]
v_permlane16_swap_b32 v240, v242
v_permlane16_swap_b32 v241, v243
v_add_f32 v240, v240, v242
v_mfma_f32_16x16x32_bf16 v[84:87], v[100:103], v[200:203], v[84:87]
buffer_load_dwordx4 v4, s[8:11], s59 offen offset:1024 lds
s_waitcnt lgkmcnt(0)
v_mfma_f32_16x16x32_bf16 v[48:51], v[112:115], v[104:107], v[48:51]
v_add_f32 v241, v241, v243
s_nop 1
v_permlane32_swap_b32 v240, v241
ds_read_b64_tr_b16 v[116:117], v6 offset:12288
v_mfma_f32_16x16x32_bf16 v[68:71], v[136:139], v[104:107], v[68:71]
ds_read_b128 v[96:99], v8 offset:8192
v_add_f32 v240, v240, v241
ds_read_b64_tr_b16 v[118:119], v6 offset:12800
v_mfma_f32_16x16x32_bf16 v[88:91], v[104:107], v[200:203], v[88:91]
buffer_load_dwordx4 v4, s[8:11], s59 offen offset:2048 lds
v_mov_b32 v241, v240
v_mfma_f32_16x16x32_bf16 v[52:55], v[112:115], v[108:111], v[52:55]
ds_read_b64_tr_b16 v[140:141], v6 offset:13312
ds_read_b64_tr_b16 v[142:143], v6 offset:13824
ds_read_b64_tr_b16 v[204:205], v6 offset:14336
ds_read_b64_tr_b16 v[206:207], v6 offset:14848
ds_read_b128 v[100:103], v8 offset:10240
v_mfma_f32_16x16x32_bf16 v[72:75], v[136:139], v[108:111], v[72:75]
v_permlane32_swap_b32 v240, v241
s_add_u32 m0, s84, 110592
v_mul_f32 v240, 0xbb000000, v240
v_mfma_f32_16x16x32_bf16 v[92:95], v[108:111], v[200:203], v[92:95]
s_xor_b32 s59, s85, 4
s_mul_i32 s59, s59, 196608
buffer_load_dwordx4 v4, s[8:11], s59 offen offset:0 lds
s_waitcnt lgkmcnt(0)
v_mfma_f32_16x16x32_bf16 v[40:43], v[116:119], v[96:99], v[40:43]
v_mul_f32 v241, 0x3b000000, v241
v_fma_f32 v241, -v240, v240, v241
v_max_f32 v241, 0, v241
v_mfma_f32_16x16x32_bf16 v[60:63], v[140:143], v[96:99], v[60:63]
buffer_load_dwordx4 v4, s[8:11], s59 offen offset:1024 lds
ds_read_b128 v[104:107], v8 offset:12288
v_mfma_f32_16x16x32_bf16 v[80:83], v[96:99], v[204:207], v[80:83]
ds_read_b128 v[108:111], v8 offset:14336
v_cvt_pk_bf16_f32 v241, v241, v241
v_and_b32 v241, 0xffff0000, v241
v_mfma_f32_16x16x32_bf16 v[44:47], v[116:119], v[100:103], v[44:47]
v_add_f32 v241, 0x3727c5ac, v241
v_cvt_pk_bf16_f32 v241, v241, v241
v_and_b32 v241, 0xffff0000, v241
v_mfma_f32_16x16x32_bf16 v[64:67], v[140:143], v[100:103], v[64:67]
buffer_load_dwordx4 v4, s[8:11], s59 offen offset:2048 lds
v_mfma_f32_16x16x32_bf16 v[84:87], v[100:103], v[204:207], v[84:87]
v_sqrt_f32 v242, v241
s_waitcnt lgkmcnt(0)
v_mfma_f32_16x16x32_bf16 v[48:51], v[116:119], v[104:107], v[48:51]
s_add_u32 m0, s61, 40960
s_xor_b32 s38, s3, 640
v_cvt_pk_bf16_f32 v240, v240, v240
v_mfma_f32_16x16x32_bf16 v[68:71], v[140:143], v[104:107], v[68:71]
s_add_u32 s38, s38, s56
buffer_load_dwordx4 v2, s[28:31], s38 offen sc1 lds
ds_read_b128 v[96:99], v7 offset:16384
v_mfma_f32_16x16x32_bf16 v[88:91], v[104:107], v[204:207], v[88:91]
v_and_b32 v240, 0xffff0000, v240
ds_read_b64_tr_b16 v[112:113], v6 offset:24576
v_cvt_pk_bf16_f32 v242, v242, v242
v_mfma_f32_16x16x32_bf16 v[52:55], v[116:119], v[108:111], v[52:55]
ds_read_b64_tr_b16 v[114:115], v6 offset:25088
ds_read_b64_tr_b16 v[144:145], v6 offset:25600
ds_read_b64_tr_b16 v[146:147], v6 offset:26112
buffer_load_dwordx4 v3, s[28:31], s38 offen offset:1024 sc1 lds
ds_read_b64_tr_b16 v[208:209], v6 offset:26624
ds_read_b64_tr_b16 v[210:211], v6 offset:27136
ds_read_b128 v[100:103], v7 offset:18432
v_mfma_f32_16x16x32_bf16 v[72:75], v[140:143], v[108:111], v[72:75]
v_and_b32 v242, 0xffff0000, v242
v_rcp_f32 v241, v242
v_mfma_f32_16x16x32_bf16 v[92:95], v[108:111], v[204:207], v[92:95]
v_and_b32 v124, 15, v0
v_lshlrev_b32 v124, 3, v124
s_waitcnt lgkmcnt(0)
v_mfma_f32_16x16x32_bf16 v[40:43], v[112:115], v[96:99], v[40:43]
s_waitcnt vmcnt(10)
s_barrier
s_add_u32 m0, s84, 122880
s_add_u32 s59, s59, 98304
buffer_load_dwordx4 v4, s[8:11], s59 offen offset:0 lds
v_mfma_f32_16x16x32_bf16 v[60:63], v[144:147], v[96:99], v[60:63]
ds_read_b128 v[104:107], v7 offset:20480
v_bfe_u32 v125, v0, 4, 1
v_lshl_add_u32 v124, v125, 2, v124
v_mfma_f32_16x16x32_bf16 v[80:83], v[96:99], v[208:211], v[80:83]
ds_read_b128 v[108:111], v7 offset:22528
s_and_b32 s88, s36, 1
s_lshl_b32 s88, s88, 7
v_mfma_f32_16x16x32_bf16 v[44:47], v[112:115], v[100:103], v[44:47]
buffer_load_dwordx4 v4, s[8:11], s59 offen offset:1024 lds
s_add_u32 s88, s88, 159744
v_mfma_f32_16x16x32_bf16 v[64:67], v[144:147], v[100:103], v[64:67]
v_add_u32 v125, s88, v124
ds_write2_b32 v125, v240, v241 offset0:16 offset1:96
v_mfma_f32_16x16x32_bf16 v[84:87], v[100:103], v[208:211], v[84:87]
s_lshl_b32 s88, s44, 2
s_add_u32 s88, s88, s36
s_cmp_lg_u32 s88, 1
s_cbranch_scc1 Lht15
s_lshl_b32 s88, s41, 7
s_add_u32 s88, s88, 12058528
s_mov_b32 exec_lo, 0xf000f000
s_mov_b32 exec_hi, 0
buffer_store_dword v240, v124, s[28:31], s88 offen sc1
buffer_store_dword v241, v124, s[28:31], s88 offen offset:32 sc1
s_mov_b64 exec, -1
Lht15:
s_waitcnt lgkmcnt(1)
v_mfma_f32_16x16x32_bf16 v[48:51], v[112:115], v[104:107], v[48:51]
buffer_load_dwordx4 v4, s[8:11], s59 offen offset:2048 lds
ds_read_b64_tr_b16 v[116:117], v5 offset:0
v_mfma_f32_16x16x32_bf16 v[68:71], v[144:147], v[104:107], v[68:71]
ds_read_b128 v[96:99], v8 offset:16384
s_add_u32 m0, s84, 135168
ds_read_b64_tr_b16 v[118:119], v5 offset:512
v_mfma_f32_16x16x32_bf16 v[88:91], v[104:107], v[208:211], v[88:91]
s_xor_b32 s59, s85, 5
s_mul_i32 s59, s59, 196608
buffer_load_dwordx4 v4, s[8:11], s59 offen offset:0 lds
v_mfma_f32_16x16x32_bf16 v[52:55], v[112:115], v[108:111], v[52:55]
ds_read_b64_tr_b16 v[148:149], v5 offset:1024
ds_read_b64_tr_b16 v[150:151], v5 offset:1536
ds_read_b64_tr_b16 v[212:213], v5 offset:2048
ds_read_b64_tr_b16 v[214:215], v5 offset:2560
ds_read_b128 v[100:103], v8 offset:18432
v_mfma_f32_16x16x32_bf16 v[72:75], v[144:147], v[108:111], v[72:75]
v_mfma_f32_16x16x32_bf16 v[92:95], v[108:111], v[208:211], v[92:95]
buffer_load_dwordx4 v4, s[8:11], s59 offen offset:1024 lds
s_waitcnt lgkmcnt(0)
v_mfma_f32_16x16x32_bf16 v[40:43], v[116:119], v[96:99], v[40:43]
ds_read_b128 v[104:107], v8 offset:20480
v_mfma_f32_16x16x32_bf16 v[60:63], v[148:151], v[96:99], v[60:63]
ds_read_b128 v[108:111], v8 offset:22528
v_mfma_f32_16x16x32_bf16 v[80:83], v[96:99], v[212:215], v[80:83]
buffer_load_dwordx4 v4, s[8:11], s59 offen offset:2048 lds
v_mfma_f32_16x16x32_bf16 v[44:47], v[116:119], v[100:103], v[44:47]
s_add_u32 m0, s61, 49152
s_xor_b32 s38, s3, 768
v_mfma_f32_16x16x32_bf16 v[64:67], v[148:151], v[100:103], v[64:67]
s_add_u32 s38, s38, s56
buffer_load_dwordx4 v2, s[28:31], s38 offen sc1 lds
v_mfma_f32_16x16x32_bf16 v[84:87], v[100:103], v[212:215], v[84:87]
ds_read_b64_tr_b16 v[112:113], v5 offset:12288
s_waitcnt lgkmcnt(1)
v_mfma_f32_16x16x32_bf16 v[48:51], v[116:119], v[104:107], v[48:51]
ds_read_b64_tr_b16 v[114:115], v5 offset:12800
Lpage7:
s_cbranch_execz Ltour1
ds_read_b64_tr_b16 v[152:153], v5 offset:13312
v_mfma_f32_16x16x32_bf16 v[68:71], v[148:151], v[104:107], v[68:71]
buffer_load_dwordx4 v3, s[28:31], s38 offen offset:1024 sc1 lds
ds_read_b128 v[96:99], v7 offset:24576
v_mfma_f32_16x16x32_bf16 v[88:91], v[104:107], v[212:215], v[88:91]
s_add_u32 m0, s84, 147456
s_add_u32 s59, s59, 98304
ds_read_b64_tr_b16 v[154:155], v5 offset:13824
v_mfma_f32_16x16x32_bf16 v[52:55], v[116:119], v[108:111], v[52:55]
ds_read_b64_tr_b16 v[216:217], v5 offset:14336
ds_read_b64_tr_b16 v[218:219], v5 offset:14848
ds_read_b128 v[100:103], v7 offset:26624
v_mfma_f32_16x16x32_bf16 v[72:75], v[148:151], v[108:111], v[72:75]
buffer_load_dwordx4 v4, s[8:11], s59 offen offset:0 lds
v_mfma_f32_16x16x32_bf16 v[92:95], v[108:111], v[212:215], v[92:95]
ds_read_b128 v[104:107], v7 offset:28672
s_waitcnt lgkmcnt(1)
v_mfma_f32_16x16x32_bf16 v[40:43], v[112:115], v[96:99], v[40:43]
s_waitcnt vmcnt(11)
s_barrier
buffer_load_dwordx4 v4, s[8:11], s59 offen offset:1024 lds
v_mfma_f32_16x16x32_bf16 v[60:63], v[152:155], v[96:99], v[60:63]
ds_read_b128 v[108:111], v7 offset:30720
v_mfma_f32_16x16x32_bf16 v[80:83], v[96:99], v[216:219], v[80:83]
ds_read_b64_tr_b16 v[116:117], v5 offset:24576
ds_read_b64_tr_b16 v[118:119], v5 offset:25088
v_mfma_f32_16x16x32_bf16 v[44:47], v[112:115], v[100:103], v[44:47]
buffer_load_dwordx4 v4, s[8:11], s59 offen offset:2048 lds
v_mfma_f32_16x16x32_bf16 v[64:67], v[152:155], v[100:103], v[64:67]
s_add_u32 m0, s84, 73728
s_xor_b32 s59, s85, 6
v_mfma_f32_16x16x32_bf16 v[84:87], v[100:103], v[216:219], v[84:87]
s_mul_i32 s59, s59, 196608
s_waitcnt lgkmcnt(2)
v_mfma_f32_16x16x32_bf16 v[48:51], v[112:115], v[104:107], v[48:51]
buffer_load_dwordx4 v4, s[8:11], s59 offen offset:0 lds
v_mfma_f32_16x16x32_bf16 v[68:71], v[152:155], v[104:107], v[68:71]
ds_read_b128 v[96:99], v8 offset:24576
ds_read_b64_tr_b16 v[156:157], v5 offset:25600
v_mfma_f32_16x16x32_bf16 v[88:91], v[104:107], v[216:219], v[88:91]
ds_read_b64_tr_b16 v[158:159], v5 offset:26112
v_mfma_f32_16x16x32_bf16 v[52:55], v[112:115], v[108:111], v[52:55]
buffer_load_dwordx4 v4, s[8:11], s59 offen offset:1024 lds
ds_read_b64_tr_b16 v[220:221], v5 offset:26624
ds_read_b64_tr_b16 v[222:223], v5 offset:27136
ds_read_b128 v[100:103], v8 offset:26624
v_mfma_f32_16x16x32_bf16 v[72:75], v[152:155], v[108:111], v[72:75]
ds_read_b128 v[104:107], v8 offset:28672
v_mfma_f32_16x16x32_bf16 v[92:95], v[108:111], v[216:219], v[92:95]
buffer_load_dwordx4 v4, s[8:11], s59 offen offset:2048 lds
s_waitcnt lgkmcnt(1)
v_mfma_f32_16x16x32_bf16 v[40:43], v[116:119], v[96:99], v[40:43]
s_add_u32 m0, s61, 57344
s_xor_b32 s38, s3, 896
v_mfma_f32_16x16x32_bf16 v[60:63], v[156:159], v[96:99], v[60:63]
s_add_u32 s38, s38, s56
ds_read_b128 v[108:111], v8 offset:30720
v_mfma_f32_16x16x32_bf16 v[80:83], v[96:99], v[220:223], v[80:83]
buffer_load_dwordx4 v2, s[28:31], s38 offen sc1 lds
v_mfma_f32_16x16x32_bf16 v[44:47], v[116:119], v[100:103], v[44:47]
ds_read_b64_tr_b16 v[112:113], v5 offset:36864
ds_read_b64_tr_b16 v[114:115], v5 offset:37376
v_mfma_f32_16x16x32_bf16 v[64:67], v[156:159], v[100:103], v[64:67]
ds_read_b64_tr_b16 v[160:161], v5 offset:37888
ds_read_b128 v[96:99], v7 offset:32768
v_mfma_f32_16x16x32_bf16 v[84:87], v[100:103], v[220:223], v[84:87]
buffer_load_dwordx4 v3, s[28:31], s38 offen offset:1024 sc1 lds
s_waitcnt lgkmcnt(4)
v_mfma_f32_16x16x32_bf16 v[48:51], v[116:119], v[104:107], v[48:51]
s_add_u32 m0, s84, 86016
s_add_u32 s59, s59, 98304
v_mfma_f32_16x16x32_bf16 v[68:71], v[156:159], v[104:107], v[68:71]
buffer_load_dwordx4 v4, s[8:11], s59 offen offset:0 lds
v_mfma_f32_16x16x32_bf16 v[88:91], v[104:107], v[220:223], v[88:91]
ds_read_b64_tr_b16 v[162:163], v5 offset:38400
ds_read_b64_tr_b16 v[224:225], v5 offset:38912
v_mfma_f32_16x16x32_bf16 v[52:55], v[116:119], v[108:111], v[52:55]
ds_read_b64_tr_b16 v[226:227], v5 offset:39424
ds_read_b128 v[100:103], v7 offset:34816
v_mfma_f32_16x16x32_bf16 v[72:75], v[156:159], v[108:111], v[72:75]
buffer_load_dwordx4 v4, s[8:11], s59 offen offset:1024 lds
v_mfma_f32_16x16x32_bf16 v[92:95], v[108:111], v[220:223], v[92:95]
ds_read_b128 v[104:107], v7 offset:36864
s_waitcnt lgkmcnt(1)
v_mfma_f32_16x16x32_bf16 v[40:43], v[112:115], v[96:99], v[40:43]
s_waitcnt vmcnt(12)
s_barrier
v_mfma_f32_16x16x32_bf16 v[60:63], v[160:163], v[96:99], v[60:63]
buffer_load_dwordx4 v4, s[8:11], s59 offen offset:2048 lds
v_mfma_f32_16x16x32_bf16 v[80:83], v[96:99], v[224:227], v[80:83]
ds_read_b128 v[108:111], v7 offset:38912
s_add_u32 m0, s84, 98304
v_mfma_f32_16x16x32_bf16 v[44:47], v[112:115], v[100:103], v[44:47]
s_xor_b32 s59, s85, 7
s_mul_i32 s59, s59, 196608
buffer_load_dwordx4 v4, s[8:11], s59 offen offset:0 lds
v_mfma_f32_16x16x32_bf16 v[64:67], v[160:163], v[100:103], v[64:67]
ds_read_b64_tr_b16 v[116:117], v6 offset:0
ds_read_b64_tr_b16 v[118:119], v6 offset:512
v_mfma_f32_16x16x32_bf16 v[84:87], v[100:103], v[224:227], v[84:87]
ds_read_b64_tr_b16 v[164:165], v6 offset:1024
s_waitcnt lgkmcnt(3)
v_mfma_f32_16x16x32_bf16 v[48:51], v[112:115], v[104:107], v[48:51]
buffer_load_dwordx4 v4, s[8:11], s59 offen offset:1024 lds
v_mfma_f32_16x16x32_bf16 v[68:71], v[160:163], v[104:107], v[68:71]
ds_read_b128 v[96:99], v8 offset:32768
v_mfma_f32_16x16x32_bf16 v[88:91], v[104:107], v[224:227], v[88:91]
ds_read_b64_tr_b16 v[166:167], v6 offset:1536
ds_read_b64_tr_b16 v[228:229], v6 offset:2048
v_mfma_f32_16x16x32_bf16 v[52:55], v[112:115], v[108:111], v[52:55]
buffer_load_dwordx4 v4, s[8:11], s59 offen offset:2048 lds
ds_read_b64_tr_b16 v[230:231], v6 offset:2560
ds_read_b128 v[100:103], v8 offset:34816
v_mfma_f32_16x16x32_bf16 v[72:75], v[160:163], v[108:111], v[72:75]
s_add_u32 m0, s84, 110592
s_add_u32 s59, s59, 98304
v_mfma_f32_16x16x32_bf16 v[92:95], v[108:111], v[224:227], v[92:95]
ds_read_b128 v[104:107], v8 offset:36864
s_waitcnt lgkmcnt(1)
v_mfma_f32_16x16x32_bf16 v[40:43], v[116:119], v[96:99], v[40:43]
buffer_load_dwordx4 v4, s[8:11], s59 offen offset:0 lds
v_mfma_f32_16x16x32_bf16 v[60:63], v[164:167], v[96:99], v[60:63]
ds_read_b128 v[108:111], v8 offset:38912
s_mul_i32 s79, s41, 229376
v_mfma_f32_16x16x32_bf16 v[80:83], v[96:99], v[228:231], v[80:83]
buffer_load_dwordx4 v4, s[8:11], s59 offen offset:1024 lds
v_mfma_f32_16x16x32_bf16 v[44:47], v[116:119], v[100:103], v[44:47]
s_lshl_b32 s80, s44, 12
s_add_u32 s79, s79, s80
v_mfma_f32_16x16x32_bf16 v[64:67], v[164:167], v[100:103], v[64:67]
ds_read_b64_tr_b16 v[112:113], v6 offset:12288
s_add_u32 s79, s79, s45
v_mfma_f32_16x16x32_bf16 v[84:87], v[100:103], v[228:231], v[84:87]
buffer_load_dwordx4 v4, s[8:11], s59 offen offset:2048 lds
s_waitcnt lgkmcnt(1)
v_mfma_f32_16x16x32_bf16 v[48:51], v[116:119], v[104:107], v[48:51]
s_add_u32 s79, s79, 16777216
ds_read_b64_tr_b16 v[114:115], v6 offset:12800
s_add_u32 s80, s79, 114688
v_mfma_f32_16x16x32_bf16 v[68:71], v[164:167], v[104:107], v[68:71]
ds_read_b128 v[96:99], v7 offset:40960
v_and_b32 v121, 7, v0
v_lshlrev_b32 v121, 7, v121
v_mfma_f32_16x16x32_bf16 v[88:91], v[104:107], v[228:231], v[88:91]
ds_read_b64_tr_b16 v[168:169], v6 offset:13312
v_bfe_u32 v34, v0, 3, 1
v_mul_u32_u24 v34, 114688, v34
v_mfma_f32_16x16x32_bf16 v[52:55], v[116:119], v[108:111], v[52:55]
ds_read_b64_tr_b16 v[170:171], v6 offset:13824
ds_read_b64_tr_b16 v[232:233], v6 offset:14336
ds_read_b64_tr_b16 v[234:235], v6 offset:14848
ds_read_b128 v[100:103], v7 offset:43008
v_mfma_f32_16x16x32_bf16 v[72:75], v[164:167], v[108:111], v[72:75]
v_add_u32 v121, v121, v34
s_add_u32 m0, s61, 65536
v_mfma_f32_16x16x32_bf16 v[92:95], v[108:111], v[228:231], v[92:95]
s_mov_b64 exec, 65535
buffer_load_dword v34, v121, s[28:31], s79 offen sc1
s_mov_b64 exec, -1
s_lshl_b32 s88, s57, 15
s_lshl_b32 s89, s44, 12
s_add_u32 s88, s88, s89
s_and_b32 s89, s45, 2048
s_add_u32 s88, s88, s89
s_add_u32 s88, s88, 4194304
v_lshlrev_b32 v121, 7, v0
s_mov_b64 exec, 65535
buffer_load_dword v34, v121, s[28:31], s88 offen sc1
s_mov_b64 exec, -1
s_lshl_b32 s88, s57, 12
s_lshl_b32 s89, s44, 9
s_add_u32 s88, s88, s89
s_lshr_b32 s89, s36, 1
s_lshl_b32 s89, s89, 8
s_add_u32 s88, s88, s89
s_add_u32 s88, s88, 10485760
s_mov_b64 exec, 3
buffer_load_dword v34, v121, s[28:31], s88 offen sc1
s_mov_b64 exec, -1
s_waitcnt lgkmcnt(0)
v_mfma_f32_16x16x32_bf16 v[40:43], v[112:115], v[96:99], v[40:43]
s_waitcnt vmcnt(14)
s_barrier
s_lshl_b32 s38, s36, 8
s_add_u32 s38, s38, 0
s_xor_b32 s38, s38, s3
s_lshl_b32 s38, s38, 3
s_add_u32 s38, s38, s78
buffer_load_dwordx4 v120, s[28:31], s38 offen sc1 lds
v_mfma_f32_16x16x32_bf16 v[60:63], v[168:171], v[96:99], v[60:63]
ds_read_b128 v[104:107], v7 offset:45056
s_add_u32 m0, s61, 66560
v_mfma_f32_16x16x32_bf16 v[80:83], v[96:99], v[232:235], v[80:83]
s_lshl_b32 s38, s36, 8
s_add_u32 s38, s38, 128
s_xor_b32 s38, s38, s3
s_lshl_b32 s38, s38, 3
s_add_u32 s38, s38, s78
buffer_load_dwordx4 v120, s[28:31], s38 offen sc1 lds
ds_read_b128 v[108:111], v7 offset:47104
v_mfma_f32_16x16x32_bf16 v[44:47], v[112:115], v[100:103], v[44:47]
s_lshl_b32 s88, s48, 7
ds_read_b64_tr_b16 v[116:117], v6 offset:24576
v_mfma_f32_16x16x32_bf16 v[64:67], v[168:171], v[100:103], v[64:67]
s_add_u32 s94, s88, 12058624
ds_read_b64_tr_b16 v[118:119], v6 offset:25088
v_mfma_f32_16x16x32_bf16 v[84:87], v[100:103], v[232:235], v[84:87]
s_cmp_eq_u32 s47, 0
s_cselect_b32 s94, 0x7ff00000, s94
s_waitcnt lgkmcnt(2)
v_mfma_f32_16x16x32_bf16 v[48:51], v[112:115], v[104:107], v[48:51]
ds_read_b64_tr_b16 v[172:173], v6 offset:25600
ds_read_b128 v[96:99], v8 offset:40960
v_mfma_f32_16x16x32_bf16 v[68:71], v[168:171], v[104:107], v[68:71]
v_and_b32 v124, 15, v0
ds_read_b64_tr_b16 v[174:175], v6 offset:26112
v_mfma_f32_16x16x32_bf16 v[88:91], v[104:107], v[232:235], v[88:91]
v_lshlrev_b32 v124, 2, v124
ds_read_b64_tr_b16 v[236:237], v6 offset:26624
v_mfma_f32_16x16x32_bf16 v[52:55], v[112:115], v[108:111], v[52:55]
ds_read_b64_tr_b16 v[238:239], v6 offset:27136
ds_read_b128 v[100:103], v8 offset:43008
v_mfma_f32_16x16x32_bf16 v[72:75], v[168:171], v[108:111], v[72:75]
ds_read_b128 v[104:107], v8 offset:45056
v_mfma_f32_16x16x32_bf16 v[92:95], v[108:111], v[232:235], v[92:95]
s_waitcnt lgkmcnt(1)
v_mfma_f32_16x16x32_bf16 v[40:43], v[116:119], v[96:99], v[40:43]
ds_read_b128 v[108:111], v8 offset:47104
v_mfma_f32_16x16x32_bf16 v[60:63], v[172:175], v[96:99], v[60:63]
ds_read_b64_tr_b16 v[112:113], v5 offset:0
v_mfma_f32_16x16x32_bf16 v[80:83], v[96:99], v[236:239], v[80:83]
ds_read_b64_tr_b16 v[114:115], v5 offset:512
v_mfma_f32_16x16x32_bf16 v[44:47], v[116:119], v[100:103], v[44:47]
ds_read_b64_tr_b16 v[176:177], v5 offset:1024
ds_read_b128 v[96:99], v7 offset:49152
v_mfma_f32_16x16x32_bf16 v[64:67], v[172:175], v[100:103], v[64:67]
ds_read_b64_tr_b16 v[178:179], v5 offset:1536
v_mfma_f32_16x16x32_bf16 v[84:87], v[100:103], v[236:239], v[84:87]
ds_read_b64_tr_b16 v[240:241], v5 offset:2048
s_waitcnt lgkmcnt(6)
v_mfma_f32_16x16x32_bf16 v[48:51], v[116:119], v[104:107], v[48:51]
ds_read_b64_tr_b16 v[242:243], v5 offset:2560
ds_read_b128 v[100:103], v7 offset:51200
v_mfma_f32_16x16x32_bf16 v[68:71], v[172:175], v[104:107], v[68:71]
v_mfma_f32_16x16x32_bf16 v[88:91], v[104:107], v[236:239], v[88:91]
v_mfma_f32_16x16x32_bf16 v[52:55], v[116:119], v[108:111], v[52:55]
ds_read_b128 v[104:107], v7 offset:53248
v_mfma_f32_16x16x32_bf16 v[72:75], v[172:175], v[108:111], v[72:75]
v_mfma_f32_16x16x32_bf16 v[92:95], v[108:111], v[236:239], v[92:95]
s_waitcnt lgkmcnt(1)
v_mfma_f32_16x16x32_bf16 v[40:43], v[112:115], v[96:99], v[40:43]
s_waitcnt vmcnt(8)
s_barrier
buffer_load_dword v125, v124, s[28:31], s94 offen sc1
s_add_u32 s88, s61, 65536
v_add_u32 v121, s88, v1
v_mfma_f32_16x16x32_bf16 v[60:63], v[176:179], v[96:99], v[60:63]
v_and_b32 v126, 7, v0
v_lshlrev_b32 v126, 2, v126
v_bfe_u32 v127, v0, 3, 1
v_mfma_f32_16x16x32_bf16 v[80:83], v[96:99], v[240:243], v[80:83]
ds_read_b128 v[108:111], v7 offset:55296
v_mul_u32_u24 v127, 320, v127
v_add_u32 v126, v126, v127
v_mfma_f32_16x16x32_bf16 v[44:47], v[112:115], v[100:103], v[44:47]
v_bfe_u32 v127, v0, 4, 1
v_lshl_add_u32 v126, v127, 5, v126
v_add_u32 v126, 159744, v126
v_mfma_f32_16x16x32_bf16 v[64:67], v[176:179], v[100:103], v[64:67]
ds_read_b64_tr_b16 v[116:117], v5 offset:12288
ds_read_b64_tr_b16 v[118:119], v5 offset:12800
v_mfma_f32_16x16x32_bf16 v[84:87], v[100:103], v[240:243], v[84:87]
ds_read_b64_tr_b16 v[180:181], v5 offset:13312
s_waitcnt lgkmcnt(3)
v_mfma_f32_16x16x32_bf16 v[48:51], v[112:115], v[104:107], v[48:51]
ds_read_b128 v[96:99], v8 offset:49152
v_mfma_f32_16x16x32_bf16 v[68:71], v[176:179], v[104:107], v[68:71]
ds_read_b64_tr_b16 v[182:183], v5 offset:13824
ds_read_b64_tr_b16 v[244:245], v5 offset:14336
v_mfma_f32_16x16x32_bf16 v[88:91], v[104:107], v[240:243], v[88:91]
ds_read_b64_tr_b16 v[246:247], v5 offset:14848
ds_read_b128 v[100:103], v8 offset:51200
v_mfma_f32_16x16x32_bf16 v[52:55], v[112:115], v[108:111], v[52:55]
ds_read_b128 v[104:107], v8 offset:53248
v_mfma_f32_16x16x32_bf16 v[72:75], v[176:179], v[108:111], v[72:75]
v_mfma_f32_16x16x32_bf16 v[92:95], v[108:111], v[240:243], v[92:95]
s_waitcnt lgkmcnt(1)
v_mfma_f32_16x16x32_bf16 v[40:43], v[116:119], v[96:99], v[40:43]
ds_read_b128 v[108:111], v8 offset:55296
v_mfma_f32_16x16x32_bf16 v[60:63], v[180:183], v[96:99], v[60:63]
ds_read_b64_tr_b16 v[112:113], v5 offset:24576
v_mfma_f32_16x16x32_bf16 v[80:83], v[96:99], v[244:247], v[80:83]
ds_read_b64_tr_b16 v[114:115], v5 offset:25088
v_mfma_f32_16x16x32_bf16 v[44:47], v[116:119], v[100:103], v[44:47]
ds_read_b64_tr_b16 v[184:185], v5 offset:25600
ds_read_b128 v[96:99], v7 offset:57344
v_mfma_f32_16x16x32_bf16 v[64:67], v[180:183], v[100:103], v[64:67]
ds_read_b64_tr_b16 v[186:187], v5 offset:26112
v_mfma_f32_16x16x32_bf16 v[84:87], v[100:103], v[244:247], v[84:87]
ds_read_b64_tr_b16 v[248:249], v5 offset:26624
s_waitcnt lgkmcnt(6)
v_mfma_f32_16x16x32_bf16 v[48:51], v[116:119], v[104:107], v[48:51]
ds_read_b64_tr_b16 v[250:251], v5 offset:27136
ds_read_b128 v[100:103], v7 offset:59392
v_mfma_f32_16x16x32_bf16 v[68:71], v[180:183], v[104:107], v[68:71]
v_mfma_f32_16x16x32_bf16 v[88:91], v[104:107], v[244:247], v[88:91]
v_mfma_f32_16x16x32_bf16 v[52:55], v[116:119], v[108:111], v[52:55]
ds_read_b128 v[104:107], v7 offset:61440
v_mfma_f32_16x16x32_bf16 v[72:75], v[180:183], v[108:111], v[72:75]
v_mfma_f32_16x16x32_bf16 v[92:95], v[108:111], v[244:247], v[92:95]
s_waitcnt lgkmcnt(1)
v_mfma_f32_16x16x32_bf16 v[40:43], v[112:115], v[96:99], v[40:43]
s_waitcnt vmcnt(6)
s_barrier
v_mfma_f32_16x16x32_bf16 v[60:63], v[184:187], v[96:99], v[60:63]
s_waitcnt vmcnt(1)
ds_read_b32 v122, v121 offset:0
ds_read_b32 v123, v121 offset:1024
v_mfma_f32_16x16x32_bf16 v[80:83], v[96:99], v[248:251], v[80:83]
ds_read_b128 v[108:111], v7 offset:63488
v_mfma_f32_16x16x32_bf16 v[44:47], v[112:115], v[100:103], v[44:47]
ds_read_b64_tr_b16 v[116:117], v5 offset:36864
ds_read_b64_tr_b16 v[118:119], v5 offset:37376
v_mfma_f32_16x16x32_bf16 v[64:67], v[184:187], v[100:103], v[64:67]
ds_read_b64_tr_b16 v[188:189], v5 offset:37888
ds_read_b128 v[96:99], v8 offset:57344
v_mfma_f32_16x16x32_bf16 v[84:87], v[100:103], v[248:251], v[84:87]
s_waitcnt lgkmcnt(5)
v_max_u32 v122, v122, v123
v_cmp_eq_u32 vcc, -1, v122
s_nop 0
s_and_b64 vcc, vcc, exec
s_cbranch_scc1 Ls16
Lb17:
s_waitcnt lgkmcnt(4)
v_mfma_f32_16x16x32_bf16 v[48:51], v[112:115], v[104:107], v[48:51]
ds_read_b64_tr_b16 v[190:191], v5 offset:38400
ds_read_b64_tr_b16 v[252:253], v5 offset:38912
v_mfma_f32_16x16x32_bf16 v[68:71], v[184:187], v[104:107], v[68:71]
ds_read_b64_tr_b16 v[254:255], v5 offset:39424
ds_read_b128 v[100:103], v8 offset:59392
v_mfma_f32_16x16x32_bf16 v[88:91], v[104:107], v[248:251], v[88:91]
s_waitcnt vmcnt(0)
v_cmp_eq_u32 vcc, -1, v125
s_nop 0
s_and_b64 vcc, vcc, exec
s_cbranch_scc1 Ls18
Lb19:
v_mfma_f32_16x16x32_bf16 v[52:55], v[112:115], v[108:111], v[52:55]
ds_write_b32 v126, v125
v_and_b32 v122, 1023, v7
v_mfma_f32_16x16x32_bf16 v[72:75], v[184:187], v[108:111], v[72:75]
v_not_b32 v123, v0
v_and_b32 v123, 8, v123
v_mfma_f32_16x16x32_bf16 v[92:95], v[108:111], v[248:251], v[92:95]
v_lshlrev_b32 v123, 3, v123
s_waitcnt lgkmcnt(1)
v_mfma_f32_16x16x32_bf16 v[40:43], v[116:119], v[96:99], v[40:43]
s_waitcnt lgkmcnt(0)
s_barrier
v_xor_b32 v122, v122, v123
v_add_u32 v122, 65536, v122
v_xor_b32 v123, 64, v122
s_mul_i32 s93, s36, 122880
v_add_u32 v36, s93, v9
v_add_u32 v37, 7168, v36
v_add_u32 v10, 14336, v36
v_add_u32 v121, 21504, v36
s_lshl_b32 s93, s36, 14
v_mfma_f32_16x16x32_bf16 v[60:63], v[188:191], v[96:99], v[60:63]
ds_read_b128 v[104:107], v8 offset:61440
s_add_u32 m0, s93, 94208
v_mfma_f32_16x16x32_bf16 v[80:83], v[96:99], v[252:255], v[80:83]
ds_read_b128 v[108:111], v8 offset:63488
s_mov_b32 s38, 0
v_mfma_f32_16x16x32_bf16 v[44:47], v[116:119], v[100:103], v[44:47]
buffer_load_dwordx4 v36, s[12:15], s38 offen offset:0 lds
v_mfma_f32_16x16x32_bf16 v[64:67], v[188:191], v[100:103], v[64:67]
v_add_u32 v126, 94208, v11
s_and_b32 s88, s36, 1
v_mfma_f32_16x16x32_bf16 v[84:87], v[100:103], v[252:255], v[84:87]
buffer_load_dwordx4 v37, s[12:15], s38 offen offset:1024 lds
s_waitcnt lgkmcnt(0)
v_mfma_f32_16x16x32_bf16 v[48:51], v[116:119], v[104:107], v[48:51]
ds_read_b128 v[96:99], v122 offset:0
s_lshl_b32 s88, s88, 15
v_mfma_f32_16x16x32_bf16 v[68:71], v[188:191], v[104:107], v[68:71]
v_add_u32 v127, s88, v1
s_lshr_b32 s89, s36, 1
v_mfma_f32_16x16x32_bf16 v[88:91], v[104:107], v[252:255], v[88:91]
ds_read_b128 v[100:103], v123 offset:0
s_lshl_b32 s40, s89, 12
v_mfma_f32_16x16x32_bf16 v[52:55], v[116:119], v[108:111], v[52:55]
buffer_load_dwordx4 v10, s[12:15], s38 offen offset:2048 lds
v_mfma_f32_16x16x32_bf16 v[72:75], v[188:191], v[108:111], v[72:75]
s_add_u32 s40, s40, s88
ds_read_b128 v[104:107], v122 offset:1024
v_mfma_f32_16x16x32_bf16 v[92:95], v[108:111], v[252:255], v[92:95]
s_mul_i32 s88, s57, 114688
s_waitcnt lgkmcnt(2)
v_mfma_f32_16x16x32_bf16 v[56:59], v[128:131], v[96:99], 0
buffer_load_dwordx4 v121, s[12:15], s38 offen offset:3072 lds
v_mfma_f32_16x16x32_bf16 v[76:79], v[96:99], v[192:195], 0
s_add_u32 s88, s88, 16777216
s_add_u32 m0, s93, 98304
s_waitcnt lgkmcnt(1)
v_mfma_f32_16x16x32_bf16 v[56:59], v[132:135], v[100:103], v[56:59]
ds_read_b128 v[108:111], v123 offset:1024
s_mov_b32 s38, 32768
v_mfma_f32_16x16x32_bf16 v[76:79], v[100:103], v[196:199], v[76:79]
buffer_load_dwordx4 v36, s[12:15], s38 offen offset:0 lds
s_waitcnt lgkmcnt(1)
v_mfma_f32_16x16x32_bf16 v[56:59], v[136:139], v[104:107], v[56:59]
ds_read_b128 v[96:99], v122 offset:2048
s_add_u32 s67, s89, 0
v_mfma_f32_16x16x32_bf16 v[76:79], v[104:107], v[200:203], v[76:79]
s_lshl_b32 s67, s67, 12
s_add_u32 s67, s67, s88
s_waitcnt lgkmcnt(1)
v_mfma_f32_16x16x32_bf16 v[56:59], v[140:143], v[108:111], v[56:59]
ds_read_b128 v[100:103], v123 offset:2048
s_add_u32 s68, s89, 2
v_mfma_f32_16x16x32_bf16 v[76:79], v[108:111], v[204:207], v[76:79]
s_lshl_b32 s68, s68, 12
s_add_u32 s68, s68, s88
s_waitcnt lgkmcnt(1)
v_mfma_f32_16x16x32_bf16 v[56:59], v[144:147], v[96:99], v[56:59]
ds_read_b128 v[104:107], v122 offset:3072
v_and_b32 v192, 15, v0
v_mfma_f32_16x16x32_bf16 v[76:79], v[96:99], v[208:211], v[76:79]
buffer_load_dwordx4 v37, s[12:15], s38 offen offset:1024 lds
s_waitcnt lgkmcnt(1)
v_mfma_f32_16x16x32_bf16 v[56:59], v[148:151], v[100:103], v[56:59]
ds_read_b128 v[108:111], v123 offset:3072
v_lshrrev_b32 v193, 4, v0
v_mfma_f32_16x16x32_bf16 v[76:79], v[100:103], v[212:215], v[76:79]
buffer_load_dwordx4 v10, s[12:15], s38 offen offset:2048 lds
s_waitcnt lgkmcnt(1)
v_mfma_f32_16x16x32_bf16 v[56:59], v[152:155], v[104:107], v[56:59]
ds_read_b128 v[96:99], v122 offset:4096
v_lshlrev_b32 v142, 2, v192
v_mfma_f32_16x16x32_bf16 v[76:79], v[104:107], v[216:219], v[76:79]
buffer_load_dwordx4 v121, s[12:15], s38 offen offset:3072 lds
v_add_u32 v142, 159744, v142
s_waitcnt lgkmcnt(1)
v_mfma_f32_16x16x32_bf16 v[56:59], v[156:159], v[108:111], v[56:59]
ds_read_b128 v[100:103], v123 offset:4096
v_lshlrev_b32 v143, 4, v193
v_add_u32 v143, 159744, v143
v_mfma_f32_16x16x32_bf16 v[76:79], v[108:111], v[220:223], v[76:79]
v_lshlrev_b32 v193, 2, v193
v_sub_u32 v192, v192, v193
v_mov_b32 v196, 0xff800000
s_waitcnt lgkmcnt(1)
v_mfma_f32_16x16x32_bf16 v[56:59], v[160:163], v[96:99], v[56:59]
ds_read_b128 v[104:107], v122 offset:5120
v_mov_b32 v197, 0xffff
v_mov_b32 v198, 0xffff0000
v_mfma_f32_16x16x32_bf16 v[76:79], v[96:99], v[224:227], v[76:79]
s_add_u32 m0, s93, 102400
s_mov_b32 s38, 65536
s_waitcnt lgkmcnt(1)
v_mfma_f32_16x16x32_bf16 v[56:59], v[164:167], v[100:103], v[56:59]
ds_read_b128 v[108:111], v123 offset:5120
s_cmp_eq_u32 s47, 0
s_cselect_b64 s[88:89], 0, -1
v_mfma_f32_16x16x32_bf16 v[76:79], v[100:103], v[228:231], v[76:79]
buffer_load_dwordx4 v36, s[12:15], s38 offen offset:0 lds
v_subrev_u32 v193, 0, v192
s_waitcnt lgkmcnt(1)
v_mfma_f32_16x16x32_bf16 v[56:59], v[168:171], v[104:107], v[56:59]
ds_read_b128 v[96:99], v122 offset:6144
v_add_u32 v199, 16, v193
v_cmp_gt_u32 vcc, 8, v193
v_mfma_f32_16x16x32_bf16 v[76:79], v[104:107], v[232:235], v[76:79]
v_cmp_gt_u32 s[90:91], 8, v199
v_cndmask_b32 v128, v196, 0, vcc
v_cndmask_b32 v200, 0, v197, vcc
s_waitcnt lgkmcnt(1)
v_mfma_f32_16x16x32_bf16 v[56:59], v[172:175], v[108:111], v[56:59]
ds_read_b128 v[100:103], v123 offset:6144
v_cndmask_b32 v132, v196, 0, s[90:91]
v_cndmask_b32 v136, v196, v132, s[88:89]
v_mfma_f32_16x16x32_bf16 v[76:79], v[108:111], v[236:239], v[76:79]
buffer_load_dwordx4 v37, s[12:15], s38 offen offset:1024 lds
v_subrev_u32 v193, 1, v192
s_waitcnt lgkmcnt(1)
v_mfma_f32_16x16x32_bf16 v[56:59], v[176:179], v[96:99], v[56:59]
ds_read_b128 v[104:107], v122 offset:7168
v_add_u32 v199, 16, v193
v_cmp_gt_u32 vcc, 8, v193
v_mfma_f32_16x16x32_bf16 v[76:79], v[96:99], v[240:243], v[76:79]
v_cmp_gt_u32 s[90:91], 8, v199
v_cndmask_b32 v129, v196, 0, vcc
v_cndmask_b32 v201, 0, v198, vcc
s_waitcnt lgkmcnt(1)
v_mfma_f32_16x16x32_bf16 v[56:59], v[180:183], v[100:103], v[56:59]
ds_read_b128 v[108:111], v123 offset:7168
v_cndmask_b32 v133, v196, 0, s[90:91]
v_cndmask_b32 v137, v196, v133, s[88:89]
v_mfma_f32_16x16x32_bf16 v[76:79], v[100:103], v[244:247], v[76:79]
buffer_load_dwordx4 v10, s[12:15], s38 offen offset:2048 lds
ds_read2_b32 v[144:145], v142 offset0:0 offset1:80
s_waitcnt lgkmcnt(2)
v_mfma_f32_16x16x32_bf16 v[56:59], v[184:187], v[104:107], v[56:59]
v_subrev_u32 v193, 2, v192
v_add_u32 v199, 16, v193
v_cmp_gt_u32 vcc, 8, v193
v_mfma_f32_16x16x32_bf16 v[76:79], v[104:107], v[248:251], v[76:79]
v_cmp_gt_u32 s[90:91], 8, v199
v_cndmask_b32 v130, v196, 0, vcc
v_cndmask_b32 v202, 0, v197, vcc
v_cndmask_b32 v134, v196, 0, s[90:91]
v_cndmask_b32 v138, v196, v134, s[88:89]
v_subrev_u32 v193, 3, v192
v_add_u32 v199, 16, v193
v_cmp_gt_u32 vcc, 8, v193
v_cmp_gt_u32 s[90:91], 8, v199
s_nop 0
v_cndmask_b32 v131, v196, 0, vcc
v_cndmask_b32 v203, 0, v198, vcc
v_cndmask_b32 v135, v196, 0, s[90:91]
v_cndmask_b32 v139, v196, v135, s[88:89]
v_or_b32 v140, v200, v201
v_or_b32 v141, v202, v203
s_waitcnt lgkmcnt(1)
v_mfma_f32_16x16x32_bf16 v[56:59], v[188:191], v[108:111], v[56:59]
ds_read2_b32 v[146:147], v142 offset0:16 offset1:96
buffer_load_dwordx4 v121, s[12:15], s38 offen offset:3072 lds
ds_read2_b32 v[148:149], v142 offset0:32 offset1:112
ds_read2_b32 v[150:151], v142 offset0:48 offset1:128
ds_read2_b32 v[152:153], v142 offset0:64 offset1:144
v_mfma_f32_16x16x32_bf16 v[76:79], v[108:111], v[252:255], v[76:79]
ds_read_b128 v[154:157], v143 offset:0
ds_read_b128 v[158:161], v143 offset:320
ds_read_b128 v[162:165], v143 offset:64
ds_read_b128 v[166:169], v143 offset:384
ds_read_b128 v[170:173], v143 offset:128
ds_read_b128 v[174:177], v143 offset:448
ds_read_b128 v[178:181], v143 offset:192
ds_read_b128 v[182:185], v143 offset:512
ds_read_b128 v[186:189], v143 offset:256
ds_read_b128 v[190:193], v143 offset:576
s_waitcnt lgkmcnt(14)
v_pk_fma_f32 v[56:57], v[28:29], v[144:145], v[56:57] op_sel_hi:[1,0,1]
v_pk_fma_f32 v[58:59], v[30:31], v[144:145], v[58:59] op_sel_hi:[1,0,1]
v_pk_mul_f32 v[56:57], v[56:57], v[144:145] op_sel:[0,1] op_sel_hi:[1,1]
v_pk_mul_f32 v[58:59], v[58:59], v[144:145] op_sel:[0,1] op_sel_hi:[1,1]
v_cvt_pk_bf16_f32 v210, v56, v57
v_cvt_pk_bf16_f32 v211, v58, v59
s_waitcnt lgkmcnt(13)
v_pk_fma_f32 v[60:61], v[28:29], v[146:147], v[60:61] op_sel_hi:[1,0,1]
v_pk_fma_f32 v[62:63], v[30:31], v[146:147], v[62:63] op_sel_hi:[1,0,1]
v_pk_fma_f32 v[40:41], v[24:25], v[146:147], v[40:41] op_sel_hi:[1,0,1]
v_pk_fma_f32 v[42:43], v[26:27], v[146:147], v[42:43] op_sel_hi:[1,0,1]
v_pk_mul_f32 v[60:61], v[60:61], v[146:147] op_sel:[0,1] op_sel_hi:[1,1]
v_pk_mul_f32 v[62:63], v[62:63], v[146:147] op_sel:[0,1] op_sel_hi:[1,1]
v_cvt_pk_bf16_f32 v202, v40, v41
v_cvt_pk_bf16_f32 v203, v42, v43
v_cvt_pk_bf16_f32 v212, v60, v61
v_cvt_pk_bf16_f32 v213, v62, v63
s_waitcnt lgkmcnt(12)
v_pk_fma_f32 v[64:65], v[28:29], v[148:149], v[64:65] op_sel_hi:[1,0,1]
v_pk_fma_f32 v[66:67], v[30:31], v[148:149], v[66:67] op_sel_hi:[1,0,1]
v_pk_fma_f32 v[44:45], v[24:25], v[148:149], v[44:45] op_sel_hi:[1,0,1]
v_pk_fma_f32 v[46:47], v[26:27], v[148:149], v[46:47] op_sel_hi:[1,0,1]
v_pk_mul_f32 v[64:65], v[64:65], v[148:149] op_sel:[0,1] op_sel_hi:[1,1]
v_pk_mul_f32 v[66:67], v[66:67], v[148:149] op_sel:[0,1] op_sel_hi:[1,1]
v_cvt_pk_bf16_f32 v204, v44, v45
v_cvt_pk_bf16_f32 v205, v46, v47
v_cvt_pk_bf16_f32 v214, v64, v65
v_cvt_pk_bf16_f32 v215, v66, v67
s_waitcnt lgkmcnt(11)
v_pk_fma_f32 v[68:69], v[28:29], v[150:151], v[68:69] op_sel_hi:[1,0,1]
v_pk_fma_f32 v[70:71], v[30:31], v[150:151], v[70:71] op_sel_hi:[1,0,1]
v_pk_fma_f32 v[48:49], v[24:25], v[150:151], v[48:49] op_sel_hi:[1,0,1]
v_pk_fma_f32 v[50:51], v[26:27], v[150:151], v[50:51] op_sel_hi:[1,0,1]
v_pk_mul_f32 v[68:69], v[68:69], v[150:151] op_sel:[0,1] op_sel_hi:[1,1]
v_pk_mul_f32 v[70:71], v[70:71], v[150:151] op_sel:[0,1] op_sel_hi:[1,1]
v_cvt_pk_bf16_f32 v206, v48, v49
v_cvt_pk_bf16_f32 v207, v50, v51
v_cvt_pk_bf16_f32 v216, v68, v69
v_cvt_pk_bf16_f32 v217, v70, v71
s_waitcnt lgkmcnt(10)
v_pk_fma_f32 v[72:73], v[28:29], v[152:153], v[72:73] op_sel_hi:[1,0,1]
v_pk_fma_f32 v[74:75], v[30:31], v[152:153], v[74:75] op_sel_hi:[1,0,1]
v_pk_fma_f32 v[52:53], v[24:25], v[152:153], v[52:53] op_sel_hi:[1,0,1]
v_pk_fma_f32 v[54:55], v[26:27], v[152:153], v[54:55] op_sel_hi:[1,0,1]
v_pk_mul_f32 v[72:73], v[72:73], v[152:153] op_sel:[0,1] op_sel_hi:[1,1]
v_pk_mul_f32 v[74:75], v[74:75], v[152:153] op_sel:[0,1] op_sel_hi:[1,1]
Lpage8:
s_cbranch_execz Ltour1
v_cvt_pk_bf16_f32 v208, v52, v53
v_cvt_pk_bf16_f32 v209, v54, v55
v_cvt_pk_bf16_f32 v218, v72, v73
v_cvt_pk_bf16_f32 v219, v74, v75
s_add_u32 m0, s93, 106496
s_mov_b32 s38, 98304
buffer_load_dwordx4 v36, s[12:15], s38 offen offset:0 lds
buffer_load_dwordx4 v37, s[12:15], s38 offen offset:1024 lds
buffer_load_dwordx4 v10, s[12:15], s38 offen offset:2048 lds
buffer_load_dwordx4 v121, s[12:15], s38 offen offset:3072 lds
v_mfma_f32_16x16x16_bf16 v[40:43], v[212:213], v[202:203], v[128:131]
v_mul_f32 v194, 0x3eb8aa3b, v147
v_mfma_f32_16x16x16_bf16 v[96:99], v[210:211], v[202:203], v[136:139]
v_mfma_f32_16x16x16_bf16 v[44:47], v[214:215], v[204:205], v[128:131]
v_mul_f32 v196, 0x3eb8aa3b, v149
v_mfma_f32_16x16x16_bf16 v[100:103], v[212:213], v[204:205], v[132:135]
v_mfma_f32_16x16x16_bf16 v[48:51], v[216:217], v[206:207], v[128:131]
v_mul_f32 v198, 0x3eb8aa3b, v151
v_mfma_f32_16x16x16_bf16 v[104:107], v[214:215], v[206:207], v[132:135]
v_mfma_f32_16x16x16_bf16 v[52:55], v[218:219], v[208:209], v[128:131]
v_mul_f32 v200, 0x3eb8aa3b, v153
v_mfma_f32_16x16x16_bf16 v[108:111], v[216:217], v[208:209], v[132:135]
v_mov_b32 v112, 0x3f803f80
v_mov_b32 v113, 0x3f803f80
v_mov_b32 v114, 0x3f803f80
v_mov_b32 v115, 0x3f803f80
s_waitcnt lgkmcnt(9)
v_pk_fma_f32 v[76:77], v[154:155], v[32:33], v[76:77] op_sel_hi:[1,0,1]
v_pk_fma_f32 v[78:79], v[156:157], v[32:33], v[78:79] op_sel_hi:[1,0,1]
s_waitcnt lgkmcnt(8)
v_pk_mul_f32 v[76:77], v[76:77], v[158:159]
v_pk_mul_f32 v[78:79], v[78:79], v[160:161]
v_cvt_pk_bf16_f32 v220, v76, v77
v_cvt_pk_bf16_f32 v221, v78, v79
s_waitcnt lgkmcnt(7)
v_pk_fma_f32 v[80:81], v[162:163], v[32:33], v[80:81] op_sel_hi:[1,0,1]
v_pk_fma_f32 v[82:83], v[164:165], v[32:33], v[82:83] op_sel_hi:[1,0,1]
s_waitcnt lgkmcnt(6)
v_pk_mul_f32 v[80:81], v[80:81], v[166:167]
v_pk_mul_f32 v[82:83], v[82:83], v[168:169]
v_cvt_pk_bf16_f32 v222, v80, v81
v_cvt_pk_bf16_f32 v223, v82, v83
s_waitcnt lgkmcnt(5)
v_pk_fma_f32 v[84:85], v[170:171], v[32:33], v[84:85] op_sel_hi:[1,0,1]
v_pk_fma_f32 v[86:87], v[172:173], v[32:33], v[86:87] op_sel_hi:[1,0,1]
s_waitcnt lgkmcnt(4)
v_pk_mul_f32 v[84:85], v[84:85], v[174:175]
v_pk_mul_f32 v[86:87], v[86:87], v[176:177]
v_cvt_pk_bf16_f32 v224, v84, v85
v_cvt_pk_bf16_f32 v225, v86, v87
s_waitcnt lgkmcnt(3)
v_pk_fma_f32 v[88:89], v[178:179], v[32:33], v[88:89] op_sel_hi:[1,0,1]
v_pk_fma_f32 v[90:91], v[180:181], v[32:33], v[90:91] op_sel_hi:[1,0,1]
s_waitcnt lgkmcnt(2)
v_pk_mul_f32 v[88:89], v[88:89], v[182:183]
v_pk_mul_f32 v[90:91], v[90:91], v[184:185]
v_cvt_pk_bf16_f32 v226, v88, v89
v_cvt_pk_bf16_f32 v227, v90, v91
s_waitcnt lgkmcnt(1)
v_pk_fma_f32 v[92:93], v[186:187], v[32:33], v[92:93] op_sel_hi:[1,0,1]
v_pk_fma_f32 v[94:95], v[188:189], v[32:33], v[94:95] op_sel_hi:[1,0,1]
s_waitcnt lgkmcnt(0)
v_pk_mul_f32 v[92:93], v[92:93], v[190:191]
v_pk_mul_f32 v[94:95], v[94:95], v[192:193]
v_cvt_pk_bf16_f32 v228, v92, v93
v_cvt_pk_bf16_f32 v229, v94, v95
v_max_f32 v40, v40, v96
v_max_f32 v41, v41, v97
v_max_f32 v42, v42, v98
v_max_f32 v43, v43, v99
v_max_f32 v44, v44, v100
v_max_f32 v45, v45, v101
v_max_f32 v46, v46, v102
v_max_f32 v47, v47, v103
v_max_f32 v48, v48, v104
v_max_f32 v49, v49, v105
v_max_f32 v50, v50, v106
v_max_f32 v51, v51, v107
v_max_f32 v52, v52, v108
v_max_f32 v53, v53, v109
v_max_f32 v54, v54, v110
v_max_f32 v55, v55, v111
v_max3_f32 v246, v40, v41, v42
v_max3_f32 v247, v44, v45, v46
v_max3_f32 v248, v48, v49, v50
v_max3_f32 v249, v52, v53, v54
v_max_f32 v246, v246, v43
v_max_f32 v247, v247, v47
v_max_f32 v248, v248, v51
v_max_f32 v249, v249, v55
v_permlane16_swap_b32 v246, v247
s_nop 0
v_permlane16_swap_b32 v248, v249
v_max_f32 v246, v246, v247
v_max_f32 v248, v248, v249
s_nop 1
v_permlane32_swap_b32 v246, v248
v_max_f32 v246, v246, v248
v_mov_b32 v248, v246
s_nop 1
v_permlane32_swap_b32 v246, v248
v_mov_b32 v247, v246
v_mov_b32 v249, v248
s_nop 0
v_permlane16_swap_b32 v246, v247
v_permlane16_swap_b32 v248, v249
v_mul_f32 v195, v246, v194
v_mul_f32 v197, v247, v196
v_mul_f32 v199, v248, v198
v_mul_f32 v201, v249, v200
v_pk_fma_f32 v[40:41], v[40:41], v[194:195], v[194:195] op_sel:[0,0,1] op_sel_hi:[1,0,1] neg_lo:[0,0,1] neg_hi:[0,0,1]
v_pk_fma_f32 v[42:43], v[42:43], v[194:195], v[194:195] op_sel:[0,0,1] op_sel_hi:[1,0,1] neg_lo:[0,0,1] neg_hi:[0,0,1]
v_pk_fma_f32 v[44:45], v[44:45], v[196:197], v[196:197] op_sel:[0,0,1] op_sel_hi:[1,0,1] neg_lo:[0,0,1] neg_hi:[0,0,1]
v_pk_fma_f32 v[46:47], v[46:47], v[196:197], v[196:197] op_sel:[0,0,1] op_sel_hi:[1,0,1] neg_lo:[0,0,1] neg_hi:[0,0,1]
v_pk_fma_f32 v[48:49], v[48:49], v[198:199], v[198:199] op_sel:[0,0,1] op_sel_hi:[1,0,1] neg_lo:[0,0,1] neg_hi:[0,0,1]
v_pk_fma_f32 v[50:51], v[50:51], v[198:199], v[198:199] op_sel:[0,0,1] op_sel_hi:[1,0,1] neg_lo:[0,0,1] neg_hi:[0,0,1]
v_pk_fma_f32 v[52:53], v[52:53], v[200:201], v[200:201] op_sel:[0,0,1] op_sel_hi:[1,0,1] neg_lo:[0,0,1] neg_hi:[0,0,1]
v_pk_fma_f32 v[54:55], v[54:55], v[200:201], v[200:201] op_sel:[0,0,1] op_sel_hi:[1,0,1] neg_lo:[0,0,1] neg_hi:[0,0,1]
v_exp_f32 v40, v40
v_exp_f32 v41, v41
v_exp_f32 v42, v42
v_exp_f32 v43, v43
v_exp_f32 v44, v44
v_exp_f32 v45, v45
v_exp_f32 v46, v46
v_exp_f32 v47, v47
v_exp_f32 v48, v48
v_exp_f32 v49, v49
v_exp_f32 v50, v50
v_exp_f32 v51, v51
v_exp_f32 v52, v52
v_exp_f32 v53, v53
v_exp_f32 v54, v54
v_exp_f32 v55, v55
v_cvt_pk_bf16_f32 v230, v40, v41
v_cvt_pk_bf16_f32 v231, v42, v43
v_and_b32 v232, v140, v230
v_and_b32 v233, v141, v231
v_xor_b32 v230, v230, v232
v_xor_b32 v231, v231, v233
v_cvt_pk_bf16_f32 v234, v44, v45
v_cvt_pk_bf16_f32 v235, v46, v47
v_and_b32 v236, v140, v234
v_and_b32 v237, v141, v235
v_xor_b32 v234, v234, v236
v_xor_b32 v235, v235, v237
v_mfma_f32_16x16x32_bf16 v[96:99], v[112:115], v[230:233], 0
v_mfma_f32_16x16x32_bf16 v[56:59], v[220:223], v[230:233], 0
v_cvt_pk_bf16_f32 v238, v48, v49
v_cvt_pk_bf16_f32 v239, v50, v51
v_and_b32 v240, v140, v238
v_and_b32 v241, v141, v239
v_xor_b32 v238, v238, v240
v_xor_b32 v239, v239, v241
v_mfma_f32_16x16x32_bf16 v[100:103], v[112:115], v[234:237], 0
v_mfma_f32_16x16x32_bf16 v[60:63], v[222:225], v[234:237], 0
v_cvt_pk_bf16_f32 v242, v52, v53
v_cvt_pk_bf16_f32 v243, v54, v55
v_and_b32 v244, v140, v242
v_and_b32 v245, v141, v243
v_xor_b32 v242, v242, v244
v_xor_b32 v243, v243, v245
v_mfma_f32_16x16x32_bf16 v[104:107], v[112:115], v[238:241], 0
v_mfma_f32_16x16x32_bf16 v[64:67], v[224:227], v[238:241], 0
v_rcp_f32 v96, v96
v_mfma_f32_16x16x32_bf16 v[108:111], v[112:115], v[242:245], 0
v_mfma_f32_16x16x32_bf16 v[68:71], v[226:229], v[242:245], 0
v_rcp_f32 v100, v100
v_mul_f32 v56, v96, v56
v_mul_f32 v57, v96, v57
v_mul_f32 v58, v96, v58
v_mul_f32 v59, v96, v59
v_rcp_f32 v104, v104
v_mul_f32 v60, v100, v60
v_mul_f32 v61, v100, v61
v_mul_f32 v62, v100, v62
v_mul_f32 v63, v100, v63
v_rcp_f32 v108, v108
v_mul_f32 v64, v104, v64
v_mul_f32 v65, v104, v65
v_mul_f32 v66, v104, v66
v_mul_f32 v67, v104, v67
v_mul_f32 v68, v108, v68
v_mul_f32 v69, v108, v69
v_mul_f32 v70, v108, v70
v_mul_f32 v71, v108, v71
v_cvt_pk_bf16_f32 v230, v56, v57
v_cvt_pk_bf16_f32 v231, v58, v59
v_cvt_pk_bf16_f32 v232, v60, v61
v_cvt_pk_bf16_f32 v233, v62, v63
v_cvt_pk_bf16_f32 v234, v64, v65
v_cvt_pk_bf16_f32 v235, v66, v67
v_cvt_pk_bf16_f32 v236, v68, v69
v_cvt_pk_bf16_f32 v237, v70, v71
v_permlane16_swap_b32 v230, v232
v_permlane16_swap_b32 v231, v233
v_permlane16_swap_b32 v234, v236
v_permlane16_swap_b32 v235, v237
s_cmp_lg_u32 s37, 0
s_cbranch_scc1 Lalt19_b
buffer_store_dwordx4 v[230:233], v1, s[28:31], s79 offen
buffer_store_dwordx4 v[234:237], v1, s[28:31], s80 offen
Lalt19_e:
s_add_u32 s91, s81, 6
v_mov_b32 v38, s91
s_waitcnt vmcnt(0)
s_cmp_lg_u32 s37, 0
s_cbranch_scc1 Lalt20_b
buffer_store_dword v38, v15, s[28:31], 0 offen
Lalt20_e:
s_barrier
v_lshlrev_b32 v40, 16, v16
v_and_b32 v41, 0xffff0000, v16
v_lshlrev_b32 v42, 16, v17
v_and_b32 v43, 0xffff0000, v17
v_lshlrev_b32 v44, 16, v18
v_and_b32 v45, 0xffff0000, v18
v_lshlrev_b32 v46, 16, v19
v_and_b32 v47, 0xffff0000, v19
v_lshlrev_b32 v48, 16, v20
v_and_b32 v49, 0xffff0000, v20
v_lshlrev_b32 v50, 16, v21
v_and_b32 v51, 0xffff0000, v21
v_lshlrev_b32 v52, 16, v22
v_and_b32 v53, 0xffff0000, v22
v_lshlrev_b32 v54, 16, v23
v_and_b32 v55, 0xffff0000, v23
ds_read_b64_tr_b16 v[56:57], v126 offset:0
ds_read_b64_tr_b16 v[58:59], v126 offset:512
ds_read_b64_tr_b16 v[60:61], v126 offset:2048
ds_read_b64_tr_b16 v[62:63], v126 offset:2560
ds_read_b64_tr_b16 v[64:65], v126 offset:4096
ds_read_b64_tr_b16 v[66:67], v126 offset:4608
ds_read_b64_tr_b16 v[68:69], v126 offset:6144
ds_read_b64_tr_b16 v[70:71], v126 offset:6656
ds_read_b64_tr_b16 v[72:73], v126 offset:8192
ds_read_b64_tr_b16 v[74:75], v126 offset:8704
ds_read_b64_tr_b16 v[76:77], v126 offset:10240
ds_read_b64_tr_b16 v[78:79], v126 offset:10752
ds_read_b64_tr_b16 v[80:81], v126 offset:12288
ds_read_b64_tr_b16 v[82:83], v126 offset:12800
ds_read_b64_tr_b16 v[84:85], v126 offset:14336
ds_read_b64_tr_b16 v[86:87], v126 offset:14848
s_add_u32 s91, s81, 6
s_mov_b32 s58, 30000
Lpl20:
buffer_load_dword v38, v14, s[28:31], 0 offen sc1
s_sub_u32 s58, s58, 1
s_cmp_eq_u32 s58, 0
s_cselect_b64 s[88:89], 0, s[54:55]
s_waitcnt vmcnt(0)
v_subrev_u32 v33, s91, v38
v_cmp_lt_u32 vcc, 7, v33
s_nop 0
s_and_b64 vcc, vcc, s[88:89]
s_cbranch_scc1 Lpl20
s_add_u32 m0, s40, 0
s_add_u32 s38, s67, 0
buffer_load_dwordx4 v1, s[28:31], s38 offen offset:0 sc1 lds
buffer_load_dwordx4 v1, s[28:31], s38 offen offset:1024 sc1 lds
buffer_load_dwordx4 v1, s[28:31], s38 offen offset:2048 sc1 lds
buffer_load_dwordx4 v1, s[28:31], s38 offen offset:3072 sc1 lds
s_add_u32 m0, s40, 8192
s_add_u32 s38, s68, 0
buffer_load_dwordx4 v1, s[28:31], s38 offen offset:0 sc1 lds
buffer_load_dwordx4 v1, s[28:31], s38 offen offset:1024 sc1 lds
buffer_load_dwordx4 v1, s[28:31], s38 offen offset:2048 sc1 lds
buffer_load_dwordx4 v1, s[28:31], s38 offen offset:3072 sc1 lds
ds_read_b64_tr_b16 v[88:89], v126 offset:16384
ds_read_b64_tr_b16 v[90:91], v126 offset:16896
ds_read_b64_tr_b16 v[92:93], v126 offset:18432
ds_read_b64_tr_b16 v[94:95], v126 offset:18944
ds_read_b64_tr_b16 v[96:97], v126 offset:20480
ds_read_b64_tr_b16 v[98:99], v126 offset:20992
ds_read_b64_tr_b16 v[100:101], v126 offset:22528
ds_read_b64_tr_b16 v[102:103], v126 offset:23040
ds_read_b64_tr_b16 v[104:105], v126 offset:24576
ds_read_b64_tr_b16 v[106:107], v126 offset:25088
ds_read_b64_tr_b16 v[108:109], v126 offset:26624
ds_read_b64_tr_b16 v[110:111], v126 offset:27136
ds_read_b64_tr_b16 v[112:113], v126 offset:28672
ds_read_b64_tr_b16 v[114:115], v126 offset:29184
ds_read_b64_tr_b16 v[116:117], v126 offset:30720
ds_read_b64_tr_b16 v[118:119], v126 offset:31232
ds_read_b64_tr_b16 v[128:129], v126 offset:32768
ds_read_b64_tr_b16 v[130:131], v126 offset:33280
ds_read_b64_tr_b16 v[132:133], v126 offset:34816
ds_read_b64_tr_b16 v[134:135], v126 offset:35328
ds_read_b64_tr_b16 v[136:137], v126 offset:36864
ds_read_b64_tr_b16 v[138:139], v126 offset:37376
ds_read_b64_tr_b16 v[140:141], v126 offset:38912
ds_read_b64_tr_b16 v[142:143], v126 offset:39424
s_waitcnt vmcnt(4)
s_barrier
ds_read_b128 v[224:227], v127 offset:0
ds_read_b128 v[228:231], v127 offset:1024
ds_read_b128 v[232:235], v127 offset:2048
ds_read_b128 v[236:239], v127 offset:3072
s_waitcnt lgkmcnt(2)
v_mfma_f32_32x32x16_bf16 v[40:55], v[56:59], v[224:227], v[40:55]
s_add_u32 m0, s40, 16384
s_add_u32 s38, s67, 16384
buffer_load_dwordx4 v1, s[28:31], s38 offen offset:0 sc1 lds
ds_read_b128 v[240:243], v127 offset:4096
v_mfma_f32_32x32x16_bf16 v[40:55], v[60:63], v[228:231], v[40:55]
ds_read_b128 v[244:247], v127 offset:5120
buffer_load_dwordx4 v1, s[28:31], s38 offen offset:1024 sc1 lds
ds_read_b128 v[224:227], v127 offset:6144
s_waitcnt lgkmcnt(3)
v_mfma_f32_32x32x16_bf16 v[40:55], v[64:67], v[232:235], v[40:55]
buffer_load_dwordx4 v1, s[28:31], s38 offen offset:2048 sc1 lds
ds_read_b128 v[228:231], v127 offset:7168
v_add_u32 v208, s64, v9
v_add_u32 v209, 7168, v208
v_mfma_f32_32x32x16_bf16 v[40:55], v[68:71], v[236:239], v[40:55]
s_waitcnt vmcnt(3)
s_barrier
ds_read_b128 v[232:235], v127 offset:8192
s_waitcnt lgkmcnt(3)
v_mfma_f32_32x32x16_bf16 v[40:55], v[72:75], v[240:243], v[40:55]
buffer_load_dwordx4 v1, s[28:31], s38 offen offset:3072 sc1 lds
v_add_u32 v210, 14336, v208
ds_read_b128 v[236:239], v127 offset:9216
v_add_u32 v211, 21504, v208
v_mfma_f32_32x32x16_bf16 v[40:55], v[76:79], v[244:247], v[40:55]
s_add_u32 m0, s40, 24576
s_add_u32 s38, s68, 16384
buffer_load_dwordx4 v1, s[28:31], s38 offen offset:0 sc1 lds
s_waitcnt lgkmcnt(2)
v_mfma_f32_32x32x16_bf16 v[40:55], v[80:83], v[224:227], v[40:55]
v_add_u32 v124, 65536, v1
ds_read_b128 v[240:243], v127 offset:10240
v_and_b32 v125, 31, v0
ds_read_b128 v[244:247], v127 offset:11264
v_lshlrev_b32 v125, 4, v125
v_mfma_f32_32x32x16_bf16 v[40:55], v[84:87], v[228:231], v[40:55]
buffer_load_dwordx4 v1, s[28:31], s38 offen offset:1024 sc1 lds
v_add_u32 v125, 159744, v125
ds_read_b128 v[224:227], v127 offset:12288
s_waitcnt lgkmcnt(3)
v_mfma_f32_32x32x16_bf16 v[40:55], v[88:91], v[232:235], v[40:55]
v_lshlrev_b32 v206, 3, v0
ds_read_b128 v[228:231], v127 offset:13312
ds_read_b64_tr_b16 v[144:145], v126 offset:40960
ds_read_b64_tr_b16 v[146:147], v126 offset:41472
s_lshl_b32 s88, s36, 9
v_mfma_f32_32x32x16_bf16 v[40:55], v[92:95], v[236:239], v[40:55]
buffer_load_dwordx4 v1, s[28:31], s38 offen offset:2048 sc1 lds
s_add_u32 s88, s88, 161792
ds_read_b128 v[232:235], v127 offset:14336
s_waitcnt lgkmcnt(5)
v_mfma_f32_32x32x16_bf16 v[40:55], v[96:99], v[240:243], v[40:55]
buffer_load_dwordx4 v1, s[28:31], s38 offen offset:3072 sc1 lds
ds_read_b64_tr_b16 v[148:149], v126 offset:43008
ds_read_b64_tr_b16 v[150:151], v126 offset:43520
v_add_u32 v206, s88, v206
v_mfma_f32_32x32x16_bf16 v[40:55], v[100:103], v[244:247], v[40:55]
s_waitcnt vmcnt(4)
s_barrier
ds_read_b128 v[236:239], v127 offset:15360
s_waitcnt lgkmcnt(6)
v_mfma_f32_32x32x16_bf16 v[40:55], v[104:107], v[224:227], v[40:55]
ds_read_b64_tr_b16 v[152:153], v126 offset:45056
ds_read_b64_tr_b16 v[154:155], v126 offset:45568
s_lshl_b32 s92, s42, 2
ds_read_b128 v[240:243], v127 offset:16384
s_add_u32 s92, s92, s36
v_mfma_f32_32x32x16_bf16 v[40:55], v[108:111], v[228:231], v[40:55]
ds_read_b128 v[244:247], v127 offset:17408
ds_read_b64_tr_b16 v[156:157], v126 offset:47104
ds_read_b64_tr_b16 v[158:159], v126 offset:47616
s_lshl_b32 s92, s92, 12
s_waitcnt lgkmcnt(6)
v_mfma_f32_32x32x16_bf16 v[40:55], v[112:115], v[232:235], v[40:55]
ds_read_b64_tr_b16 v[160:161], v126 offset:49152
ds_read_b64_tr_b16 v[162:163], v126 offset:49664
s_mul_i32 s76, s42, 458752
ds_read_b128 v[224:227], v127 offset:18432
s_lshl_b32 s88, s43, 13
v_mfma_f32_32x32x16_bf16 v[40:55], v[116:119], v[236:239], v[40:55]
ds_read_b128 v[228:231], v127 offset:19456
ds_read_b64_tr_b16 v[164:165], v126 offset:51200
ds_read_b64_tr_b16 v[166:167], v126 offset:51712
s_add_u32 s76, s76, s88
s_waitcnt lgkmcnt(8)
v_mfma_f32_32x32x16_bf16 v[40:55], v[128:131], v[240:243], v[40:55]
ds_read_b64_tr_b16 v[168:169], v126 offset:53248
ds_read_b64_tr_b16 v[170:171], v126 offset:53760
s_add_u32 s76, s76, s45
ds_read_b128 v[232:235], v127 offset:20480
s_add_u32 s76, s76, 16777216
v_mfma_f32_32x32x16_bf16 v[40:55], v[132:135], v[244:247], v[40:55]
ds_read_b128 v[236:239], v127 offset:21504
ds_read_b64_tr_b16 v[172:173], v126 offset:55296
ds_read_b64_tr_b16 v[174:175], v126 offset:55808
s_waitcnt lgkmcnt(8)
v_mfma_f32_32x32x16_bf16 v[40:55], v[136:139], v[224:227], v[40:55]
s_cmp_lg_u32 s49, 0
s_cselect_b32 s76, 0x7fe00000, s76
ds_read_b64_tr_b16 v[176:177], v126 offset:57344
ds_read_b64_tr_b16 v[178:179], v126 offset:57856
ds_read_b128 v[240:243], v127 offset:22528
v_mfma_f32_32x32x16_bf16 v[40:55], v[140:143], v[228:231], v[40:55]
s_waitcnt vmcnt(0)
s_barrier
ds_read_b128 v[244:247], v127 offset:23552
s_waitcnt lgkmcnt(6)
v_mfma_f32_32x32x16_bf16 v[40:55], v[144:147], v[232:235], v[40:55]
ds_read_b64_tr_b16 v[180:181], v126 offset:59392
ds_read_b64_tr_b16 v[182:183], v126 offset:59904
s_lshl_b32 s79, s57, 15
s_lshl_b32 s89, s44, 12
ds_read_b64_tr_b16 v[184:185], v126 offset:61440
v_mfma_f32_32x32x16_bf16 v[40:55], v[148:151], v[236:239], v[40:55]
ds_read_b128 v[224:227], v127 offset:24576
ds_read_b128 v[228:231], v127 offset:25600
s_add_u32 s79, s79, s89
s_and_b32 s89, s45, 2048
s_waitcnt lgkmcnt(5)
v_mfma_f32_32x32x16_bf16 v[40:55], v[152:155], v[240:243], v[40:55]
ds_read_b64_tr_b16 v[186:187], v126 offset:61952
ds_read_b64_tr_b16 v[188:189], v126 offset:63488
ds_read_b64_tr_b16 v[190:191], v126 offset:64000
s_add_u32 s79, s79, s89
s_add_u32 s79, s79, 4194304
v_mfma_f32_32x32x16_bf16 v[40:55], v[156:159], v[244:247], v[40:55]
ds_read_b128 v[232:235], v127 offset:26624
ds_read_b128 v[236:239], v127 offset:27648
s_lshl_b32 s80, s57, 12
s_lshl_b32 s89, s44, 9
s_waitcnt lgkmcnt(5)
v_mfma_f32_32x32x16_bf16 v[40:55], v[160:163], v[224:227], v[40:55]
s_add_u32 s80, s80, s89
ds_read_b128 v[240:243], v127 offset:28672
s_lshr_b32 s89, s36, 1
s_lshl_b32 s89, s89, 8
ds_read_b128 v[244:247], v127 offset:29696
v_mfma_f32_32x32x16_bf16 v[40:55], v[164:167], v[228:231], v[40:55]
s_add_u32 s80, s80, s89
ds_read_b128 v[224:227], v127 offset:30720
s_add_u32 s80, s80, 10485760
v_add_u32 v122, s46, v1
s_waitcnt lgkmcnt(3)
v_mfma_f32_32x32x16_bf16 v[40:55], v[168:171], v[232:235], v[40:55]
ds_read_b128 v[228:231], v127 offset:31744
v_xor_b32 v123, 8192, v122
v_and_b32 v207, 31, v0
v_lshlrev_b32 v207, 3, v207
v_lshrrev_b32 v33, 5, v0
v_mfma_f32_32x32x16_bf16 v[40:55], v[172:175], v[236:239], v[40:55]
v_lshl_add_u32 v207, v33, 2, v207
s_waitcnt lgkmcnt(2)
v_mfma_f32_32x32x16_bf16 v[40:55], v[176:179], v[240:243], v[40:55]
v_mfma_f32_32x32x16_bf16 v[40:55], v[180:183], v[244:247], v[40:55]
s_waitcnt lgkmcnt(0)
v_mfma_f32_32x32x16_bf16 v[40:55], v[184:187], v[224:227], v[40:55]
v_mfma_f32_32x32x16_bf16 v[40:55], v[188:191], v[228:231], v[40:55]
s_nop 11
v_cvt_pk_bf16_f32 v16, v40, v41
v_cvt_pk_bf16_f32 v17, v42, v43
v_cvt_pk_bf16_f32 v18, v44, v45
v_cvt_pk_bf16_f32 v19, v46, v47
v_cvt_pk_bf16_f32 v20, v48, v49
v_cvt_pk_bf16_f32 v21, v50, v51
v_cvt_pk_bf16_f32 v22, v52, v53
v_cvt_pk_bf16_f32 v23, v54, v55
s_cmp_lg_u32 s37, 0
s_cbranch_scc1 Lalt21_b
buffer_store_dwordx4 v[16:19], v1, s[28:31], s79 offen
buffer_store_dwordx4 v[20:23], v1, s[28:31], s79 offen offset:1024
Lalt21_e:
v_pk_add_f32 v[88:89], v[40:41], v[42:43]
v_pk_mul_f32 v[90:91], v[40:41], v[40:41]
v_pk_fma_f32 v[90:91], v[42:43], v[42:43], v[90:91]
v_pk_add_f32 v[88:89], v[88:89], v[44:45]
v_pk_fma_f32 v[90:91], v[44:45], v[44:45], v[90:91]
v_pk_add_f32 v[88:89], v[88:89], v[46:47]
v_pk_fma_f32 v[90:91], v[46:47], v[46:47], v[90:91]
v_pk_add_f32 v[88:89], v[88:89], v[48:49]
v_pk_fma_f32 v[90:91], v[48:49], v[48:49], v[90:91]
v_pk_add_f32 v[88:89], v[88:89], v[50:51]
v_pk_fma_f32 v[90:91], v[50:51], v[50:51], v[90:91]
v_pk_add_f32 v[88:89], v[88:89], v[52:53]
v_pk_fma_f32 v[90:91], v[52:53], v[52:53], v[90:91]
v_pk_add_f32 v[88:89], v[88:89], v[54:55]
v_pk_fma_f32 v[90:91], v[54:55], v[54:55], v[90:91]
v_add_f32 v88, v88, v89
v_add_f32 v90, v90, v91
s_nop 1
v_permlane32_swap_b32 v88, v90
v_add_f32 v88, v88, v90
s_cmp_lg_u32 s37, 0
s_cbranch_scc1 Lalt22_b
buffer_store_dword v88, v207, s[28:31], s80 offen
Lalt22_e:
s_add_u32 s91, s81, 7
v_mov_b32 v38, s91
s_waitcnt vmcnt(0)
s_cmp_lg_u32 s37, 0
s_cbranch_scc1 Lalt23_b
buffer_store_dword v38, v15, s[28:31], 0 offen
Lalt23_e:
s_waitcnt lgkmcnt(0)
s_barrier
s_cmp_lg_u32 s49, 0
s_cbranch_scc1 Lp3skip21
s_add_u32 s91, s81, 7
s_mov_b32 s58, 30000
Lpl22:
buffer_load_dword v38, v14, s[28:31], 0 offen sc1
s_sub_u32 s58, s58, 1
s_cmp_eq_u32 s58, 0
s_cselect_b64 s[88:89], 0, exec
s_waitcnt vmcnt(0)
v_subrev_u32 v33, s91, v38
v_cmp_lt_u32 vcc, 7, v33
s_nop 0
s_and_b64 vcc, vcc, s[88:89]
s_cbranch_scc1 Lpl22
s_add_u32 m0, s46, 0
s_add_u32 s38, s65, 4194304
buffer_load_dwordx4 v1, s[28:31], s38 offen offset:0 sc1 lds
buffer_load_dwordx4 v1, s[28:31], s38 offen offset:1024 sc1 lds
buffer_load_dwordx4 v1, s[28:31], s38 offen offset:2048 sc1 lds
buffer_load_dwordx4 v1, s[28:31], s38 offen offset:3072 sc1 lds
s_add_u32 m0, s46, 16384
s_add_u32 s38, s66, 4194304
buffer_load_dwordx4 v1, s[28:31], s38 offen offset:0 sc1 lds
buffer_load_dwordx4 v1, s[28:31], s38 offen offset:1024 sc1 lds
buffer_load_dwordx4 v1, s[28:31], s38 offen offset:2048 sc1 lds
buffer_load_dwordx4 v1, s[28:31], s38 offen offset:3072 sc1 lds
s_waitcnt vmcnt(4)
s_barrier
ds_read_b128 v[72:75], v1 offset:0
ds_read_b128 v[76:79], v1 offset:1024
ds_read_b128 v[80:83], v1 offset:2048
ds_read_b128 v[84:87], v1 offset:3072
ds_read_b128 v[88:91], v1 offset:4096
ds_read_b128 v[92:95], v1 offset:5120
ds_read_b128 v[96:99], v1 offset:6144
ds_read_b128 v[100:103], v1 offset:7168
s_waitcnt lgkmcnt(4)
v_mfma_f32_32x32x16_bf16 v[40:55], a[0:3], v[72:75], 0
s_add_u32 s38, s92, 10485760
buffer_load_dwordx4 v[224:227], v1, s[28:31], s38 offen offset:0 sc1
ds_read_b128 v[104:107], v1 offset:8192
ds_read_b128 v[108:111], v1 offset:9216
v_mfma_f32_32x32x16_bf16 v[40:55], a[4:7], v[76:79], v[40:55]
buffer_load_dwordx4 v[228:231], v1, s[28:31], s38 offen offset:1024 sc1
ds_read_b128 v[112:115], v1 offset:10240
ds_read_b128 v[116:119], v1 offset:11264
v_mfma_f32_32x32x16_bf16 v[40:55], a[8:11], v[80:83], v[40:55]
ds_read_b128 v[72:75], v1 offset:12288
ds_read_b128 v[76:79], v1 offset:13312
v_mfma_f32_32x32x16_bf16 v[40:55], a[12:15], v[84:87], v[40:55]
buffer_load_dwordx4 v[232:235], v1, s[28:31], s38 offen offset:2048 sc1
ds_read_b128 v[80:83], v1 offset:14336
s_waitcnt lgkmcnt(7)
v_mfma_f32_32x32x16_bf16 v[40:55], a[16:19], v[88:91], v[40:55]
ds_read_b128 v[84:87], v1 offset:15360
v_mfma_f32_32x32x16_bf16 v[40:55], a[20:23], v[92:95], v[40:55]
buffer_load_dwordx4 v[236:239], v1, s[28:31], s38 offen offset:3072 sc1
s_add_u32 m0, s46, 32768
s_add_u32 s38, s65, 4227072
v_mfma_f32_32x32x16_bf16 v[40:55], a[24:27], v[96:99], v[40:55]
v_mov_b32 v120, 0
v_mov_b32 v121, 0
s_mov_b64 exec, 0xffffffff
ds_read_b64 v[120:121], v206 offset:0
s_mov_b64 exec, -1
v_mfma_f32_32x32x16_bf16 v[40:55], a[28:31], v[100:103], v[40:55]
s_waitcnt vmcnt(4)
s_barrier
buffer_load_dwordx4 v1, s[28:31], s38 offen offset:0 sc1 lds
s_waitcnt lgkmcnt(5)
v_mfma_f32_32x32x16_bf16 v[40:55], a[32:35], v[104:107], v[40:55]
ds_read_b128 v[88:91], v1 offset:16384
ds_read_b128 v[92:95], v1 offset:17408
v_mfma_f32_32x32x16_bf16 v[40:55], a[36:39], v[108:111], v[40:55]
buffer_load_dwordx4 v1, s[28:31], s38 offen offset:1024 sc1 lds
ds_read_b128 v[96:99], v1 offset:18432
ds_read_b128 v[100:103], v1 offset:19456
v_mfma_f32_32x32x16_bf16 v[40:55], a[40:43], v[112:115], v[40:55]
buffer_load_dwordx4 v1, s[28:31], s38 offen offset:2048 sc1 lds
ds_read_b128 v[104:107], v1 offset:20480
ds_read_b128 v[108:111], v1 offset:21504
s_waitcnt vmcnt(5)
v_add_f32 v224, v224, v228
v_mfma_f32_32x32x16_bf16 v[40:55], a[44:47], v[116:119], v[40:55]
v_add_f32 v225, v225, v229
v_add_f32 v226, v226, v230
v_add_f32 v227, v227, v231
ds_read_b128 v[112:115], v1 offset:22528
s_waitcnt lgkmcnt(8)
v_mfma_f32_32x32x16_bf16 v[40:55], a[48:51], v[72:75], v[40:55]
buffer_load_dwordx4 v1, s[28:31], s38 offen offset:3072 sc1 lds
s_add_u32 m0, s46, 49152
s_add_u32 s38, s66, 4227072
s_waitcnt vmcnt(4)
v_add_f32 v232, v232, v236
v_mfma_f32_32x32x16_bf16 v[40:55], a[52:55], v[76:79], v[40:55]
v_add_f32 v233, v233, v237
v_add_f32 v234, v234, v238
v_add_f32 v235, v235, v239
v_add_f32 v224, v224, v232
ds_read_b128 v[116:119], v1 offset:23552
v_mfma_f32_32x32x16_bf16 v[40:55], a[56:59], v[80:83], v[40:55]
buffer_load_dwordx4 v1, s[28:31], s38 offen offset:0 sc1 lds
v_add_f32 v225, v225, v233
v_add_f32 v226, v226, v234
v_add_f32 v227, v227, v235
v_mfma_f32_32x32x16_bf16 v[40:55], a[60:63], v[84:87], v[40:55]
v_mov_b32 v122, 0
v_mov_b32 v123, 0
s_mov_b64 exec, 0xffffffff
ds_read_b64 v[122:123], v206 offset:256
s_mov_b64 exec, -1
s_waitcnt lgkmcnt(5)
v_mfma_f32_32x32x16_bf16 v[40:55], a[64:67], v[88:91], v[40:55]
buffer_load_dwordx4 v1, s[28:31], s38 offen offset:1024 sc1 lds
v_permlane16_swap_b32 v224, v226
ds_read_b128 v[72:75], v1 offset:24576
v_permlane16_swap_b32 v225, v227
v_mfma_f32_32x32x16_bf16 v[40:55], a[68:71], v[92:95], v[40:55]
v_add_f32 v224, v224, v226
v_add_f32 v225, v225, v227
s_nop 1
v_permlane32_swap_b32 v224, v225
ds_read_b128 v[76:79], v1 offset:25600
v_add_f32 v224, v224, v225
v_mfma_f32_32x32x16_bf16 v[40:55], a[72:75], v[96:99], v[40:55]
buffer_load_dwordx4 v1, s[28:31], s38 offen offset:2048 sc1 lds
v_mov_b32 v225, v224
s_nop 1
v_permlane32_swap_b32 v224, v225
v_mul_f32 v224, 0xbb000000, v224
v_mfma_f32_32x32x16_bf16 v[40:55], a[76:79], v[100:103], v[40:55]
buffer_load_dwordx4 v1, s[28:31], s38 offen offset:3072 sc1 lds
s_add_u32 m0, s46, 65536
s_add_u32 s38, s65, 4259840
ds_read_b128 v[80:83], v1 offset:26624
s_waitcnt lgkmcnt(4)
v_mfma_f32_32x32x16_bf16 v[40:55], a[80:83], v[104:107], v[40:55]
v_mul_f32 v225, 0x3b000000, v225
v_fma_f32 v225, -v224, v224, v225
v_max_f32 v225, 0, v225
v_cvt_pk_bf16_f32 v225, v225, v225
Lpage9:
s_cbranch_execz Ltour2
ds_read_b128 v[84:87], v1 offset:27648
v_and_b32 v225, 0xffff0000, v225
v_mfma_f32_32x32x16_bf16 v[40:55], a[84:87], v[108:111], v[40:55]
v_add_f32 v225, 0x3727c5ac, v225
v_cvt_pk_bf16_f32 v225, v225, v225
v_and_b32 v225, 0xffff0000, v225
v_sqrt_f32 v226, v225
buffer_load_dwordx4 v1, s[28:31], s38 offen offset:0 sc1 lds
v_cvt_pk_bf16_f32 v224, v224, v224
v_and_b32 v224, 0xffff0000, v224
v_cvt_pk_bf16_f32 v226, v226, v226
v_and_b32 v226, 0xffff0000, v226
v_rcp_f32 v225, v226
s_nop 0
v_mul_f32 v227, 0xbfb8aa3b, v225
v_cvt_pk_bf16_f32 v224, v224, v224
v_mov_b32 v225, v224
v_and_b32 v228, 15, v0
v_lshlrev_b32 v228, 5, v228
v_bfe_u32 v229, v0, 4, 1
v_lshl_add_u32 v228, v229, 4, v228
s_lshl_b32 s88, s36, 9
s_add_u32 s88, s88, 159744
v_add_u32 v228, s88, v228
ds_write_b128 v228, v[224:227]
v_mfma_f32_32x32x16_bf16 v[40:55], a[88:91], v[112:115], v[40:55]
ds_read_b128 v[88:91], v1 offset:28672
v_mfma_f32_32x32x16_bf16 v[40:55], a[92:95], v[116:119], v[40:55]
s_waitcnt vmcnt(5) lgkmcnt(1)
s_barrier
buffer_load_dwordx4 v1, s[28:31], s38 offen offset:1024 sc1 lds
v_mfma_f32_32x32x16_bf16 v[40:55], a[96:99], v[72:75], v[40:55]
ds_read_b128 v[92:95], v1 offset:29696
ds_read_b128 v[96:99], v1 offset:30720
ds_read_b128 v[100:103], v1 offset:31744
v_and_b32 v127, 7, v0
v_lshlrev_b32 v127, 7, v127
v_mfma_f32_32x32x16_bf16 v[40:55], a[100:103], v[76:79], v[40:55]
buffer_load_dwordx4 v1, s[28:31], s38 offen offset:2048 sc1 lds
ds_read_b128 v[104:107], v1 offset:32768
v_and_b32 v34, 8, v0
v_lshl_add_u32 v127, v34, 9, v127
v_mfma_f32_32x32x16_bf16 v[40:55], a[104:107], v[80:83], v[40:55]
ds_read_b128 v[108:111], v1 offset:33792
ds_read_b128 v[112:115], v1 offset:34816
v_mfma_f32_32x32x16_bf16 v[40:55], a[108:111], v[84:87], v[40:55]
buffer_load_dwordx4 v1, s[28:31], s38 offen offset:3072 sc1 lds
s_add_u32 m0, s46, 81920
s_add_u32 s38, s66, 4259840
s_waitcnt lgkmcnt(3)
v_mfma_f32_32x32x16_bf16 v[40:55], a[112:115], v[88:91], v[40:55]
buffer_load_dwordx4 v1, s[28:31], s38 offen offset:0 sc1 lds
ds_read_b128 v[240:243], v125 offset:0
ds_read_b128 v[116:119], v1 offset:35840
v_mfma_f32_32x32x16_bf16 v[40:55], a[116:119], v[92:95], v[40:55]
ds_read_b128 v[72:75], v1 offset:36864
ds_read_b128 v[76:79], v1 offset:37888
v_mfma_f32_32x32x16_bf16 v[40:55], a[120:123], v[96:99], v[40:55]
buffer_load_dwordx4 v1, s[28:31], s38 offen offset:1024 sc1 lds
ds_read_b128 v[80:83], v1 offset:38912
ds_read_b128 v[84:87], v1 offset:39936
v_mfma_f32_32x32x16_bf16 v[40:55], a[124:127], v[100:103], v[40:55]
ds_read_b128 v[88:91], v1 offset:40960
ds_read_b128 v[92:95], v1 offset:41984
s_waitcnt lgkmcnt(7)
v_mfma_f32_32x32x8_bf16 v[40:55], v[120:121], v[240:241], v[40:55]
buffer_load_dwordx4 v1, s[28:31], s38 offen offset:2048 sc1 lds
ds_read_b128 v[96:99], v1 offset:43008
s_waitcnt lgkmcnt(7)
v_mfma_f32_32x32x16_bf16 v[56:71], a[0:3], v[104:107], 0
ds_read_b128 v[100:103], v1 offset:44032
v_mfma_f32_32x32x16_bf16 v[56:71], a[4:7], v[108:111], v[56:71]
buffer_load_dwordx4 v1, s[28:31], s38 offen offset:3072 sc1 lds
s_add_u32 m0, s46, 98304
s_add_u32 s38, s65, 4292608
ds_read_b128 v[104:107], v1 offset:45056
v_mfma_f32_32x32x16_bf16 v[56:71], a[8:11], v[112:115], v[56:71]
ds_read_b128 v[108:111], v1 offset:46080
v_mfma_f32_32x32x16_bf16 v[56:71], a[12:15], v[116:119], v[56:71]
buffer_load_dwordx4 v1, s[28:31], s38 offen offset:0 sc1 lds
ds_read_b128 v[112:115], v1 offset:47104
v_mul_f32 v40, v243, v40
s_waitcnt lgkmcnt(7)
v_mfma_f32_32x32x16_bf16 v[56:71], a[16:19], v[72:75], v[56:71]
buffer_load_dwordx4 v1, s[28:31], s38 offen offset:1024 sc1 lds
v_mul_f32 v41, v243, v41
ds_read_b128 v[116:119], v1 offset:48128
s_lshr_b32 s88, s36, 1
v_mfma_f32_32x32x16_bf16 v[56:71], a[20:23], v[76:79], v[56:71]
v_exp_f32 v40, v40
v_mul_f32 v42, v243, v42
v_exp_f32 v41, v41
v_mfma_f32_32x32x16_bf16 v[56:71], a[24:27], v[80:83], v[56:71]
buffer_load_dwordx4 v1, s[28:31], s38 offen offset:2048 sc1 lds
v_mul_f32 v43, v243, v43
s_lshl_b32 s89, s88, 13
v_add_u32 v200, s89, v11
v_mfma_f32_32x32x16_bf16 v[56:71], a[28:31], v[84:87], v[56:71]
s_waitcnt vmcnt(11)
s_barrier
ds_read_b128 v[72:75], v1 offset:49152
s_waitcnt lgkmcnt(5)
v_mfma_f32_32x32x16_bf16 v[56:71], a[32:35], v[88:91], v[56:71]
buffer_load_dwordx4 v1, s[28:31], s38 offen offset:3072 sc1 lds
s_add_u32 m0, s46, 114688
s_add_u32 s38, s66, 4292608
ds_read_b128 v[76:79], v1 offset:50176
v_mfma_f32_32x32x16_bf16 v[56:71], a[36:39], v[92:95], v[56:71]
v_exp_f32 v42, v42
v_mul_f32 v48, v243, v48
v_exp_f32 v43, v43
v_mfma_f32_32x32x16_bf16 v[56:71], a[40:43], v[96:99], v[56:71]
buffer_load_dwordx4 v1, s[28:31], s38 offen offset:0 sc1 lds
ds_read_b128 v[80:83], v1 offset:51200
v_mul_f32 v49, v243, v49
v_add_u32 v201, s89, v12
v_mfma_f32_32x32x16_bf16 v[56:71], a[44:47], v[100:103], v[56:71]
v_exp_f32 v48, v48
ds_read_b128 v[84:87], v1 offset:52224
v_mul_f32 v50, v243, v50
s_waitcnt lgkmcnt(4)
v_mfma_f32_32x32x16_bf16 v[56:71], a[48:51], v[104:107], v[56:71]
buffer_load_dwordx4 v1, s[28:31], s38 offen offset:1024 sc1 lds
v_exp_f32 v49, v49
ds_read_b128 v[88:91], v1 offset:53248
v_mfma_f32_32x32x16_bf16 v[56:71], a[52:55], v[108:111], v[56:71]
buffer_load_dwordx4 v1, s[28:31], s38 offen offset:2048 sc1 lds
v_mul_f32 v51, v243, v51
v_add_u32 v202, 65536, v200
v_exp_f32 v50, v50
v_mfma_f32_32x32x16_bf16 v[56:71], a[56:59], v[112:115], v[56:71]
v_exp_f32 v51, v51
ds_read_b128 v[92:95], v1 offset:54272
v_add_u32 v203, 65536, v201
v_fma_f32 v40, v40, v242, v242
v_fma_f32 v41, v41, v242, v242
v_mfma_f32_32x32x16_bf16 v[56:71], a[60:63], v[116:119], v[56:71]
buffer_load_dwordx4 v1, s[28:31], s38 offen offset:3072 sc1 lds
ds_read_b128 v[96:99], v1 offset:55296
v_fma_f32 v42, v42, v242, v242
v_add_u32 v204, 131072, v200
s_waitcnt lgkmcnt(3)
v_mfma_f32_32x32x16_bf16 v[56:71], a[64:67], v[72:75], v[56:71]
v_fma_f32 v43, v43, v242, v242
ds_read_b128 v[100:103], v1 offset:56320
v_fma_f32 v48, v48, v242, v242
v_fma_f32 v49, v49, v242, v242
v_add_u32 v205, 131072, v201
v_mfma_f32_32x32x16_bf16 v[56:71], a[68:71], v[76:79], v[56:71]
ds_read_b128 v[104:107], v1 offset:57344
v_fma_f32 v50, v50, v242, v242
v_fma_f32 v51, v51, v242, v242
s_mul_i32 s88, s88, 57344
ds_read_b128 v[108:111], v1 offset:58368
v_mfma_f32_32x32x16_bf16 v[56:71], a[72:75], v[80:83], v[56:71]
v_rcp_f32 v40, v40
v_rcp_f32 v41, v41
v_mul_f32 v40, v40, v44
v_mfma_f32_32x32x16_bf16 v[56:71], a[76:79], v[84:87], v[56:71]
ds_read_b128 v[112:115], v1 offset:59392
s_mul_i32 s79, s57, 114688
v_rcp_f32 v42, v42
v_mul_f32 v41, v41, v45
s_waitcnt lgkmcnt(3)
v_mfma_f32_32x32x16_bf16 v[56:71], a[80:83], v[88:91], v[56:71]
s_add_u32 s79, s79, s88
s_add_u32 s79, s79, 16777216
s_add_u32 s80, s79, 4096
ds_read_b128 v[116:119], v1 offset:60416
v_rcp_f32 v43, v43
v_mfma_f32_32x32x16_bf16 v[56:71], a[84:87], v[92:95], v[56:71]
v_mul_f32 v42, v42, v46
ds_read_b128 v[72:75], v1 offset:61440
v_rcp_f32 v48, v48
v_mul_f32 v43, v43, v47
v_mfma_f32_32x32x16_bf16 v[56:71], a[88:91], v[96:99], v[56:71]
ds_read_b128 v[76:79], v1 offset:62464
v_rcp_f32 v49, v49
v_mul_f32 v48, v48, v52
ds_read_b128 v[80:83], v1 offset:63488
v_mfma_f32_32x32x16_bf16 v[56:71], a[92:95], v[100:103], v[56:71]
s_waitcnt vmcnt(8)
s_barrier
v_rcp_f32 v50, v50
s_waitcnt lgkmcnt(3)
v_mfma_f32_32x32x16_bf16 v[56:71], a[96:99], v[104:107], v[56:71]
v_mul_f32 v49, v49, v53
v_rcp_f32 v51, v51
v_mul_f32 v50, v50, v54
s_add_u32 s94, s76, 0
v_mul_f32 v51, v51, v55
v_cvt_pk_bf16_f32 v192, v40, v41
v_cvt_pk_bf16_f32 v193, v42, v43
v_cvt_pk_bf16_f32 v194, v48, v49
v_cvt_pk_bf16_f32 v195, v50, v51
s_cmp_lg_u32 s37, 0
s_cbranch_scc1 Lalt24_b
buffer_store_dwordx4 v[192:195], v1, s[28:31], s94 offen
Lalt24_e:
v_mfma_f32_32x32x16_bf16 v[56:71], a[100:103], v[108:111], v[56:71]
ds_read_b128 v[84:87], v1 offset:64512
s_add_u32 m0, s46, 131072
s_lshl4_add_u32 s38, s69, 0
buffer_load_dwordx4 v208, s[20:23], s38 offen offset:0 lds
v_mfma_f32_32x32x16_bf16 v[56:71], a[104:107], v[112:115], v[56:71]
s_add_u32 s89, s76, 0
buffer_load_dword v34, v127, s[28:31], s89 offen sc1
ds_read_b128 v[88:91], v124 offset:0
ds_read_b128 v[92:95], v124 offset:1024
v_mfma_f32_32x32x16_bf16 v[56:71], a[108:111], v[116:119], v[56:71]
buffer_load_dwordx4 v209, s[20:23], s38 offen offset:1024 lds
s_add_u32 m0, s46, 131072
s_lshl4_add_u32 s38, s69, 0
ds_read_b128 v[96:99], v124 offset:2048
s_waitcnt lgkmcnt(3)
v_mfma_f32_32x32x16_bf16 v[56:71], a[112:115], v[72:75], v[56:71]
ds_read_b128 v[244:247], v125 offset:512
buffer_load_dwordx4 v210, s[20:23], s38 offen offset:2048 lds
ds_read_b128 v[100:103], v124 offset:3072
v_mfma_f32_32x32x16_bf16 v[56:71], a[116:119], v[76:79], v[56:71]
ds_read_b128 v[104:107], v124 offset:4096
ds_read_b128 v[108:111], v124 offset:5120
v_mfma_f32_32x32x16_bf16 v[56:71], a[120:123], v[80:83], v[56:71]
buffer_load_dwordx4 v211, s[20:23], s38 offen offset:3072 lds
ds_read_b128 v[112:115], v124 offset:6144
ds_read_b128 v[116:119], v124 offset:7168
v_mfma_f32_32x32x16_bf16 v[56:71], a[124:127], v[84:87], v[56:71]
ds_read_b128 v[72:75], v124 offset:8192
ds_read_b128 v[76:79], v124 offset:9216
s_waitcnt lgkmcnt(7)
v_mfma_f32_32x32x8_bf16 v[56:71], v[120:121], v[244:245], v[56:71]
ds_read_b128 v[80:83], v124 offset:10240
s_waitcnt lgkmcnt(7)
v_mfma_f32_32x32x16_bf16 v[40:55], a[0:3], v[88:91], 0
ds_read_b128 v[84:87], v124 offset:11264
v_mfma_f32_32x32x16_bf16 v[40:55], a[4:7], v[92:95], v[40:55]
ds_read_b128 v[88:91], v124 offset:12288
v_mfma_f32_32x32x16_bf16 v[40:55], a[8:11], v[96:99], v[40:55]
ds_read_b128 v[92:95], v124 offset:13312
v_mfma_f32_32x32x16_bf16 v[40:55], a[12:15], v[100:103], v[40:55]
ds_read_b128 v[96:99], v124 offset:14336
s_nop 1
v_mul_f32 v56, v247, v56
s_waitcnt lgkmcnt(7)
v_mfma_f32_32x32x16_bf16 v[40:55], a[16:19], v[104:107], v[40:55]
v_mul_f32 v57, v247, v57
ds_read_b128 v[100:103], v124 offset:15360
v_exp_f32 v56, v56
v_mul_f32 v58, v247, v58
v_mfma_f32_32x32x16_bf16 v[40:55], a[20:23], v[108:111], v[40:55]
v_exp_f32 v57, v57
ds_read_b128 v[104:107], v124 offset:16384
v_mul_f32 v59, v247, v59
v_mfma_f32_32x32x16_bf16 v[40:55], a[24:27], v[112:115], v[40:55]
v_exp_f32 v58, v58
ds_read_b128 v[108:111], v124 offset:17408
v_mul_f32 v64, v247, v64
v_mfma_f32_32x32x16_bf16 v[40:55], a[28:31], v[116:119], v[40:55]
v_exp_f32 v59, v59
ds_read_b128 v[112:115], v124 offset:18432
v_mul_f32 v65, v247, v65
s_waitcnt lgkmcnt(7)
v_mfma_f32_32x32x16_bf16 v[40:55], a[32:35], v[72:75], v[40:55]
v_exp_f32 v64, v64
ds_read_b128 v[116:119], v124 offset:19456
v_mul_f32 v66, v247, v66
v_mfma_f32_32x32x16_bf16 v[40:55], a[36:39], v[76:79], v[40:55]
v_exp_f32 v65, v65
ds_read_b128 v[72:75], v124 offset:20480
v_mul_f32 v67, v247, v67
v_mfma_f32_32x32x16_bf16 v[40:55], a[40:43], v[80:83], v[40:55]
v_exp_f32 v66, v66
v_exp_f32 v67, v67
ds_read_b128 v[76:79], v124 offset:21504
v_mfma_f32_32x32x16_bf16 v[40:55], a[44:47], v[84:87], v[40:55]
v_fma_f32 v56, v56, v246, v246
v_fma_f32 v57, v57, v246, v246
ds_read_b128 v[80:83], v124 offset:22528
v_fma_f32 v58, v58, v246, v246
s_waitcnt lgkmcnt(7)
v_mfma_f32_32x32x16_bf16 v[40:55], a[48:51], v[88:91], v[40:55]
v_fma_f32 v59, v59, v246, v246
ds_read_b128 v[84:87], v124 offset:23552
v_fma_f32 v64, v64, v246, v246
s_add_u32 s89, s76, 114688
v_mfma_f32_32x32x16_bf16 v[40:55], a[52:55], v[92:95], v[40:55]
v_fma_f32 v65, v65, v246, v246
ds_read_b128 v[88:91], v124 offset:24576
v_fma_f32 v66, v66, v246, v246
v_mfma_f32_32x32x16_bf16 v[40:55], a[56:59], v[96:99], v[40:55]
v_fma_f32 v67, v67, v246, v246
ds_read_b128 v[92:95], v124 offset:25600
v_rcp_f32 v56, v56
v_mfma_f32_32x32x16_bf16 v[40:55], a[60:63], v[100:103], v[40:55]
buffer_load_dword v34, v127, s[28:31], s89 offen sc1
v_rcp_f32 v57, v57
s_waitcnt lgkmcnt(6)
v_mfma_f32_32x32x16_bf16 v[40:55], a[64:67], v[104:107], v[40:55]
v_mul_f32 v56, v56, v60
ds_read_b128 v[96:99], v124 offset:26624
v_rcp_f32 v58, v58
v_mul_f32 v57, v57, v61
v_mfma_f32_32x32x16_bf16 v[40:55], a[68:71], v[108:111], v[40:55]
ds_read_b128 v[100:103], v124 offset:27648
v_rcp_f32 v59, v59
v_mul_f32 v58, v58, v62
ds_read_b128 v[104:107], v124 offset:28672
v_mfma_f32_32x32x16_bf16 v[40:55], a[72:75], v[112:115], v[40:55]
v_rcp_f32 v64, v64
v_mul_f32 v59, v59, v63
ds_read_b128 v[108:111], v124 offset:29696
v_mfma_f32_32x32x16_bf16 v[40:55], a[76:79], v[116:119], v[40:55]
v_rcp_f32 v65, v65
v_mul_f32 v64, v64, v68
ds_read_b128 v[112:115], v124 offset:30720
s_waitcnt lgkmcnt(7)
v_mfma_f32_32x32x16_bf16 v[40:55], a[80:83], v[72:75], v[40:55]
v_rcp_f32 v66, v66
v_mul_f32 v65, v65, v69
v_rcp_f32 v67, v67
v_mfma_f32_32x32x16_bf16 v[40:55], a[84:87], v[76:79], v[40:55]
ds_read_b128 v[116:119], v124 offset:31744
v_mul_f32 v66, v66, v70
s_add_u32 s94, s76, 114688
v_mul_f32 v67, v67, v71
v_mfma_f32_32x32x16_bf16 v[40:55], a[88:91], v[80:83], v[40:55]
v_cvt_pk_bf16_f32 v196, v56, v57
v_cvt_pk_bf16_f32 v197, v58, v59
v_mfma_f32_32x32x16_bf16 v[40:55], a[92:95], v[84:87], v[40:55]
s_waitcnt vmcnt(1)
s_barrier
v_cvt_pk_bf16_f32 v198, v64, v65
s_waitcnt lgkmcnt(4)
v_mfma_f32_32x32x16_bf16 v[40:55], a[96:99], v[88:91], v[40:55]
v_cvt_pk_bf16_f32 v199, v66, v67
s_cmp_lg_u32 s37, 0
s_cbranch_scc1 Lalt25_b
buffer_store_dwordx4 v[196:199], v1, s[28:31], s94 offen
Lalt25_e:
v_mfma_f32_32x32x16_bf16 v[40:55], a[100:103], v[92:95], v[40:55]
ds_read_b128 v[72:75], v124 offset:32768
ds_read_b128 v[76:79], v124 offset:33792
v_mfma_f32_32x32x16_bf16 v[40:55], a[104:107], v[96:99], v[40:55]
ds_read_b128 v[80:83], v124 offset:34816
ds_read_b64_tr_b16 v[132:133], v205 offset:0
ds_read_b64_tr_b16 v[134:135], v205 offset:512
v_mfma_f32_32x32x16_bf16 v[40:55], a[108:111], v[100:103], v[40:55]
ds_read_b128 v[84:87], v124 offset:35840
ds_read_b64_tr_b16 v[128:129], v204 offset:0
ds_read_b64_tr_b16 v[130:131], v204 offset:512
s_waitcnt lgkmcnt(8)
v_mfma_f32_32x32x16_bf16 v[40:55], a[112:115], v[104:107], v[40:55]
ds_read_b128 v[240:243], v125 offset:1024
ds_read_b128 v[88:91], v124 offset:36864
v_mfma_f32_32x32x16_bf16 v[40:55], a[116:119], v[108:111], v[40:55]
ds_read_b64_tr_b16 v[140:141], v205 offset:2048
ds_read_b64_tr_b16 v[142:143], v205 offset:2560
ds_read_b128 v[92:95], v124 offset:37888
v_mfma_f32_32x32x16_bf16 v[40:55], a[120:123], v[112:115], v[40:55]
ds_read_b64_tr_b16 v[136:137], v204 offset:2048
ds_read_b64_tr_b16 v[138:139], v204 offset:2560
ds_read_b128 v[96:99], v124 offset:38912
v_mfma_f32_32x32x16_bf16 v[40:55], a[124:127], v[116:119], v[40:55]
ds_read_b64_tr_b16 v[148:149], v205 offset:4096
ds_read_b64_tr_b16 v[150:151], v205 offset:4608
ds_read_b64_tr_b16 v[144:145], v204 offset:4096
ds_read_b64_tr_b16 v[146:147], v204 offset:4608
ds_read_b64_tr_b16 v[156:157], v205 offset:6144
ds_read_b64_tr_b16 v[158:159], v205 offset:6656
ds_read_b64_tr_b16 v[152:153], v204 offset:6144
ds_read_b64_tr_b16 v[154:155], v204 offset:6656
s_waitcnt lgkmcnt(15)
v_mfma_f32_32x32x8_bf16 v[40:55], v[120:121], v[240:241], v[40:55]
ds_read_b128 v[100:103], v124 offset:39936
v_mfma_f32_32x32x16_bf16 v[56:71], a[0:3], v[72:75], 0
ds_read_b128 v[104:107], v124 offset:40960
ds_read_b128 v[108:111], v124 offset:41984
v_mfma_f32_32x32x16_bf16 v[56:71], a[4:7], v[76:79], v[56:71]
s_waitcnt lgkmcnt(3)
s_barrier
ds_read_b128 v[112:115], v124 offset:43008
ds_read_b128 v[116:119], v124 offset:44032
v_mfma_f32_32x32x16_bf16 v[56:71], a[8:11], v[80:83], v[56:71]
s_add_u32 m0, s46, 131072
s_lshl4_add_u32 s38, s70, 0
buffer_load_dwordx4 v208, s[20:23], s38 offen offset:0 lds
ds_read_b128 v[72:75], v124 offset:45056
v_mfma_f32_32x32x16_bf16 v[56:71], a[12:15], v[84:87], v[56:71]
buffer_load_dwordx4 v209, s[20:23], s38 offen offset:1024 lds
ds_read_b128 v[76:79], v124 offset:46080
s_add_u32 s89, s76, 229376
s_waitcnt lgkmcnt(6)
v_mfma_f32_32x32x16_bf16 v[56:71], a[16:19], v[88:91], v[56:71]
ds_read_b128 v[80:83], v124 offset:47104
v_mul_f32 v40, v243, v40
v_mul_f32 v41, v243, v41
ds_read_b128 v[84:87], v124 offset:48128
v_mfma_f32_32x32x16_bf16 v[56:71], a[20:23], v[92:95], v[56:71]
s_add_u32 m0, s46, 131072
s_lshl4_add_u32 s38, s70, 0
buffer_load_dwordx4 v210, s[20:23], s38 offen offset:2048 lds
ds_read_b128 v[88:91], v124 offset:49152
v_mfma_f32_32x32x16_bf16 v[56:71], a[24:27], v[96:99], v[56:71]
buffer_load_dword v34, v127, s[28:31], s89 offen sc1
v_exp_f32 v40, v40
v_mul_f32 v42, v243, v42
v_mfma_f32_32x32x16_bf16 v[56:71], a[28:31], v[100:103], v[56:71]
buffer_load_dwordx4 v211, s[20:23], s38 offen offset:3072 lds
v_exp_f32 v41, v41
s_waitcnt lgkmcnt(5)
v_mfma_f32_32x32x16_bf16 v[56:71], a[32:35], v[104:107], v[56:71]
v_mul_f32 v43, v243, v43
v_exp_f32 v42, v42
ds_read_b128 v[92:95], v124 offset:50176
v_mul_f32 v48, v243, v48
v_mfma_f32_32x32x16_bf16 v[56:71], a[36:39], v[108:111], v[56:71]
v_exp_f32 v43, v43
ds_read_b128 v[96:99], v124 offset:51200
v_mul_f32 v49, v243, v49
ds_read_b128 v[100:103], v124 offset:52224
v_mfma_f32_32x32x16_bf16 v[56:71], a[40:43], v[112:115], v[56:71]
v_exp_f32 v48, v48
v_mul_f32 v50, v243, v50
v_exp_f32 v49, v49
v_mfma_f32_32x32x16_bf16 v[56:71], a[44:47], v[116:119], v[56:71]
ds_read_b128 v[104:107], v124 offset:53248
v_mul_f32 v51, v243, v51
v_exp_f32 v50, v50
s_waitcnt lgkmcnt(5)
v_mfma_f32_32x32x16_bf16 v[56:71], a[48:51], v[72:75], v[56:71]
v_exp_f32 v51, v51
ds_read_b128 v[108:111], v124 offset:54272
v_fma_f32 v40, v40, v242, v242
v_fma_f32 v41, v41, v242, v242
v_mfma_f32_32x32x16_bf16 v[56:71], a[52:55], v[76:79], v[56:71]
ds_read_b128 v[112:115], v124 offset:55296
v_fma_f32 v42, v42, v242, v242
v_fma_f32 v43, v43, v242, v242
ds_read_b128 v[116:119], v124 offset:56320
v_fma_f32 v48, v48, v242, v242
v_mfma_f32_32x32x16_bf16 v[56:71], a[56:59], v[80:83], v[56:71]
v_fma_f32 v49, v49, v242, v242
ds_read_b128 v[72:75], v124 offset:57344
v_fma_f32 v50, v50, v242, v242
v_fma_f32 v51, v51, v242, v242
ds_read_b128 v[76:79], v124 offset:58368
v_mfma_f32_32x32x16_bf16 v[56:71], a[60:63], v[84:87], v[56:71]
v_rcp_f32 v40, v40
v_rcp_f32 v41, v41
s_waitcnt lgkmcnt(6)
v_mfma_f32_32x32x16_bf16 v[56:71], a[64:67], v[88:91], v[56:71]
v_mul_f32 v40, v40, v44
ds_read_b128 v[80:83], v124 offset:59392
v_rcp_f32 v42, v42
v_mul_f32 v41, v41, v45
v_mfma_f32_32x32x16_bf16 v[56:71], a[68:71], v[92:95], v[56:71]
ds_read_b128 v[84:87], v124 offset:60416
v_rcp_f32 v43, v43
v_mul_f32 v42, v42, v46
ds_read_b128 v[88:91], v124 offset:61440
v_mfma_f32_32x32x16_bf16 v[56:71], a[72:75], v[96:99], v[56:71]
v_rcp_f32 v48, v48
v_mul_f32 v43, v43, v47
ds_read_b128 v[92:95], v124 offset:62464
v_mfma_f32_32x32x16_bf16 v[56:71], a[76:79], v[100:103], v[56:71]
v_rcp_f32 v49, v49
v_mul_f32 v48, v48, v52
ds_read_b128 v[96:99], v124 offset:63488
s_waitcnt lgkmcnt(7)
v_mfma_f32_32x32x16_bf16 v[56:71], a[80:83], v[104:107], v[56:71]
v_rcp_f32 v50, v50
v_mul_f32 v49, v49, v53
v_rcp_f32 v51, v51
v_mfma_f32_32x32x16_bf16 v[56:71], a[84:87], v[108:111], v[56:71]
ds_read_b128 v[100:103], v124 offset:64512
v_mul_f32 v50, v50, v54
s_add_u32 s94, s76, 229376
ds_read_b128 v[104:107], v1 offset:0
v_mul_f32 v51, v51, v55
v_mfma_f32_32x32x16_bf16 v[56:71], a[88:91], v[112:115], v[56:71]
v_cvt_pk_bf16_f32 v192, v40, v41
ds_read_b128 v[108:111], v1 offset:1024
v_cvt_pk_bf16_f32 v193, v42, v43
v_mfma_f32_32x32x16_bf16 v[56:71], a[92:95], v[116:119], v[56:71]
v_cvt_pk_bf16_f32 v194, v48, v49
ds_read_b128 v[112:115], v1 offset:2048
v_cvt_pk_bf16_f32 v195, v50, v51
s_waitcnt lgkmcnt(7)
v_mfma_f32_32x32x16_bf16 v[56:71], a[96:99], v[72:75], v[56:71]
s_cmp_lg_u32 s37, 0
s_cbranch_scc1 Lalt26_b
buffer_store_dwordx4 v[192:195], v1, s[28:31], s94 offen
Lalt26_e:
ds_read_b128 v[116:119], v1 offset:3072
v_mfma_f32_32x32x16_bf16 v[56:71], a[100:103], v[76:79], v[56:71]
s_add_u32 s89, s76, 344064
ds_read_b128 v[72:75], v1 offset:4096
ds_read_b128 v[244:247], v125 offset:1536
v_mfma_f32_32x32x16_bf16 v[56:71], a[104:107], v[80:83], v[56:71]
ds_read_b128 v[76:79], v1 offset:5120
buffer_load_dword v34, v127, s[28:31], s89 offen sc1
v_mfma_f32_32x32x16_bf16 v[56:71], a[108:111], v[84:87], v[56:71]
ds_read_b128 v[80:83], v1 offset:6144
s_waitcnt lgkmcnt(8)
v_mfma_f32_32x32x16_bf16 v[56:71], a[112:115], v[88:91], v[56:71]
ds_read_b128 v[84:87], v1 offset:7168
v_mfma_f32_32x32x16_bf16 v[56:71], a[116:119], v[92:95], v[56:71]
ds_read_b128 v[88:91], v1 offset:8192
v_mfma_f32_32x32x16_bf16 v[56:71], a[120:123], v[96:99], v[56:71]
ds_read_b128 v[92:95], v1 offset:9216
v_mfma_f32_32x32x16_bf16 v[56:71], a[124:127], v[100:103], v[56:71]
ds_read_b128 v[96:99], v1 offset:10240
s_waitcnt lgkmcnt(6)
v_mfma_f32_32x32x8_bf16 v[56:71], v[120:121], v[244:245], v[56:71]
v_mfma_f32_32x32x16_bf16 v[40:55], a[128:131], v[104:107], 0
ds_read_b128 v[100:103], v1 offset:11264
v_mfma_f32_32x32x16_bf16 v[40:55], a[132:135], v[108:111], v[40:55]
s_waitcnt vmcnt(2)
s_barrier
ds_read_b128 v[104:107], v1 offset:12288
ds_read_b64_tr_b16 v[164:165], v205 offset:0
v_mfma_f32_32x32x16_bf16 v[40:55], a[136:139], v[112:115], v[40:55]
ds_read_b64_tr_b16 v[166:167], v205 offset:512
ds_read_b128 v[108:111], v1 offset:13312
ds_read_b64_tr_b16 v[160:161], v204 offset:0
v_mfma_f32_32x32x16_bf16 v[40:55], a[140:143], v[116:119], v[40:55]
ds_read_b64_tr_b16 v[162:163], v204 offset:512
ds_read_b128 v[112:115], v1 offset:14336
ds_read_b64_tr_b16 v[172:173], v205 offset:2048
v_mul_f32 v56, v247, v56
s_waitcnt lgkmcnt(12)
v_mfma_f32_32x32x16_bf16 v[40:55], a[144:147], v[72:75], v[40:55]
v_mul_f32 v57, v247, v57
ds_read_b64_tr_b16 v[174:175], v205 offset:2560
ds_read_b128 v[116:119], v1 offset:15360
v_exp_f32 v56, v56
v_mfma_f32_32x32x16_bf16 v[40:55], a[148:151], v[76:79], v[40:55]
ds_read_b64_tr_b16 v[168:169], v204 offset:2048
v_mul_f32 v58, v247, v58
ds_read_b64_tr_b16 v[170:171], v204 offset:2560
v_exp_f32 v57, v57
v_mfma_f32_32x32x16_bf16 v[40:55], a[152:155], v[80:83], v[40:55]
ds_read_b128 v[72:75], v1 offset:16384
ds_read_b64_tr_b16 v[180:181], v205 offset:4096
v_mul_f32 v59, v247, v59
ds_read_b64_tr_b16 v[182:183], v205 offset:4608
v_mfma_f32_32x32x16_bf16 v[40:55], a[156:159], v[84:87], v[40:55]
v_exp_f32 v58, v58
ds_read_b128 v[76:79], v1 offset:17408
ds_read_b64_tr_b16 v[176:177], v204 offset:4096
s_waitcnt lgkmcnt(15)
v_mfma_f32_32x32x16_bf16 v[40:55], a[160:163], v[88:91], v[40:55]
v_mul_f32 v64, v247, v64
ds_read_b64_tr_b16 v[178:179], v204 offset:4608
v_exp_f32 v59, v59
ds_read_b128 v[80:83], v1 offset:18432
v_mfma_f32_32x32x16_bf16 v[40:55], a[164:167], v[92:95], v[40:55]
ds_read_b64_tr_b16 v[188:189], v205 offset:6144
ds_read_b64_tr_b16 v[190:191], v205 offset:6656
ds_read_b64_tr_b16 v[184:185], v204 offset:6144
ds_read_b64_tr_b16 v[186:187], v204 offset:6656
v_mul_f32 v65, v247, v65
v_mfma_f32_32x32x16_bf16 v[40:55], a[168:171], v[96:99], v[40:55]
v_exp_f32 v64, v64
ds_read_b128 v[84:87], v1 offset:19456
v_mul_f32 v66, v247, v66
ds_read_b128 v[88:91], v1 offset:20480
v_mfma_f32_32x32x16_bf16 v[40:55], a[172:175], v[100:103], v[40:55]
s_waitcnt lgkmcnt(2)
s_barrier
ds_read_b128 v[92:95], v1 offset:21504
v_mfma_f32_32x32x16_bf16 v[40:55], a[176:179], v[104:107], v[40:55]
s_add_u32 m0, s46, 131072
s_lshl4_add_u32 s38, s71, 0
buffer_load_dwordx4 v208, s[20:23], s38 offen offset:0 lds
v_exp_f32 v65, v65
v_mfma_f32_32x32x16_bf16 v[40:55], a[180:183], v[108:111], v[40:55]
v_mul_f32 v67, v247, v67
v_exp_f32 v66, v66
buffer_load_dwordx4 v209, s[20:23], s38 offen offset:1024 lds
v_mfma_f32_32x32x16_bf16 v[40:55], a[184:187], v[112:115], v[40:55]
v_exp_f32 v67, v67
v_fma_f32 v56, v56, v246, v246
v_fma_f32 v57, v57, v246, v246
ds_read_b128 v[96:99], v1 offset:22528
v_mfma_f32_32x32x16_bf16 v[40:55], a[188:191], v[116:119], v[40:55]
s_add_u32 m0, s46, 131072
s_lshl4_add_u32 s38, s71, 0
buffer_load_dwordx4 v210, s[20:23], s38 offen offset:2048 lds
v_fma_f32 v58, v58, v246, v246
s_waitcnt lgkmcnt(3)
v_mfma_f32_32x32x16_bf16 v[40:55], a[192:195], v[72:75], v[40:55]
v_fma_f32 v59, v59, v246, v246
ds_read_b128 v[100:103], v1 offset:23552
v_fma_f32 v64, v64, v246, v246
buffer_load_dwordx4 v211, s[20:23], s38 offen offset:3072 lds
v_fma_f32 v65, v65, v246, v246
v_mfma_f32_32x32x16_bf16 v[40:55], a[196:199], v[76:79], v[40:55]
ds_read_b128 v[104:107], v1 offset:24576
v_fma_f32 v66, v66, v246, v246
v_fma_f32 v67, v67, v246, v246
ds_read_b128 v[108:111], v1 offset:25600
v_mfma_f32_32x32x16_bf16 v[40:55], a[200:203], v[80:83], v[40:55]
v_rcp_f32 v56, v56
v_rcp_f32 v57, v57
v_mul_f32 v56, v56, v60
v_mfma_f32_32x32x16_bf16 v[40:55], a[204:207], v[84:87], v[40:55]
ds_read_b128 v[112:115], v1 offset:26624
v_rcp_f32 v58, v58
v_mul_f32 v57, v57, v61
s_waitcnt lgkmcnt(3)
v_mfma_f32_32x32x16_bf16 v[40:55], a[208:211], v[88:91], v[40:55]
Lpage10:
s_cbranch_execz Ltour2
ds_read_b128 v[116:119], v1 offset:27648
v_rcp_f32 v59, v59
v_mul_f32 v58, v58, v62
ds_read_b128 v[72:75], v1 offset:28672
v_mfma_f32_32x32x16_bf16 v[40:55], a[212:215], v[92:95], v[40:55]
v_rcp_f32 v64, v64
v_mul_f32 v59, v59, v63
ds_read_b128 v[76:79], v1 offset:29696
ds_read_b128 v[80:83], v1 offset:30720
v_mfma_f32_32x32x16_bf16 v[40:55], a[216:219], v[96:99], v[40:55]
v_rcp_f32 v65, v65
v_mul_f32 v64, v64, v68
v_rcp_f32 v66, v66
v_mfma_f32_32x32x16_bf16 v[40:55], a[220:223], v[100:103], v[40:55]
v_mul_f32 v65, v65, v69
v_rcp_f32 v67, v67
ds_read_b128 v[84:87], v1 offset:31744
s_waitcnt lgkmcnt(4)
v_mfma_f32_32x32x16_bf16 v[40:55], a[224:227], v[104:107], v[40:55]
v_mul_f32 v66, v66, v70
s_add_u32 s94, s76, 344064
v_mul_f32 v67, v67, v71
v_cvt_pk_bf16_f32 v196, v56, v57
v_cvt_pk_bf16_f32 v197, v58, v59
v_cvt_pk_bf16_f32 v198, v64, v65
v_cvt_pk_bf16_f32 v199, v66, v67
s_cmp_lg_u32 s37, 0
s_cbranch_scc1 Lalt27_b
buffer_store_dwordx4 v[196:199], v1, s[28:31], s94 offen
Lalt27_e:
v_mfma_f32_32x32x16_bf16 v[40:55], a[228:231], v[108:111], v[40:55]
ds_read_b128 v[88:91], v1 offset:32768
ds_read_b128 v[92:95], v1 offset:33792
v_mfma_f32_32x32x16_bf16 v[40:55], a[232:235], v[112:115], v[40:55]
ds_read_b128 v[96:99], v1 offset:34816
ds_read_b128 v[100:103], v1 offset:35840
v_mfma_f32_32x32x16_bf16 v[40:55], a[236:239], v[116:119], v[40:55]
ds_read_b128 v[104:107], v1 offset:36864
ds_read_b128 v[240:243], v125 offset:0
s_waitcnt lgkmcnt(6)
v_mfma_f32_32x32x16_bf16 v[40:55], a[240:243], v[72:75], v[40:55]
ds_read_b128 v[108:111], v1 offset:37888
ds_read_b128 v[112:115], v1 offset:38912
v_mfma_f32_32x32x16_bf16 v[40:55], a[244:247], v[76:79], v[40:55]
ds_read_b128 v[116:119], v1 offset:39936
ds_read_b128 v[72:75], v1 offset:40960
v_mfma_f32_32x32x16_bf16 v[40:55], a[248:251], v[80:83], v[40:55]
ds_read_b128 v[76:79], v1 offset:41984
v_mfma_f32_32x32x16_bf16 v[40:55], a[252:255], v[84:87], v[40:55]
ds_read_b128 v[80:83], v1 offset:43008
s_waitcnt lgkmcnt(6)
v_mfma_f32_32x32x8_bf16 v[40:55], v[122:123], v[240:241], v[40:55]
v_mfma_f32_32x32x16_bf16 v[56:71], a[128:131], v[88:91], 0
s_add_u32 m0, s46, 0
s_lshl4_add_u32 s38, s72, 0
ds_read_b128 v[84:87], v1 offset:44032
v_mfma_f32_32x32x16_bf16 v[56:71], a[132:135], v[92:95], v[56:71]
s_barrier
ds_read_b128 v[88:91], v1 offset:45056
v_mfma_f32_32x32x16_bf16 v[56:71], a[136:139], v[96:99], v[56:71]
buffer_load_dwordx4 v208, s[20:23], s38 offen offset:0 lds
ds_read_b128 v[92:95], v1 offset:46080
v_mfma_f32_32x32x16_bf16 v[56:71], a[140:143], v[100:103], v[56:71]
buffer_load_dwordx4 v209, s[20:23], s38 offen offset:1024 lds
s_add_u32 m0, s46, 0
s_lshl4_add_u32 s38, s72, 0
s_waitcnt lgkmcnt(6)
v_mfma_f32_32x32x16_bf16 v[56:71], a[144:147], v[104:107], v[56:71]
s_add_u32 s91, s81, 8
v_mov_b32 v38, s91
s_waitcnt vmcnt(2)
s_cmp_lg_u32 s37, 0
s_cbranch_scc1 Lalt32_b
buffer_store_dword v38, v15, s[28:31], 0 offen
Lalt32_e:
v_mfma_f32_32x32x16_bf16 v[56:71], a[148:151], v[108:111], v[56:71]
buffer_load_dwordx4 v210, s[20:23], s38 offen offset:2048 lds
ds_read_b128 v[96:99], v1 offset:47104
v_mul_f32 v40, v243, v40
v_mul_f32 v41, v243, v41
v_mfma_f32_32x32x16_bf16 v[56:71], a[152:155], v[112:115], v[56:71]
buffer_load_dwordx4 v211, s[20:23], s38 offen offset:3072 lds
s_add_u32 m0, s46, 16384
s_lshl4_add_u32 s38, s73, 0
ds_read_b128 v[100:103], v1 offset:48128
v_mfma_f32_32x32x16_bf16 v[56:71], a[156:159], v[116:119], v[56:71]
v_exp_f32 v40, v40
v_mul_f32 v42, v243, v42
ds_read_b128 v[104:107], v1 offset:49152
s_waitcnt lgkmcnt(5)
v_mfma_f32_32x32x16_bf16 v[56:71], a[160:163], v[72:75], v[56:71]
buffer_load_dwordx4 v208, s[20:23], s38 offen offset:0 lds
v_exp_f32 v41, v41
v_mul_f32 v43, v243, v43
v_mfma_f32_32x32x16_bf16 v[56:71], a[164:167], v[76:79], v[56:71]
buffer_load_dwordx4 v209, s[20:23], s38 offen offset:1024 lds
s_add_u32 m0, s46, 16384
s_lshl4_add_u32 s38, s73, 0
v_exp_f32 v42, v42
v_mfma_f32_32x32x16_bf16 v[56:71], a[168:171], v[80:83], v[56:71]
ds_read_b128 v[108:111], v1 offset:50176
v_mul_f32 v48, v243, v48
v_exp_f32 v43, v43
ds_read_b128 v[112:115], v1 offset:51200
v_mfma_f32_32x32x16_bf16 v[56:71], a[172:175], v[84:87], v[56:71]
buffer_load_dwordx4 v210, s[20:23], s38 offen offset:2048 lds
v_mul_f32 v49, v243, v49
v_exp_f32 v48, v48
s_waitcnt lgkmcnt(3)
v_mfma_f32_32x32x16_bf16 v[56:71], a[176:179], v[88:91], v[56:71]
buffer_load_dwordx4 v211, s[20:23], s38 offen offset:3072 lds
ds_read_b128 v[116:119], v1 offset:52224
v_mul_f32 v50, v243, v50
v_exp_f32 v49, v49
v_mfma_f32_32x32x16_bf16 v[56:71], a[180:183], v[92:95], v[56:71]
ds_read_b128 v[72:75], v1 offset:53248
v_mul_f32 v51, v243, v51
v_exp_f32 v50, v50
v_exp_f32 v51, v51
v_mfma_f32_32x32x16_bf16 v[56:71], a[184:187], v[96:99], v[56:71]
ds_read_b128 v[76:79], v1 offset:54272
v_fma_f32 v40, v40, v242, v242
v_fma_f32 v41, v41, v242, v242
ds_read_b128 v[80:83], v1 offset:55296
v_fma_f32 v42, v42, v242, v242
v_mfma_f32_32x32x16_bf16 v[56:71], a[188:191], v[100:103], v[56:71]
v_fma_f32 v43, v43, v242, v242
ds_read_b128 v[84:87], v1 offset:56320
v_fma_f32 v48, v48, v242, v242
v_fma_f32 v49, v49, v242, v242
s_waitcnt lgkmcnt(4)
v_mfma_f32_32x32x16_bf16 v[56:71], a[192:195], v[104:107], v[56:71]
ds_read_b128 v[88:91], v1 offset:57344
v_fma_f32 v50, v50, v242, v242
v_fma_f32 v51, v51, v242, v242
ds_read_b128 v[92:95], v1 offset:58368
v_mfma_f32_32x32x16_bf16 v[56:71], a[196:199], v[108:111], v[56:71]
v_rcp_f32 v40, v40
v_rcp_f32 v41, v41
v_mul_f32 v40, v40, v44
v_mfma_f32_32x32x16_bf16 v[56:71], a[200:203], v[112:115], v[56:71]
ds_read_b128 v[96:99], v1 offset:59392
v_rcp_f32 v42, v42
v_mul_f32 v41, v41, v45
ds_read_b128 v[100:103], v1 offset:60416
v_mfma_f32_32x32x16_bf16 v[56:71], a[204:207], v[116:119], v[56:71]
v_rcp_f32 v43, v43
v_mul_f32 v42, v42, v46
ds_read_b128 v[104:107], v1 offset:61440
s_waitcnt lgkmcnt(5)
v_mfma_f32_32x32x16_bf16 v[56:71], a[208:211], v[72:75], v[56:71]
buffer_load_dword v38, v14, s[28:31], 0 offen sc1
v_rcp_f32 v48, v48
v_mul_f32 v43, v43, v47
v_mfma_f32_32x32x16_bf16 v[56:71], a[212:215], v[76:79], v[56:71]
ds_read_b128 v[108:111], v1 offset:62464
v_rcp_f32 v49, v49
v_mul_f32 v48, v48, v52
ds_read_b128 v[112:115], v1 offset:63488
v_mfma_f32_32x32x16_bf16 v[56:71], a[216:219], v[80:83], v[56:71]
v_rcp_f32 v50, v50
v_mul_f32 v49, v49, v53
v_rcp_f32 v51, v51
v_mfma_f32_32x32x16_bf16 v[56:71], a[220:223], v[84:87], v[56:71]
ds_read_b128 v[116:119], v1 offset:64512
v_mul_f32 v50, v50, v54
s_add_u32 s94, s76, 4096
ds_read_b128 v[72:75], v124 offset:0
s_waitcnt lgkmcnt(5)
v_mfma_f32_32x32x16_bf16 v[56:71], a[224:227], v[88:91], v[56:71]
v_mul_f32 v51, v51, v55
v_cvt_pk_bf16_f32 v192, v40, v41
v_cvt_pk_bf16_f32 v193, v42, v43
v_cvt_pk_bf16_f32 v194, v48, v49
v_cvt_pk_bf16_f32 v195, v50, v51
s_cmp_lg_u32 s37, 0
s_cbranch_scc1 Lalt28_b
buffer_store_dwordx4 v[192:195], v1, s[28:31], s94 offen
Lalt28_e:
v_mfma_f32_32x32x16_bf16 v[56:71], a[228:231], v[92:95], v[56:71]
ds_read_b128 v[76:79], v124 offset:1024
ds_read_b128 v[80:83], v124 offset:2048
v_mfma_f32_32x32x16_bf16 v[56:71], a[232:235], v[96:99], v[56:71]
ds_read_b128 v[84:87], v124 offset:3072
ds_read_b128 v[88:91], v124 offset:4096
v_mfma_f32_32x32x16_bf16 v[56:71], a[236:239], v[100:103], v[56:71]
ds_read_b128 v[244:247], v125 offset:512
ds_read_b128 v[92:95], v124 offset:5120
s_waitcnt lgkmcnt(7)
v_mfma_f32_32x32x16_bf16 v[56:71], a[240:243], v[104:107], v[56:71]
ds_read_b128 v[96:99], v124 offset:6144
ds_read_b128 v[100:103], v124 offset:7168
v_mfma_f32_32x32x16_bf16 v[56:71], a[244:247], v[108:111], v[56:71]
ds_read_b128 v[104:107], v124 offset:8192
v_mfma_f32_32x32x16_bf16 v[56:71], a[248:251], v[112:115], v[56:71]
ds_read_b128 v[108:111], v124 offset:9216
v_mfma_f32_32x32x16_bf16 v[56:71], a[252:255], v[116:119], v[56:71]
ds_read_b128 v[112:115], v124 offset:10240
s_waitcnt lgkmcnt(6)
v_mfma_f32_32x32x8_bf16 v[56:71], v[122:123], v[244:245], v[56:71]
v_mfma_f32_32x32x16_bf16 v[40:55], a[128:131], v[72:75], 0
s_add_u32 s77, s79, s69
ds_read_b128 v[116:119], v124 offset:11264
v_mfma_f32_32x32x16_bf16 v[40:55], a[132:135], v[76:79], v[40:55]
s_barrier
s_add_u32 s91, s81, 8
s_waitcnt vmcnt(1)
v_subrev_u32 v33, s91, v38
v_cmp_lt_u32 vcc, 7, v33
s_nop 0
s_and_b64 vcc, vcc, s[52:53]
s_cbranch_scc1 Ls23
Lb24:
v_mfma_f32_32x32x16_bf16 v[40:55], a[136:139], v[80:83], v[40:55]
buffer_load_dwordx4 a[0:3], v1, s[28:31], s77 offen offset:0 sc1
ds_read_b128 v[72:75], v124 offset:12288
ds_read_b128 v[76:79], v124 offset:13312
v_mfma_f32_32x32x16_bf16 v[40:55], a[140:143], v[84:87], v[40:55]
buffer_load_dwordx4 a[4:7], v1, s[28:31], s77 offen offset:1024 sc1
ds_read_b128 v[80:83], v124 offset:14336
v_mul_f32 v56, v247, v56
s_waitcnt lgkmcnt(7)
v_mfma_f32_32x32x16_bf16 v[40:55], a[144:147], v[88:91], v[40:55]
v_mul_f32 v57, v247, v57
ds_read_b128 v[84:87], v124 offset:15360
v_exp_f32 v56, v56
v_mul_f32 v58, v247, v58
v_mfma_f32_32x32x16_bf16 v[40:55], a[148:151], v[92:95], v[40:55]
buffer_load_dwordx4 a[8:11], v1, s[28:31], s77 offen offset:2048 sc1
v_exp_f32 v57, v57
ds_read_b128 v[88:91], v124 offset:16384
v_mfma_f32_32x32x16_bf16 v[40:55], a[152:155], v[96:99], v[40:55]
buffer_load_dwordx4 a[12:15], v1, s[28:31], s77 offen offset:3072 sc1
s_add_u32 s77, s79, s70
v_mul_f32 v59, v247, v59
ds_read_b128 v[92:95], v124 offset:17408
v_mfma_f32_32x32x16_bf16 v[40:55], a[156:159], v[100:103], v[40:55]
v_exp_f32 v58, v58
v_mul_f32 v64, v247, v64
ds_read_b128 v[96:99], v124 offset:18432
s_waitcnt lgkmcnt(7)
v_mfma_f32_32x32x16_bf16 v[40:55], a[160:163], v[104:107], v[40:55]
buffer_load_dwordx4 a[16:19], v1, s[28:31], s77 offen offset:0 sc1
v_exp_f32 v59, v59
v_mul_f32 v65, v247, v65
v_mfma_f32_32x32x16_bf16 v[40:55], a[164:167], v[108:111], v[40:55]
buffer_load_dwordx4 a[20:23], v1, s[28:31], s77 offen offset:1024 sc1
v_exp_f32 v64, v64
ds_read_b128 v[100:103], v124 offset:19456
v_mfma_f32_32x32x16_bf16 v[40:55], a[168:171], v[112:115], v[40:55]
v_mul_f32 v66, v247, v66
v_exp_f32 v65, v65
ds_read_b128 v[104:107], v124 offset:20480
v_mul_f32 v67, v247, v67
v_mfma_f32_32x32x16_bf16 v[40:55], a[172:175], v[116:119], v[40:55]
buffer_load_dwordx4 a[24:27], v1, s[28:31], s77 offen offset:2048 sc1
v_exp_f32 v66, v66
s_waitcnt lgkmcnt(5)
v_mfma_f32_32x32x16_bf16 v[40:55], a[176:179], v[72:75], v[40:55]
buffer_load_dwordx4 a[28:31], v1, s[28:31], s77 offen offset:3072 sc1
s_add_u32 s77, s79, s71
v_exp_f32 v67, v67
v_mfma_f32_32x32x16_bf16 v[40:55], a[180:183], v[76:79], v[40:55]
ds_read_b128 v[108:111], v124 offset:21504
v_fma_f32 v56, v56, v246, v246
v_fma_f32 v57, v57, v246, v246
ds_read_b128 v[112:115], v124 offset:22528
v_fma_f32 v58, v58, v246, v246
v_mfma_f32_32x32x16_bf16 v[40:55], a[184:187], v[80:83], v[40:55]
buffer_load_dwordx4 a[32:35], v1, s[28:31], s77 offen offset:0 sc1
v_fma_f32 v59, v59, v246, v246
ds_read_b128 v[116:119], v124 offset:23552
v_fma_f32 v64, v64, v246, v246
v_mfma_f32_32x32x16_bf16 v[40:55], a[188:191], v[84:87], v[40:55]
buffer_load_dwordx4 a[36:39], v1, s[28:31], s77 offen offset:1024 sc1
v_fma_f32 v65, v65, v246, v246
ds_read_b128 v[72:75], v124 offset:24576
s_waitcnt lgkmcnt(5)
v_mfma_f32_32x32x16_bf16 v[40:55], a[192:195], v[88:91], v[40:55]
v_fma_f32 v66, v66, v246, v246
v_fma_f32 v67, v67, v246, v246
ds_read_b128 v[76:79], v124 offset:25600
v_rcp_f32 v56, v56
v_mfma_f32_32x32x16_bf16 v[40:55], a[196:199], v[92:95], v[40:55]
buffer_load_dwordx4 a[40:43], v1, s[28:31], s77 offen offset:2048 sc1
v_rcp_f32 v57, v57
v_mul_f32 v56, v56, v60
v_mfma_f32_32x32x16_bf16 v[40:55], a[200:203], v[96:99], v[40:55]
buffer_load_dwordx4 a[44:47], v1, s[28:31], s77 offen offset:3072 sc1
s_add_u32 s77, s79, s72
ds_read_b128 v[80:83], v124 offset:26624
ds_read_b128 v[84:87], v124 offset:27648
v_mfma_f32_32x32x16_bf16 v[40:55], a[204:207], v[100:103], v[40:55]
v_rcp_f32 v58, v58
v_mul_f32 v57, v57, v61
ds_read_b128 v[88:91], v124 offset:28672
s_waitcnt lgkmcnt(5)
v_mfma_f32_32x32x16_bf16 v[40:55], a[208:211], v[104:107], v[40:55]
buffer_load_dwordx4 a[48:51], v1, s[28:31], s77 offen offset:0 sc1
v_rcp_f32 v59, v59
v_mul_f32 v58, v58, v62
v_mfma_f32_32x32x16_bf16 v[40:55], a[212:215], v[108:111], v[40:55]
buffer_load_dwordx4 a[52:55], v1, s[28:31], s77 offen offset:1024 sc1
v_rcp_f32 v64, v64
v_mul_f32 v59, v59, v63
v_mfma_f32_32x32x16_bf16 v[40:55], a[216:219], v[112:115], v[40:55]
ds_read_b128 v[92:95], v124 offset:29696
v_rcp_f32 v65, v65
v_mul_f32 v64, v64, v68
ds_read_b128 v[96:99], v124 offset:30720
v_mfma_f32_32x32x16_bf16 v[40:55], a[220:223], v[116:119], v[40:55]
buffer_load_dwordx4 a[56:59], v1, s[28:31], s77 offen offset:2048 sc1
v_rcp_f32 v66, v66
v_mul_f32 v65, v65, v69
s_waitcnt lgkmcnt(3)
v_mfma_f32_32x32x16_bf16 v[40:55], a[224:227], v[72:75], v[40:55]
v_rcp_f32 v67, v67
buffer_load_dwordx4 a[60:63], v1, s[28:31], s77 offen offset:3072 sc1
v_mul_f32 v66, v66, v70
s_add_u32 s94, s76, 118784
v_mul_f32 v67, v67, v71
v_cvt_pk_bf16_f32 v196, v56, v57
v_cvt_pk_bf16_f32 v197, v58, v59
v_cvt_pk_bf16_f32 v198, v64, v65
v_cvt_pk_bf16_f32 v199, v66, v67
s_cmp_lg_u32 s37, 0
s_cbranch_scc1 Lalt29_b
buffer_store_dwordx4 v[196:199], v1, s[28:31], s94 offen
Lalt29_e:
v_mfma_f32_32x32x16_bf16 v[40:55], a[228:231], v[76:79], v[40:55]
ds_read_b128 v[100:103], v124 offset:31744
s_add_u32 s77, s79, s73
ds_read_b128 v[104:107], v124 offset:32768
v_mfma_f32_32x32x16_bf16 v[40:55], a[232:235], v[80:83], v[40:55]
buffer_load_dwordx4 a[64:67], v1, s[28:31], s77 offen offset:0 sc1
ds_read_b128 v[108:111], v124 offset:33792
ds_read_b128 v[112:115], v124 offset:34816
v_mfma_f32_32x32x16_bf16 v[40:55], a[236:239], v[84:87], v[40:55]
buffer_load_dwordx4 a[68:71], v1, s[28:31], s77 offen offset:1024 sc1
s_add_u32 m0, s46, 32768
s_lshl4_add_u32 s38, s74, 0
s_waitcnt lgkmcnt(3)
v_mfma_f32_32x32x16_bf16 v[40:55], a[240:243], v[88:91], v[40:55]
ds_read_b128 v[240:243], v125 offset:1024
ds_read_b128 v[116:119], v124 offset:35840
v_mfma_f32_32x32x16_bf16 v[40:55], a[244:247], v[92:95], v[40:55]
buffer_load_dwordx4 v208, s[20:23], s38 offen offset:0 lds
ds_read_b128 v[72:75], v124 offset:36864
ds_read_b128 v[76:79], v124 offset:37888
v_mfma_f32_32x32x16_bf16 v[40:55], a[248:251], v[96:99], v[40:55]
buffer_load_dwordx4 v209, s[20:23], s38 offen offset:1024 lds
s_add_u32 m0, s46, 32768
s_lshl4_add_u32 s38, s74, 0
ds_read_b128 v[80:83], v124 offset:38912
v_mfma_f32_32x32x16_bf16 v[40:55], a[252:255], v[100:103], v[40:55]
ds_read_b128 v[84:87], v124 offset:39936
ds_read_b128 v[88:91], v124 offset:40960
s_waitcnt lgkmcnt(6)
v_mfma_f32_32x32x8_bf16 v[40:55], v[122:123], v[240:241], v[40:55]
buffer_load_dwordx4 v210, s[20:23], s38 offen offset:2048 lds
ds_read_b128 v[92:95], v124 offset:41984
ds_read_b128 v[96:99], v124 offset:43008
s_waitcnt lgkmcnt(7)
v_mfma_f32_32x32x16_bf16 v[56:71], a[128:131], v[104:107], 0
buffer_load_dwordx4 v211, s[20:23], s38 offen offset:3072 lds
ds_read_b128 v[100:103], v124 offset:44032
v_mfma_f32_32x32x16_bf16 v[56:71], a[132:135], v[108:111], v[56:71]
s_barrier
ds_read_b128 v[104:107], v124 offset:45056
v_mfma_f32_32x32x16_bf16 v[56:71], a[136:139], v[112:115], v[56:71]
buffer_load_dwordx4 a[72:75], v1, s[28:31], s77 offen offset:2048 sc1
ds_read_b128 v[108:111], v124 offset:46080
v_mfma_f32_32x32x16_bf16 v[56:71], a[140:143], v[116:119], v[56:71]
buffer_load_dwordx4 a[76:79], v1, s[28:31], s77 offen offset:3072 sc1
s_add_u32 s77, s79, s74
ds_read_b128 v[112:115], v124 offset:47104
s_waitcnt lgkmcnt(7)
v_mfma_f32_32x32x16_bf16 v[56:71], a[144:147], v[72:75], v[56:71]
v_mul_f32 v40, v243, v40
v_mul_f32 v41, v243, v41
ds_read_b128 v[116:119], v124 offset:48128
v_exp_f32 v40, v40
v_mfma_f32_32x32x16_bf16 v[56:71], a[148:151], v[76:79], v[56:71]
buffer_load_dwordx4 a[80:83], v1, s[28:31], s77 offen offset:0 sc1
v_mul_f32 v42, v243, v42
v_exp_f32 v41, v41
v_mfma_f32_32x32x16_bf16 v[56:71], a[152:155], v[80:83], v[56:71]
buffer_load_dwordx4 a[84:87], v1, s[28:31], s77 offen offset:1024 sc1
s_add_u32 m0, s46, 49152
s_lshl4_add_u32 s38, s75, 0
ds_read_b128 v[72:75], v124 offset:49152
v_mfma_f32_32x32x16_bf16 v[56:71], a[156:159], v[84:87], v[56:71]
v_mul_f32 v43, v243, v43
v_exp_f32 v42, v42
ds_read_b128 v[76:79], v124 offset:50176
s_waitcnt lgkmcnt(6)
v_mfma_f32_32x32x16_bf16 v[56:71], a[160:163], v[88:91], v[56:71]
buffer_load_dwordx4 v208, s[20:23], s38 offen offset:0 lds
v_mul_f32 v48, v243, v48
v_exp_f32 v43, v43
v_mfma_f32_32x32x16_bf16 v[56:71], a[164:167], v[92:95], v[56:71]
buffer_load_dwordx4 v209, s[20:23], s38 offen offset:1024 lds
s_add_u32 m0, s46, 49152
s_lshl4_add_u32 s38, s75, 0
ds_read_b128 v[80:83], v124 offset:51200
v_mfma_f32_32x32x16_bf16 v[56:71], a[168:171], v[96:99], v[56:71]
v_mul_f32 v49, v243, v49
v_exp_f32 v48, v48
ds_read_b128 v[84:87], v124 offset:52224
v_mul_f32 v50, v243, v50
v_mfma_f32_32x32x16_bf16 v[56:71], a[172:175], v[100:103], v[56:71]
buffer_load_dwordx4 v210, s[20:23], s38 offen offset:2048 lds
v_exp_f32 v49, v49
s_waitcnt lgkmcnt(4)
v_mfma_f32_32x32x16_bf16 v[56:71], a[176:179], v[104:107], v[56:71]
buffer_load_dwordx4 v211, s[20:23], s38 offen offset:3072 lds
ds_read_b128 v[88:91], v124 offset:53248
v_mul_f32 v51, v243, v51
ds_read_b128 v[92:95], v124 offset:54272
v_mfma_f32_32x32x16_bf16 v[56:71], a[180:183], v[108:111], v[56:71]
v_exp_f32 v50, v50
v_exp_f32 v51, v51
v_fma_f32 v40, v40, v242, v242
v_mfma_f32_32x32x16_bf16 v[56:71], a[184:187], v[112:115], v[56:71]
buffer_load_dwordx4 a[88:91], v1, s[28:31], s77 offen offset:2048 sc1
v_fma_f32 v41, v41, v242, v242
ds_read_b128 v[96:99], v124 offset:55296
v_fma_f32 v42, v42, v242, v242
v_mfma_f32_32x32x16_bf16 v[56:71], a[188:191], v[116:119], v[56:71]
buffer_load_dwordx4 a[92:95], v1, s[28:31], s77 offen offset:3072 sc1
s_add_u32 s77, s79, s75
v_fma_f32 v43, v43, v242, v242
s_waitcnt lgkmcnt(3)
v_mfma_f32_32x32x16_bf16 v[56:71], a[192:195], v[72:75], v[56:71]
ds_read_b128 v[100:103], v124 offset:56320
v_fma_f32 v48, v48, v242, v242
v_fma_f32 v49, v49, v242, v242
ds_read_b128 v[104:107], v124 offset:57344
v_fma_f32 v50, v50, v242, v242
v_mfma_f32_32x32x16_bf16 v[56:71], a[196:199], v[76:79], v[56:71]
buffer_load_dwordx4 a[96:99], v1, s[28:31], s77 offen offset:0 sc1
v_fma_f32 v51, v51, v242, v242
ds_read_b128 v[108:111], v124 offset:58368
ds_read_b128 v[112:115], v124 offset:59392
v_mfma_f32_32x32x16_bf16 v[56:71], a[200:203], v[80:83], v[56:71]
buffer_load_dwordx4 a[100:103], v1, s[28:31], s77 offen offset:1024 sc1
s_add_u32 m0, s46, 65536
s_lshl4_add_u32 s38, s69, 65536
v_rcp_f32 v40, v40
v_mfma_f32_32x32x16_bf16 v[56:71], a[204:207], v[84:87], v[56:71]
v_rcp_f32 v41, v41
v_mul_f32 v40, v40, v44
v_rcp_f32 v42, v42
s_waitcnt lgkmcnt(3)
v_mfma_f32_32x32x16_bf16 v[56:71], a[208:211], v[88:91], v[56:71]
buffer_load_dwordx4 v208, s[20:23], s38 offen offset:0 lds
v_mul_f32 v41, v41, v45
ds_read_b128 v[116:119], v124 offset:60416
v_rcp_f32 v43, v43
v_mfma_f32_32x32x16_bf16 v[56:71], a[212:215], v[92:95], v[56:71]
buffer_load_dwordx4 v209, s[20:23], s38 offen offset:1024 lds
v_mul_f32 v42, v42, v46
ds_read_b128 v[72:75], v124 offset:61440
s_add_u32 m0, s46, 65536
v_mfma_f32_32x32x16_bf16 v[56:71], a[216:219], v[96:99], v[56:71]
s_lshl4_add_u32 s38, s69, 65536
v_rcp_f32 v48, v48
v_mul_f32 v43, v43, v47
ds_read_b128 v[76:79], v124 offset:62464
v_mfma_f32_32x32x16_bf16 v[56:71], a[220:223], v[100:103], v[56:71]
buffer_load_dwordx4 v210, s[20:23], s38 offen offset:2048 lds
v_rcp_f32 v49, v49
v_mul_f32 v48, v48, v52
s_waitcnt lgkmcnt(2)
v_mfma_f32_32x32x16_bf16 v[56:71], a[224:227], v[104:107], v[56:71]
v_rcp_f32 v50, v50
v_mul_f32 v49, v49, v53
v_rcp_f32 v51, v51
buffer_load_dwordx4 v211, s[20:23], s38 offen offset:3072 lds
v_mul_f32 v50, v50, v54
s_add_u32 s94, s76, 233472
v_mul_f32 v51, v51, v55
v_cvt_pk_bf16_f32 v192, v40, v41
v_cvt_pk_bf16_f32 v193, v42, v43
v_cvt_pk_bf16_f32 v194, v48, v49
v_cvt_pk_bf16_f32 v195, v50, v51
s_cmp_lg_u32 s37, 0
s_cbranch_scc1 Lalt30_b
buffer_store_dwordx4 v[192:195], v1, s[28:31], s94 offen
Lalt30_e:
v_mfma_f32_32x32x16_bf16 v[56:71], a[228:231], v[108:111], v[56:71]
ds_read_b128 v[80:83], v124 offset:63488
ds_read_b128 v[84:87], v124 offset:64512
v_mfma_f32_32x32x16_bf16 v[56:71], a[232:235], v[112:115], v[56:71]
buffer_load_dwordx4 a[104:107], v1, s[28:31], s77 offen offset:2048 sc1
ds_read_b128 v[244:247], v125 offset:1536
v_lshlrev_b32 v40, 16, v16
v_and_b32 v41, 0xffff0000, v16
v_mfma_f32_32x32x16_bf16 v[56:71], a[236:239], v[116:119], v[56:71]
buffer_load_dwordx4 a[108:111], v1, s[28:31], s77 offen offset:3072 sc1
v_lshlrev_b32 v42, 16, v17
v_and_b32 v43, 0xffff0000, v17
s_waitcnt lgkmcnt(1)
v_mfma_f32_32x32x16_bf16 v[56:71], a[240:243], v[72:75], v[56:71]
v_lshlrev_b32 v44, 16, v18
v_and_b32 v45, 0xffff0000, v18
v_lshlrev_b32 v46, 16, v19
v_and_b32 v47, 0xffff0000, v19
v_lshlrev_b32 v48, 16, v20
v_mfma_f32_32x32x16_bf16 v[56:71], a[244:247], v[76:79], v[56:71]
v_and_b32 v49, 0xffff0000, v20
v_lshlrev_b32 v50, 16, v21
v_and_b32 v51, 0xffff0000, v21
v_lshlrev_b32 v52, 16, v22
v_and_b32 v53, 0xffff0000, v22
v_mfma_f32_32x32x16_bf16 v[56:71], a[248:251], v[80:83], v[56:71]
v_lshlrev_b32 v54, 16, v23
v_and_b32 v55, 0xffff0000, v23
v_mfma_f32_32x32x16_bf16 v[56:71], a[252:255], v[84:87], v[56:71]
s_waitcnt lgkmcnt(0)
v_mfma_f32_32x32x8_bf16 v[56:71], v[122:123], v[244:245], v[56:71]
Lp3join25:
s_waitcnt vmcnt(41)
v_mfma_f32_32x32x16_bf16 v[104:119], v[132:135], a[0:3], 0
s_barrier
v_mfma_f32_32x32x16_bf16 v[40:55], v[128:131], a[0:3], v[40:55]
s_waitcnt vmcnt(40)
v_mfma_f32_32x32x16_bf16 v[104:119], v[140:143], a[4:7], v[104:119]
s_nop 5
v_mul_f32 v56, v247, v56
v_mul_f32 v57, v247, v57
v_exp_f32 v56, v56
v_mul_f32 v58, v247, v58
v_mfma_f32_32x32x16_bf16 v[40:55], v[136:139], a[4:7], v[40:55]
v_exp_f32 v57, v57
v_mul_f32 v59, v247, v59
v_exp_f32 v58, v58
s_waitcnt vmcnt(39)
v_mfma_f32_32x32x16_bf16 v[104:119], v[148:151], a[8:11], v[104:119]
v_mul_f32 v64, v247, v64
v_exp_f32 v59, v59
v_mul_f32 v65, v247, v65
v_mfma_f32_32x32x16_bf16 v[40:55], v[144:147], a[8:11], v[40:55]
v_exp_f32 v64, v64
v_mul_f32 v66, v247, v66
v_exp_f32 v65, v65
s_waitcnt vmcnt(38)
v_mfma_f32_32x32x16_bf16 v[104:119], v[156:159], a[12:15], v[104:119]
v_mul_f32 v67, v247, v67
v_exp_f32 v66, v66
v_exp_f32 v67, v67
v_mfma_f32_32x32x16_bf16 v[40:55], v[152:155], a[12:15], v[40:55]
v_fma_f32 v56, v56, v246, v246
v_fma_f32 v57, v57, v246, v246
v_fma_f32 v58, v58, v246, v246
v_fma_f32 v59, v59, v246, v246
s_waitcnt vmcnt(37)
v_mfma_f32_32x32x16_bf16 v[104:119], v[164:167], a[16:19], v[104:119]
v_fma_f32 v64, v64, v246, v246
v_fma_f32 v65, v65, v246, v246
v_fma_f32 v66, v66, v246, v246
v_fma_f32 v67, v67, v246, v246
v_mfma_f32_32x32x16_bf16 v[40:55], v[160:163], a[16:19], v[40:55]
s_add_u32 m0, s46, 81920
s_lshl4_add_u32 s38, s70, 65536
v_rcp_f32 v56, v56
ds_read_b64_tr_b16 v[92:93], v205 offset:0
s_waitcnt vmcnt(36)
v_mfma_f32_32x32x16_bf16 v[104:119], v[172:175], a[20:23], v[104:119]
v_rcp_f32 v57, v57
v_mul_f32 v56, v56, v60
v_rcp_f32 v58, v58
v_mul_f32 v57, v57, v61
v_rcp_f32 v59, v59
v_mul_f32 v58, v58, v62
v_rcp_f32 v64, v64
v_mul_f32 v59, v59, v63
v_rcp_f32 v65, v65
v_mul_f32 v64, v64, v68
v_rcp_f32 v66, v66
v_mul_f32 v65, v65, v69
v_rcp_f32 v67, v67
v_mul_f32 v66, v66, v70
s_add_u32 s94, s76, 348160
v_mul_f32 v67, v67, v71
v_cvt_pk_bf16_f32 v196, v56, v57
v_cvt_pk_bf16_f32 v197, v58, v59
v_cvt_pk_bf16_f32 v198, v64, v65
v_cvt_pk_bf16_f32 v199, v66, v67
s_cmp_lg_u32 s37, 0
s_cbranch_scc1 Lalt31_b
buffer_store_dwordx4 v[196:199], v1, s[28:31], s94 offen
Lalt31_e:
v_mfma_f32_32x32x16_bf16 v[40:55], v[168:171], a[20:23], v[40:55]
buffer_load_dwordx4 v208, s[20:23], s38 offen offset:0 lds
ds_read_b64_tr_b16 v[94:95], v205 offset:512
ds_read_b64_tr_b16 v[88:89], v204 offset:0
ds_read_b64_tr_b16 v[90:91], v204 offset:512
s_waitcnt vmcnt(37)
v_mfma_f32_32x32x16_bf16 v[104:119], v[180:183], a[24:27], v[104:119]
buffer_load_dwordx4 v209, s[20:23], s38 offen offset:1024 lds
s_add_u32 m0, s46, 81920
s_lshl4_add_u32 s38, s70, 65536
ds_read_b64_tr_b16 v[100:101], v205 offset:2048
v_mfma_f32_32x32x16_bf16 v[40:55], v[176:179], a[24:27], v[40:55]
ds_read_b64_tr_b16 v[102:103], v205 offset:2560
ds_read_b64_tr_b16 v[96:97], v204 offset:2048
ds_read_b64_tr_b16 v[98:99], v204 offset:2560
ds_read_b64_tr_b16 v[76:77], v205 offset:4096
s_waitcnt vmcnt(37)
v_mfma_f32_32x32x16_bf16 v[104:119], v[188:191], a[28:31], v[104:119]
buffer_load_dwordx4 v210, s[20:23], s38 offen offset:2048 lds
ds_read_b64_tr_b16 v[78:79], v205 offset:4608
ds_read_b64_tr_b16 v[72:73], v204 offset:4096
ds_read_b64_tr_b16 v[74:75], v204 offset:4608
v_mfma_f32_32x32x16_bf16 v[40:55], v[184:187], a[28:31], v[40:55]
buffer_load_dwordx4 v211, s[20:23], s38 offen offset:3072 lds
s_add_u32 m0, s46, 98304
s_lshl4_add_u32 s38, s71, 65536
s_waitcnt lgkmcnt(8)
s_waitcnt vmcnt(38)
v_mfma_f32_32x32x16_bf16 v[104:119], v[92:95], a[32:35], v[104:119]
ds_read_b64_tr_b16 v[84:85], v205 offset:6144
ds_read_b64_tr_b16 v[86:87], v205 offset:6656
ds_read_b64_tr_b16 v[80:81], v204 offset:6144
ds_read_b64_tr_b16 v[82:83], v204 offset:6656
v_mfma_f32_32x32x16_bf16 v[40:55], v[88:91], a[32:35], v[40:55]
buffer_load_dwordx4 v208, s[20:23], s38 offen offset:0 lds
s_add_u32 s91, s81, 9
v_mov_b32 v38, s91
s_waitcnt vmcnt(5)
s_cmp_lg_u32 s37, 0
s_cbranch_scc1 Lalt33_b
buffer_store_dword v38, v15, s[28:31], 0 offen
Lalt33_e:
s_waitcnt lgkmcnt(8)
v_mfma_f32_32x32x16_bf16 v[104:119], v[100:103], a[36:39], v[104:119]
buffer_load_dwordx4 v209, s[20:23], s38 offen offset:1024 lds
Lpage11:
s_cbranch_execz Ltour2
s_add_u32 m0, s46, 98304
s_lshl4_add_u32 s38, s71, 65536
ds_read_b64_tr_b16 v[92:93], v201 offset:0
v_mfma_f32_32x32x16_bf16 v[40:55], v[96:99], a[36:39], v[40:55]
ds_read_b64_tr_b16 v[94:95], v201 offset:512
ds_read_b64_tr_b16 v[88:89], v200 offset:0
ds_read_b64_tr_b16 v[90:91], v200 offset:512
ds_read_b64_tr_b16 v[100:101], v201 offset:2048
s_waitcnt lgkmcnt(9)
v_mfma_f32_32x32x16_bf16 v[104:119], v[76:79], a[40:43], v[104:119]
buffer_load_dwordx4 v210, s[20:23], s38 offen offset:2048 lds
ds_read_b64_tr_b16 v[102:103], v201 offset:2560
ds_read_b64_tr_b16 v[96:97], v200 offset:2048
ds_read_b64_tr_b16 v[98:99], v200 offset:2560
v_mfma_f32_32x32x16_bf16 v[40:55], v[72:75], a[40:43], v[40:55]
buffer_load_dwordx4 v211, s[20:23], s38 offen offset:3072 lds
s_add_u32 m0, s46, 114688
s_lshl4_add_u32 s38, s72, 65536
s_waitcnt lgkmcnt(8)
v_mfma_f32_32x32x16_bf16 v[104:119], v[84:87], a[44:47], v[104:119]
ds_read_b64_tr_b16 v[76:77], v201 offset:4096
ds_read_b64_tr_b16 v[78:79], v201 offset:4608
ds_read_b64_tr_b16 v[72:73], v200 offset:4096
ds_read_b64_tr_b16 v[74:75], v200 offset:4608
v_mfma_f32_32x32x16_bf16 v[40:55], v[80:83], a[44:47], v[40:55]
buffer_load_dwordx4 v208, s[20:23], s38 offen offset:0 lds
ds_read_b64_tr_b16 v[84:85], v201 offset:6144
ds_read_b64_tr_b16 v[86:87], v201 offset:6656
s_waitcnt lgkmcnt(10)
v_mfma_f32_32x32x16_bf16 v[104:119], v[92:95], a[48:51], v[104:119]
buffer_load_dwordx4 v209, s[20:23], s38 offen offset:1024 lds
s_add_u32 m0, s46, 114688
s_lshl4_add_u32 s38, s72, 65536
ds_read_b64_tr_b16 v[80:81], v200 offset:6144
v_mfma_f32_32x32x16_bf16 v[40:55], v[88:91], a[48:51], v[40:55]
ds_read_b64_tr_b16 v[82:83], v200 offset:6656
ds_read_b64_tr_b16 v[92:93], v201 offset:16384
ds_read_b64_tr_b16 v[94:95], v201 offset:16896
s_waitcnt lgkmcnt(10)
v_mfma_f32_32x32x16_bf16 v[104:119], v[100:103], a[52:55], v[104:119]
buffer_load_dwordx4 v210, s[20:23], s38 offen offset:2048 lds
ds_read_b64_tr_b16 v[88:89], v200 offset:16384
ds_read_b64_tr_b16 v[90:91], v200 offset:16896
v_mfma_f32_32x32x16_bf16 v[40:55], v[96:99], a[52:55], v[40:55]
buffer_load_dwordx4 v211, s[20:23], s38 offen offset:3072 lds
ds_read_b64_tr_b16 v[100:101], v201 offset:18432
ds_read_b64_tr_b16 v[102:103], v201 offset:18944
s_waitcnt lgkmcnt(10)
v_mfma_f32_32x32x16_bf16 v[104:119], v[76:79], a[56:59], v[104:119]
ds_read_b64_tr_b16 v[96:97], v200 offset:18432
ds_read_b64_tr_b16 v[98:99], v200 offset:18944
v_mfma_f32_32x32x16_bf16 v[40:55], v[72:75], a[56:59], v[40:55]
ds_read_b64_tr_b16 v[76:77], v201 offset:20480
ds_read_b64_tr_b16 v[78:79], v201 offset:20992
s_waitcnt lgkmcnt(10)
v_mfma_f32_32x32x16_bf16 v[104:119], v[84:87], a[60:63], v[104:119]
buffer_load_dword v127, v14, s[28:31], 0 offen sc1
ds_read_b64_tr_b16 v[72:73], v200 offset:20480
ds_read_b64_tr_b16 v[74:75], v200 offset:20992
v_mfma_f32_32x32x16_bf16 v[40:55], v[80:83], a[60:63], v[40:55]
ds_read_b64_tr_b16 v[84:85], v201 offset:22528
ds_read_b64_tr_b16 v[86:87], v201 offset:23040
s_waitcnt lgkmcnt(10)
v_mfma_f32_32x32x16_bf16 v[104:119], v[92:95], a[64:67], v[104:119]
ds_read_b64_tr_b16 v[80:81], v200 offset:22528
ds_read_b64_tr_b16 v[82:83], v200 offset:23040
v_mfma_f32_32x32x16_bf16 v[40:55], v[88:91], a[64:67], v[40:55]
s_add_u32 m0, s46, 131072
s_lshl4_add_u32 s38, s73, 65536
s_waitcnt lgkmcnt(8)
v_mfma_f32_32x32x16_bf16 v[104:119], v[100:103], a[68:71], v[104:119]
s_barrier
ds_read_b64_tr_b16 v[92:93], v201 offset:32768
ds_read_b64_tr_b16 v[88:89], v200 offset:32768
v_mfma_f32_32x32x16_bf16 v[40:55], v[96:99], a[68:71], v[40:55]
buffer_load_dwordx4 v208, s[20:23], s38 offen offset:0 lds
ds_read_b64_tr_b16 v[94:95], v201 offset:33280
ds_read_b64_tr_b16 v[90:91], v200 offset:33280
s_waitcnt lgkmcnt(8)
v_mfma_f32_32x32x16_bf16 v[104:119], v[76:79], a[72:75], v[104:119]
buffer_load_dwordx4 v209, s[20:23], s38 offen offset:1024 lds
s_add_u32 m0, s46, 131072
s_lshl4_add_u32 s38, s73, 65536
ds_read_b64_tr_b16 v[100:101], v201 offset:34816
v_mfma_f32_32x32x16_bf16 v[40:55], v[72:75], a[72:75], v[40:55]
ds_read_b64_tr_b16 v[102:103], v201 offset:35328
ds_read_b64_tr_b16 v[96:97], v200 offset:34816
ds_read_b64_tr_b16 v[98:99], v200 offset:35328
ds_read_b64_tr_b16 v[76:77], v201 offset:36864
s_waitcnt lgkmcnt(9)
v_mfma_f32_32x32x16_bf16 v[104:119], v[84:87], a[76:79], v[104:119]
buffer_load_dwordx4 v210, s[20:23], s38 offen offset:2048 lds
ds_read_b64_tr_b16 v[78:79], v201 offset:37376
ds_read_b64_tr_b16 v[72:73], v200 offset:36864
ds_read_b64_tr_b16 v[74:75], v200 offset:37376
v_mfma_f32_32x32x16_bf16 v[40:55], v[80:83], a[76:79], v[40:55]
buffer_load_dwordx4 v211, s[20:23], s38 offen offset:3072 lds
ds_read_b64_tr_b16 v[84:85], v201 offset:38912
ds_read_b64_tr_b16 v[86:87], v201 offset:39424
s_waitcnt lgkmcnt(10)
v_mfma_f32_32x32x16_bf16 v[104:119], v[92:95], a[80:83], v[104:119]
ds_read_b64_tr_b16 v[80:81], v200 offset:38912
ds_read_b64_tr_b16 v[82:83], v200 offset:39424
v_mfma_f32_32x32x16_bf16 v[40:55], v[88:91], a[80:83], v[40:55]
s_add_u32 m0, s46, 16384
s_lshl4_add_u32 s38, s74, 65536
s_waitcnt lgkmcnt(8)
v_mfma_f32_32x32x16_bf16 v[104:119], v[100:103], a[84:87], v[104:119]
s_barrier
ds_read_b64_tr_b16 v[92:93], v201 offset:49152
ds_read_b64_tr_b16 v[88:89], v200 offset:49152
v_mfma_f32_32x32x16_bf16 v[40:55], v[96:99], a[84:87], v[40:55]
buffer_load_dwordx4 v208, s[20:23], s38 offen offset:0 lds
s_add_u32 s91, s81, 9
s_waitcnt vmcnt(5)
v_subrev_u32 v33, s91, v127
v_cmp_lt_u32 vcc, 7, v33
s_nop 0
s_and_b64 vcc, vcc, s[52:53]
s_cbranch_scc1 Ls26
Lb27:
s_waitcnt lgkmcnt(6)
v_mfma_f32_32x32x16_bf16 v[104:119], v[76:79], a[88:91], v[104:119]
buffer_load_dwordx4 v209, s[20:23], s38 offen offset:1024 lds
s_add_u32 m0, s46, 16384
s_lshl4_add_u32 s38, s74, 65536
ds_read_b64_tr_b16 v[94:95], v201 offset:49664
v_mfma_f32_32x32x16_bf16 v[40:55], v[72:75], a[88:91], v[40:55]
ds_read_b64_tr_b16 v[90:91], v200 offset:49664
ds_read_b64_tr_b16 v[100:101], v201 offset:51200
ds_read_b64_tr_b16 v[102:103], v201 offset:51712
ds_read_b64_tr_b16 v[96:97], v200 offset:51200
s_waitcnt lgkmcnt(7)
v_mfma_f32_32x32x16_bf16 v[104:119], v[84:87], a[92:95], v[104:119]
buffer_load_dwordx4 v210, s[20:23], s38 offen offset:2048 lds
ds_read_b64_tr_b16 v[98:99], v200 offset:51712
ds_read_b64_tr_b16 v[76:77], v201 offset:53248
ds_read_b64_tr_b16 v[78:79], v201 offset:53760
v_mfma_f32_32x32x16_bf16 v[40:55], v[80:83], a[92:95], v[40:55]
buffer_load_dwordx4 v211, s[20:23], s38 offen offset:3072 lds
s_add_u32 s77, s80, s69
ds_read_b64_tr_b16 v[72:73], v200 offset:53248
s_waitcnt lgkmcnt(7)
v_mfma_f32_32x32x16_bf16 v[104:119], v[92:95], a[96:99], v[104:119]
ds_read_b64_tr_b16 v[74:75], v200 offset:53760
ds_read_b64_tr_b16 v[84:85], v201 offset:55296
ds_read_b64_tr_b16 v[86:87], v201 offset:55808
ds_read_b64_tr_b16 v[80:81], v200 offset:55296
v_mfma_f32_32x32x16_bf16 v[40:55], v[88:91], a[96:99], v[40:55]
buffer_load_dwordx4 a[128:131], v1, s[28:31], s77 offen offset:0 sc1
ds_read_b64_tr_b16 v[82:83], v200 offset:55808
s_waitcnt lgkmcnt(8)
v_mfma_f32_32x32x16_bf16 v[104:119], v[100:103], a[100:103], v[104:119]
s_barrier
buffer_load_dwordx4 a[132:135], v1, s[28:31], s77 offen offset:1024 sc1
v_mfma_f32_32x32x16_bf16 v[40:55], v[96:99], a[100:103], v[40:55]
ds_read_b64_tr_b16 v[92:93], v203 offset:0
ds_read_b64_tr_b16 v[88:89], v202 offset:0
ds_read_b64_tr_b16 v[94:95], v203 offset:512
ds_read_b64_tr_b16 v[90:91], v202 offset:512
s_waitcnt lgkmcnt(8)
v_mfma_f32_32x32x16_bf16 v[104:119], v[76:79], a[104:107], v[104:119]
buffer_load_dwordx4 a[136:139], v1, s[28:31], s77 offen offset:2048 sc1
ds_read_b64_tr_b16 v[100:101], v203 offset:2048
ds_read_b64_tr_b16 v[102:103], v203 offset:2560
ds_read_b64_tr_b16 v[96:97], v202 offset:2048
v_mfma_f32_32x32x16_bf16 v[40:55], v[72:75], a[104:107], v[40:55]
buffer_load_dwordx4 a[140:143], v1, s[28:31], s77 offen offset:3072 sc1
s_add_u32 s77, s80, s70
ds_read_b64_tr_b16 v[98:99], v202 offset:2560
s_waitcnt lgkmcnt(8)
v_mfma_f32_32x32x16_bf16 v[104:119], v[84:87], a[108:111], v[104:119]
ds_read_b64_tr_b16 v[76:77], v203 offset:4096
ds_read_b64_tr_b16 v[78:79], v203 offset:4608
ds_read_b64_tr_b16 v[72:73], v202 offset:4096
ds_read_b64_tr_b16 v[74:75], v202 offset:4608
v_mfma_f32_32x32x16_bf16 v[40:55], v[80:83], a[108:111], v[40:55]
buffer_load_dwordx4 a[144:147], v1, s[28:31], s77 offen offset:0 sc1
ds_read_b64_tr_b16 v[84:85], v203 offset:6144
ds_read_b64_tr_b16 v[86:87], v203 offset:6656
s_waitcnt lgkmcnt(10)
s_waitcnt vmcnt(4)
v_mfma_f32_32x32x16_bf16 v[104:119], v[92:95], a[128:131], v[104:119]
buffer_load_dwordx4 a[148:151], v1, s[28:31], s77 offen offset:1024 sc1
ds_read_b64_tr_b16 v[80:81], v202 offset:6144
ds_read_b64_tr_b16 v[82:83], v202 offset:6656
v_mfma_f32_32x32x16_bf16 v[40:55], v[88:91], a[128:131], v[40:55]
s_waitcnt lgkmcnt(8)
s_waitcnt vmcnt(4)
v_mfma_f32_32x32x16_bf16 v[104:119], v[100:103], a[132:135], v[104:119]
s_barrier
buffer_load_dwordx4 a[152:155], v1, s[28:31], s77 offen offset:2048 sc1
v_mfma_f32_32x32x16_bf16 v[40:55], v[96:99], a[132:135], v[40:55]
buffer_load_dwordx4 a[156:159], v1, s[28:31], s77 offen offset:3072 sc1
s_add_u32 s77, s80, s71
ds_read_b64_tr_b16 v[92:93], v203 offset:16384
s_waitcnt lgkmcnt(5)
s_waitcnt vmcnt(5)
v_mfma_f32_32x32x16_bf16 v[104:119], v[76:79], a[136:139], v[104:119]
ds_read_b64_tr_b16 v[88:89], v202 offset:16384
ds_read_b64_tr_b16 v[94:95], v203 offset:16896
ds_read_b64_tr_b16 v[90:91], v202 offset:16896
ds_read_b64_tr_b16 v[100:101], v203 offset:18432
v_mfma_f32_32x32x16_bf16 v[40:55], v[72:75], a[136:139], v[40:55]
buffer_load_dwordx4 a[160:163], v1, s[28:31], s77 offen offset:0 sc1
ds_read_b64_tr_b16 v[102:103], v203 offset:18944
ds_read_b64_tr_b16 v[96:97], v202 offset:18432
s_waitcnt lgkmcnt(7)
s_waitcnt vmcnt(5)
v_mfma_f32_32x32x16_bf16 v[104:119], v[84:87], a[140:143], v[104:119]
buffer_load_dwordx4 a[164:167], v1, s[28:31], s77 offen offset:1024 sc1
ds_read_b64_tr_b16 v[98:99], v202 offset:18944
ds_read_b64_tr_b16 v[76:77], v203 offset:20480
ds_read_b64_tr_b16 v[78:79], v203 offset:20992
v_mfma_f32_32x32x16_bf16 v[40:55], v[80:83], a[140:143], v[40:55]
ds_read_b64_tr_b16 v[72:73], v202 offset:20480
ds_read_b64_tr_b16 v[74:75], v202 offset:20992
ds_read_b64_tr_b16 v[84:85], v203 offset:22528
ds_read_b64_tr_b16 v[86:87], v203 offset:23040
s_waitcnt lgkmcnt(10)
s_waitcnt vmcnt(5)
v_mfma_f32_32x32x16_bf16 v[104:119], v[92:95], a[144:147], v[104:119]
buffer_load_dwordx4 a[168:171], v1, s[28:31], s77 offen offset:2048 sc1
ds_read_b64_tr_b16 v[80:81], v202 offset:22528
ds_read_b64_tr_b16 v[82:83], v202 offset:23040
v_mfma_f32_32x32x16_bf16 v[40:55], v[88:91], a[144:147], v[40:55]
buffer_load_dwordx4 a[172:175], v1, s[28:31], s77 offen offset:3072 sc1
s_add_u32 s77, s80, s72
s_waitcnt lgkmcnt(8)
s_waitcnt vmcnt(6)
v_mfma_f32_32x32x16_bf16 v[104:119], v[100:103], a[148:151], v[104:119]
s_barrier
ds_read_b64_tr_b16 v[92:93], v203 offset:32768
ds_read_b64_tr_b16 v[88:89], v202 offset:32768
v_mfma_f32_32x32x16_bf16 v[40:55], v[96:99], a[148:151], v[40:55]
buffer_load_dwordx4 a[176:179], v1, s[28:31], s77 offen offset:0 sc1
ds_read_b64_tr_b16 v[94:95], v203 offset:33280
ds_read_b64_tr_b16 v[90:91], v202 offset:33280
s_waitcnt lgkmcnt(8)
s_waitcnt vmcnt(6)
v_mfma_f32_32x32x16_bf16 v[104:119], v[76:79], a[152:155], v[104:119]
buffer_load_dwordx4 a[180:183], v1, s[28:31], s77 offen offset:1024 sc1
ds_read_b64_tr_b16 v[100:101], v203 offset:34816
ds_read_b64_tr_b16 v[102:103], v203 offset:35328
ds_read_b64_tr_b16 v[96:97], v202 offset:34816
v_mfma_f32_32x32x16_bf16 v[40:55], v[72:75], a[152:155], v[40:55]
ds_read_b64_tr_b16 v[98:99], v202 offset:35328
ds_read_b64_tr_b16 v[76:77], v203 offset:36864
ds_read_b64_tr_b16 v[78:79], v203 offset:37376
s_waitcnt lgkmcnt(10)
s_waitcnt vmcnt(6)
v_mfma_f32_32x32x16_bf16 v[104:119], v[84:87], a[156:159], v[104:119]
buffer_load_dwordx4 a[184:187], v1, s[28:31], s77 offen offset:2048 sc1
ds_read_b64_tr_b16 v[72:73], v202 offset:36864
ds_read_b64_tr_b16 v[74:75], v202 offset:37376
v_add_u32 v122, s46, v1
v_mfma_f32_32x32x16_bf16 v[40:55], v[80:83], a[156:159], v[40:55]
buffer_load_dwordx4 a[188:191], v1, s[28:31], s77 offen offset:3072 sc1
s_add_u32 s77, s80, s73
ds_read_b64_tr_b16 v[84:85], v203 offset:38912
s_waitcnt lgkmcnt(9)
s_waitcnt vmcnt(7)
v_mfma_f32_32x32x16_bf16 v[104:119], v[92:95], a[160:163], v[104:119]
ds_read_b64_tr_b16 v[86:87], v203 offset:39424
ds_read_b64_tr_b16 v[80:81], v202 offset:38912
ds_read_b64_tr_b16 v[82:83], v202 offset:39424
v_xor_b32 v123, 8192, v122
v_and_b32 v207, 31, v0
v_mfma_f32_32x32x16_bf16 v[40:55], v[88:91], a[160:163], v[40:55]
buffer_load_dwordx4 a[192:195], v1, s[28:31], s77 offen offset:0 sc1
v_lshlrev_b32 v207, 3, v207
v_lshrrev_b32 v33, 5, v0
s_waitcnt lgkmcnt(8)
s_waitcnt vmcnt(7)
v_mfma_f32_32x32x16_bf16 v[104:119], v[100:103], a[164:167], v[104:119]
s_barrier
buffer_load_dwordx4 a[196:199], v1, s[28:31], s77 offen offset:1024 sc1
v_mfma_f32_32x32x16_bf16 v[40:55], v[96:99], a[164:167], v[40:55]
ds_read_b64_tr_b16 v[92:93], v203 offset:49152
ds_read_b64_tr_b16 v[88:89], v202 offset:49152
ds_read_b64_tr_b16 v[94:95], v203 offset:49664
ds_read_b64_tr_b16 v[90:91], v202 offset:49664
s_waitcnt lgkmcnt(8)
s_waitcnt vmcnt(7)
v_mfma_f32_32x32x16_bf16 v[104:119], v[76:79], a[168:171], v[104:119]
buffer_load_dwordx4 a[200:203], v1, s[28:31], s77 offen offset:2048 sc1
ds_read_b64_tr_b16 v[100:101], v203 offset:51200
ds_read_b64_tr_b16 v[102:103], v203 offset:51712
ds_read_b64_tr_b16 v[96:97], v202 offset:51200
v_mfma_f32_32x32x16_bf16 v[40:55], v[72:75], a[168:171], v[40:55]
buffer_load_dwordx4 a[204:207], v1, s[28:31], s77 offen offset:3072 sc1
s_add_u32 s77, s80, s74
ds_read_b64_tr_b16 v[98:99], v202 offset:51712
s_waitcnt lgkmcnt(8)
s_waitcnt vmcnt(8)
v_mfma_f32_32x32x16_bf16 v[104:119], v[84:87], a[172:175], v[104:119]
ds_read_b64_tr_b16 v[76:77], v203 offset:53248
ds_read_b64_tr_b16 v[78:79], v203 offset:53760
ds_read_b64_tr_b16 v[72:73], v202 offset:53248
ds_read_b64_tr_b16 v[74:75], v202 offset:53760
v_lshl_add_u32 v207, v33, 2, v207
v_mfma_f32_32x32x16_bf16 v[40:55], v[80:83], a[172:175], v[40:55]
buffer_load_dwordx4 a[208:211], v1, s[28:31], s77 offen offset:0 sc1
s_add_u32 m0, s46, 32768
s_lshl4_add_u32 s38, s75, 65536
s_waitcnt lgkmcnt(8)
s_waitcnt vmcnt(8)
v_mfma_f32_32x32x16_bf16 v[104:119], v[92:95], a[176:179], v[104:119]
buffer_load_dwordx4 v208, s[20:23], s38 offen offset:0 lds
ds_read_b64_tr_b16 v[84:85], v203 offset:55296
ds_read_b64_tr_b16 v[86:87], v203 offset:55808
ds_read_b64_tr_b16 v[80:81], v202 offset:55296
v_mfma_f32_32x32x16_bf16 v[40:55], v[88:91], a[176:179], v[40:55]
ds_read_b64_tr_b16 v[82:83], v202 offset:55808
s_waitcnt lgkmcnt(8)
s_waitcnt vmcnt(8)
v_mfma_f32_32x32x16_bf16 v[104:119], v[100:103], a[180:183], v[104:119]
s_barrier
buffer_load_dwordx4 v209, s[20:23], s38 offen offset:1024 lds
v_mfma_f32_32x32x16_bf16 v[40:55], v[96:99], a[180:183], v[40:55]
s_add_u32 m0, s46, 32768
s_lshl4_add_u32 s38, s75, 65536
buffer_load_dwordx4 v210, s[20:23], s38 offen offset:2048 lds
s_waitcnt lgkmcnt(4)
s_waitcnt vmcnt(9)
v_mfma_f32_32x32x16_bf16 v[104:119], v[76:79], a[184:187], v[104:119]
ds_read_b64_tr_b16 v[92:93], v205 offset:0
ds_read_b64_tr_b16 v[88:89], v204 offset:0
ds_read_b64_tr_b16 v[94:95], v205 offset:512
ds_read_b64_tr_b16 v[90:91], v204 offset:512
v_mfma_f32_32x32x16_bf16 v[40:55], v[72:75], a[184:187], v[40:55]
buffer_load_dwordx4 v211, s[20:23], s38 offen offset:3072 lds
ds_read_b64_tr_b16 v[100:101], v205 offset:2048
ds_read_b64_tr_b16 v[102:103], v205 offset:2560
s_waitcnt lgkmcnt(6)
s_waitcnt vmcnt(9)
v_mfma_f32_32x32x16_bf16 v[104:119], v[84:87], a[188:191], v[104:119]
buffer_load_dwordx4 a[212:215], v1, s[28:31], s77 offen offset:1024 sc1
ds_read_b64_tr_b16 v[96:97], v204 offset:2048
ds_read_b64_tr_b16 v[98:99], v204 offset:2560
ds_read_b64_tr_b16 v[76:77], v205 offset:4096
v_mfma_f32_32x32x16_bf16 v[40:55], v[80:83], a[188:191], v[40:55]
ds_read_b64_tr_b16 v[78:79], v205 offset:4608
ds_read_b64_tr_b16 v[72:73], v204 offset:4096
ds_read_b64_tr_b16 v[74:75], v204 offset:4608
ds_read_b64_tr_b16 v[84:85], v205 offset:6144
s_waitcnt lgkmcnt(9)
s_waitcnt vmcnt(9)
v_mfma_f32_32x32x16_bf16 v[104:119], v[92:95], a[192:195], v[104:119]
buffer_load_dwordx4 a[216:219], v1, s[28:31], s77 offen offset:2048 sc1
ds_read_b64_tr_b16 v[86:87], v205 offset:6656
ds_read_b64_tr_b16 v[80:81], v204 offset:6144
ds_read_b64_tr_b16 v[82:83], v204 offset:6656
v_mfma_f32_32x32x16_bf16 v[40:55], v[88:91], a[192:195], v[40:55]
buffer_load_dwordx4 a[220:223], v1, s[28:31], s77 offen offset:3072 sc1
s_add_u32 s77, s80, s75
s_waitcnt lgkmcnt(8)
s_waitcnt vmcnt(10)
v_mfma_f32_32x32x16_bf16 v[104:119], v[100:103], a[196:199], v[104:119]
s_barrier
ds_read_b64_tr_b16 v[92:93], v201 offset:16384
ds_read_b64_tr_b16 v[88:89], v200 offset:16384
v_mfma_f32_32x32x16_bf16 v[40:55], v[96:99], a[196:199], v[40:55]
buffer_load_dwordx4 a[224:227], v1, s[28:31], s77 offen offset:0 sc1
ds_read_b64_tr_b16 v[94:95], v201 offset:16896
ds_read_b64_tr_b16 v[90:91], v200 offset:16896
s_waitcnt lgkmcnt(8)
s_waitcnt vmcnt(10)
v_mfma_f32_32x32x16_bf16 v[104:119], v[76:79], a[200:203], v[104:119]
buffer_load_dwordx4 a[228:231], v1, s[28:31], s77 offen offset:1024 sc1
ds_read_b64_tr_b16 v[100:101], v201 offset:18432
ds_read_b64_tr_b16 v[102:103], v201 offset:18944
ds_read_b64_tr_b16 v[96:97], v200 offset:18432
v_mfma_f32_32x32x16_bf16 v[40:55], v[72:75], a[200:203], v[40:55]
ds_read_b64_tr_b16 v[98:99], v200 offset:18944
ds_read_b64_tr_b16 v[76:77], v201 offset:20480
ds_read_b64_tr_b16 v[78:79], v201 offset:20992
s_waitcnt lgkmcnt(10)
s_waitcnt vmcnt(10)
v_mfma_f32_32x32x16_bf16 v[104:119], v[84:87], a[204:207], v[104:119]
buffer_load_dwordx4 a[232:235], v1, s[28:31], s77 offen offset:2048 sc1
ds_read_b64_tr_b16 v[72:73], v200 offset:20480
ds_read_b64_tr_b16 v[74:75], v200 offset:20992
v_mfma_f32_32x32x16_bf16 v[40:55], v[80:83], a[204:207], v[40:55]
buffer_load_dwordx4 a[236:239], v1, s[28:31], s77 offen offset:3072 sc1
ds_read_b64_tr_b16 v[84:85], v201 offset:22528
ds_read_b64_tr_b16 v[86:87], v201 offset:23040
s_waitcnt lgkmcnt(10)
s_waitcnt vmcnt(11)
v_mfma_f32_32x32x16_bf16 v[104:119], v[92:95], a[208:211], v[104:119]
v_mfma_f32_32x32x16_bf16 v[40:55], v[88:91], a[208:211], v[40:55]
s_waitcnt vmcnt(7)
s_barrier
ds_read_b64_tr_b16 v[92:93], v201 offset:32768
s_waitcnt lgkmcnt(7)
s_waitcnt vmcnt(6)
v_mfma_f32_32x32x16_bf16 v[104:119], v[100:103], a[212:215], v[104:119]
ds_read_b64_tr_b16 v[94:95], v201 offset:33280
v_mfma_f32_32x32x16_bf16 v[40:55], v[96:99], a[212:215], v[40:55]
ds_read_b64_tr_b16 v[100:101], v201 offset:34816
ds_read_b64_tr_b16 v[80:81], v200 offset:22528
ds_read_b64_tr_b16 v[102:103], v201 offset:35328
ds_read_b64_tr_b16 v[82:83], v200 offset:23040
s_waitcnt lgkmcnt(8)
s_waitcnt vmcnt(5)
v_mfma_f32_32x32x16_bf16 v[104:119], v[76:79], a[216:219], v[104:119]
ds_read_b64_tr_b16 v[88:89], v200 offset:32768
ds_read_b64_tr_b16 v[90:91], v200 offset:33280
v_mfma_f32_32x32x16_bf16 v[40:55], v[72:75], a[216:219], v[40:55]
ds_read_b64_tr_b16 v[76:77], v201 offset:36864
ds_read_b64_tr_b16 v[96:97], v200 offset:34816
ds_read_b64_tr_b16 v[78:79], v201 offset:37376
ds_read_b64_tr_b16 v[98:99], v200 offset:35328
s_waitcnt vmcnt(4) lgkmcnt(12)
v_mfma_f32_32x32x16_bf16 v[104:119], v[84:87], a[220:223], v[104:119]
ds_read_b64_tr_b16 v[72:73], v200 offset:36864
ds_read_b64_tr_b16 v[74:75], v200 offset:37376
s_waitcnt vmcnt(3) lgkmcnt(12)
v_mfma_f32_32x32x16_bf16 v[104:119], v[92:95], a[224:227], v[104:119]
ds_read_b64_tr_b16 v[84:85], v201 offset:38912
ds_read_b64_tr_b16 v[86:87], v201 offset:39424
s_waitcnt vmcnt(2) lgkmcnt(11)
v_mfma_f32_32x32x16_bf16 v[104:119], v[100:103], a[228:231], v[104:119]
s_waitcnt vmcnt(1) lgkmcnt(5)
v_mfma_f32_32x32x16_bf16 v[104:119], v[76:79], a[232:235], v[104:119]
s_waitcnt vmcnt(0) lgkmcnt(0)
v_mfma_f32_32x32x16_bf16 v[104:119], v[84:87], a[236:239], v[104:119]
v_mfma_f32_32x32x16_bf16 v[40:55], v[80:83], a[220:223], v[40:55]
v_mfma_f32_32x32x16_bf16 v[40:55], v[88:91], a[224:227], v[40:55]
ds_read_b64_tr_b16 v[80:81], v200 offset:38912
ds_read_b64_tr_b16 v[82:83], v200 offset:39424
s_nop 7
ds_write_b128 v122, v[104:107] offset:0
v_mfma_f32_32x32x16_bf16 v[40:55], v[96:99], a[228:231], v[40:55]
v_mfma_f32_32x32x16_bf16 v[40:55], v[72:75], a[232:235], v[40:55]
ds_write_b128 v122, v[108:111] offset:1024
s_waitcnt lgkmcnt(2)
v_mfma_f32_32x32x16_bf16 v[40:55], v[80:83], a[236:239], v[40:55]
ds_write_b128 v122, v[112:115] offset:2048
ds_write_b128 v122, v[116:119] offset:3072
s_waitcnt lgkmcnt(0)
s_barrier
ds_read_b128 v[56:59], v123 offset:0
ds_read_b128 v[60:63], v123 offset:1024
ds_read_b128 v[64:67], v123 offset:2048
ds_read_b128 v[68:71], v123 offset:3072
s_waitcnt lgkmcnt(3)
s_nop 2
v_pk_add_f32 v[40:41], v[40:41], v[56:57]
v_pk_add_f32 v[42:43], v[42:43], v[58:59]
v_cvt_pk_bf16_f32 v16, v40, v41
v_cvt_pk_bf16_f32 v17, v42, v43
s_waitcnt lgkmcnt(2)
v_pk_add_f32 v[44:45], v[44:45], v[60:61]
v_pk_add_f32 v[46:47], v[46:47], v[62:63]
v_cvt_pk_bf16_f32 v18, v44, v45
v_cvt_pk_bf16_f32 v19, v46, v47
s_waitcnt lgkmcnt(1)
v_pk_add_f32 v[48:49], v[48:49], v[64:65]
v_pk_add_f32 v[50:51], v[50:51], v[66:67]
v_cvt_pk_bf16_f32 v20, v48, v49
v_cvt_pk_bf16_f32 v21, v50, v51
s_waitcnt lgkmcnt(0)
v_pk_add_f32 v[52:53], v[52:53], v[68:69]
v_pk_add_f32 v[54:55], v[54:55], v[70:71]
v_cvt_pk_bf16_f32 v22, v52, v53
v_cvt_pk_bf16_f32 v23, v54, v55
buffer_store_dwordx4 v[16:19], v13, s[24:27], s39 offen
buffer_store_dwordx4 v[20:23], v13, s[24:27], s39 offen offset:32
s_add_u32 s88, s43, s36
s_cmp_lg_u32 s88, 0
s_cbranch_scc1 Lep29
s_lshl_b32 s88, s42, 7
s_add_u32 s88, s88, 12328960
s_add_u32 s89, s81, 16
v_mov_b32 v33, s89
v_mov_b32 v34, 0
s_mov_b64 exec, 1
buffer_store_dword v33, v34, s[28:31], s88 offen
s_mov_b64 exec, -1
Lep29:
L_end:
s_endpgm
Lalt1_b:
buffer_store_dwordx4 v[230:233], v1, s[28:31], s79 offen sc1
buffer_store_dwordx4 v[234:237], v1, s[28:31], s80 offen sc1
s_branch Lalt1_e
Lalt2_b:
buffer_store_dword v38, v15, s[28:31], 0 offen sc1
s_branch Lalt2_e
Lalt3_b:
buffer_store_dwordx4 v[16:19], v1, s[28:31], s79 offen sc1
buffer_store_dwordx4 v[20:23], v1, s[28:31], s79 offen offset:1024 sc1
s_branch Lalt3_e
Lalt4_b:
buffer_store_dword v88, v207, s[28:31], s80 offen sc1
s_branch Lalt4_e
Lalt5_b:
buffer_store_dword v38, v15, s[28:31], 0 offen sc1
s_branch Lalt5_e
Lalt6_b:
buffer_store_dwordx4 v[192:195], v1, s[28:31], s94 offen sc1
s_branch Lalt6_e
Lalt7_b:
buffer_store_dwordx4 v[196:199], v1, s[28:31], s94 offen sc1
s_branch Lalt7_e
Lalt8_b:
buffer_store_dwordx4 v[192:195], v1, s[28:31], s94 offen sc1
s_branch Lalt8_e
Lalt9_b:
buffer_store_dwordx4 v[196:199], v1, s[28:31], s94 offen sc1
s_branch Lalt9_e
Lalt14_b:
buffer_store_dword v38, v15, s[28:31], 0 offen sc1
s_branch Lalt14_e
Lalt10_b:
buffer_store_dwordx4 v[192:195], v1, s[28:31], s94 offen sc1
s_branch Lalt10_e
Lalt11_b:
buffer_store_dwordx4 v[196:199], v1, s[28:31], s94 offen sc1
s_branch Lalt11_e
Lalt12_b:
buffer_store_dwordx4 v[192:195], v1, s[28:31], s94 offen sc1
s_branch Lalt12_e
Lalt13_b:
buffer_store_dwordx4 v[196:199], v1, s[28:31], s94 offen sc1
s_branch Lalt13_e
Lalt15_b:
buffer_store_dword v38, v15, s[28:31], 0 offen sc1
s_branch Lalt15_e
Lalt16_b:
buffer_store_dwordx4 v[16:19], v242, s[28:31], s79 offen sc1
buffer_store_dwordx4 v[20:23], v242, s[28:31], s79 offen offset:32 sc1
s_branch Lalt16_e
Lalt17_b:
buffer_store_dword v88, v207, s[28:31], s80 offen sc1
s_branch Lalt17_e
Lalt18_b:
buffer_store_dword v38, v15, s[28:31], 0 offen sc1
s_branch Lalt18_e
Lalt19_b:
buffer_store_dwordx4 v[230:233], v1, s[28:31], s79 offen sc1
buffer_store_dwordx4 v[234:237], v1, s[28:31], s80 offen sc1
s_branch Lalt19_e
Lalt20_b:
buffer_store_dword v38, v15, s[28:31], 0 offen sc1
s_branch Lalt20_e
Lalt21_b:
buffer_store_dwordx4 v[16:19], v1, s[28:31], s79 offen sc1
buffer_store_dwordx4 v[20:23], v1, s[28:31], s79 offen offset:1024 sc1
s_branch Lalt21_e
Lalt22_b:
buffer_store_dword v88, v207, s[28:31], s80 offen sc1
s_branch Lalt22_e
Lalt23_b:
buffer_store_dword v38, v15, s[28:31], 0 offen sc1
s_branch Lalt23_e
Lalt24_b:
buffer_store_dwordx4 v[192:195], v1, s[28:31], s94 offen sc1
s_branch Lalt24_e
Lalt25_b:
buffer_store_dwordx4 v[196:199], v1, s[28:31], s94 offen sc1
s_branch Lalt25_e
Lalt26_b:
buffer_store_dwordx4 v[192:195], v1, s[28:31], s94 offen sc1
s_branch Lalt26_e
Lalt27_b:
buffer_store_dwordx4 v[196:199], v1, s[28:31], s94 offen sc1
s_branch Lalt27_e
Lalt32_b:
buffer_store_dword v38, v15, s[28:31], 0 offen sc1
s_branch Lalt32_e
Lalt28_b:
buffer_store_dwordx4 v[192:195], v1, s[28:31], s94 offen sc1
s_branch Lalt28_e
Lalt29_b:
buffer_store_dwordx4 v[196:199], v1, s[28:31], s94 offen sc1
s_branch Lalt29_e
Lalt30_b:
buffer_store_dwordx4 v[192:195], v1, s[28:31], s94 offen sc1
s_branch Lalt30_e
Lalt31_b:
buffer_store_dwordx4 v[196:199], v1, s[28:31], s94 offen sc1
s_branch Lalt31_e
Lalt33_b:
buffer_store_dword v38, v15, s[28:31], 0 offen sc1
s_branch Lalt33_e
Ls2:
s_mov_b32 s58, 0
Ls2_l:

buffer_load_dwordx2 v[198:199], v197, s[28:31], 0 offen sc1
s_add_u32 s58, s58, 1
s_cmp_gt_u32 s58, 30000
s_cbranch_scc1 Ls2_x
s_waitcnt vmcnt(0)

v_cmp_ne_u32 vcc, v33, v198
s_nop 0
s_and_b64 vcc, vcc, s[92:93]
s_cbranch_scc1 Ls2_l
Ls2_x:
s_waitcnt vmcnt(0) lgkmcnt(0)
s_branch Lb3
Ls7:
s_mov_b32 s58, 0
Ls7_l:

buffer_load_dword v38, v14, s[28:31], 0 offen sc1
s_add_u32 s58, s58, 1
s_cmp_gt_u32 s58, 30000
s_cbranch_scc1 Ls7_x
s_waitcnt vmcnt(0)

s_add_u32 s91, s81, 3
v_subrev_u32 v33, s91, v38
v_cmp_lt_u32 vcc, 7, v33
s_nop 0
s_and_b64 vcc, vcc, s[52:53]
s_cbranch_scc1 Ls7_l
Ls7_x:
s_waitcnt vmcnt(0) lgkmcnt(0)
s_branch Lb8
Ls10:
s_mov_b32 s58, 0
Ls10_l:

buffer_load_dword v127, v14, s[28:31], 0 offen sc1
s_add_u32 s58, s58, 1
s_cmp_gt_u32 s58, 30000
s_cbranch_scc1 Ls10_x
s_waitcnt vmcnt(0)

s_add_u32 s91, s81, 4
v_subrev_u32 v33, s91, v127
v_cmp_lt_u32 vcc, 7, v33
s_nop 0
s_and_b64 vcc, vcc, s[52:53]
s_cbranch_scc1 Ls10_l
Ls10_x:
s_waitcnt vmcnt(0) lgkmcnt(0)
s_branch Lb11
Lp3skip5:
s_lshl_b32 s88, s57, 15
s_lshl_b32 s89, s44, 12
s_add_u32 s88, s88, s89
s_and_b32 s89, s45, 2048
s_add_u32 s88, s88, s89
s_add_u32 s88, s88, 4194304
v_lshlrev_b32 v127, 7, v0
s_mov_b64 exec, 65535
buffer_load_dword v34, v127, s[28:31], s88 offen sc1
s_mov_b64 exec, -1
s_lshl_b32 s88, s57, 12
s_lshl_b32 s89, s44, 9
s_add_u32 s88, s88, s89
s_lshr_b32 s89, s36, 1
s_lshl_b32 s89, s89, 8
s_add_u32 s88, s88, s89
s_add_u32 s88, s88, 10485760
s_mov_b64 exec, 3
buffer_load_dword v34, v127, s[28:31], s88 offen sc1
s_mov_b64 exec, -1
s_lshr_b32 s88, s36, 1
s_lshl_b32 s89, s88, 13
v_add_u32 v200, s89, v11
v_add_u32 v201, s89, v12
v_add_u32 v202, 65536, v200
v_add_u32 v203, 65536, v201
v_add_u32 v204, 131072, v200
v_add_u32 v205, 131072, v201
s_mul_i32 s88, s88, 57344
s_mul_i32 s79, s57, 114688
s_add_u32 s79, s79, s88
s_add_u32 s79, s79, 16777216
s_add_u32 s80, s79, 4096
s_and_b32 s88, s42, 1
s_lshl_b32 s88, s88, 1
s_add_u32 s88, s88, s43
s_sub_u32 s88, s88, 14
s_lshl_b32 s88, s88, 2
s_add_u32 s88, s88, s36
v_lshlrev_b32 v40, 7, v0
v_lshlrev_b32 v42, 10, v0
v_add_u32 v42, 384, v42
s_lshl_b32 s89, s88, 16
s_add_u32 s89, s89, 0
buffer_load_dword v41, v42, s[20:23], s89 offen
s_waitcnt vmcnt(1)
s_lshl_b32 s89, s88, 16
s_add_u32 s89, s89, 1048576
buffer_load_dword v41, v42, s[20:23], s89 offen
s_waitcnt vmcnt(1)
s_add_u32 m0, s46, 131072
s_lshl4_add_u32 s38, s69, 0
buffer_load_dwordx4 v208, s[20:23], s38 offen offset:0 lds
buffer_load_dwordx4 v209, s[20:23], s38 offen offset:1024 lds
s_add_u32 m0, s46, 131072
s_lshl4_add_u32 s38, s69, 0
buffer_load_dwordx4 v210, s[20:23], s38 offen offset:2048 lds
buffer_load_dwordx4 v211, s[20:23], s38 offen offset:3072 lds
s_add_u32 m0, s46, 32768
s_lshl4_add_u32 s38, s70, 0
buffer_load_dwordx4 v208, s[20:23], s38 offen offset:0 lds
buffer_load_dwordx4 v209, s[20:23], s38 offen offset:1024 lds
s_add_u32 m0, s46, 32768
s_lshl4_add_u32 s38, s70, 0
buffer_load_dwordx4 v210, s[20:23], s38 offen offset:2048 lds
buffer_load_dwordx4 v211, s[20:23], s38 offen offset:3072 lds
s_add_u32 m0, s46, 49152
s_lshl4_add_u32 s38, s71, 0
buffer_load_dwordx4 v208, s[20:23], s38 offen offset:0 lds
buffer_load_dwordx4 v209, s[20:23], s38 offen offset:1024 lds
s_add_u32 m0, s46, 49152
s_lshl4_add_u32 s38, s71, 0
buffer_load_dwordx4 v210, s[20:23], s38 offen offset:2048 lds
buffer_load_dwordx4 v211, s[20:23], s38 offen offset:3072 lds
s_add_u32 m0, s46, 65536
s_lshl4_add_u32 s38, s72, 0
buffer_load_dwordx4 v208, s[20:23], s38 offen offset:0 lds
buffer_load_dwordx4 v209, s[20:23], s38 offen offset:1024 lds
s_add_u32 m0, s46, 65536
s_lshl4_add_u32 s38, s72, 0
buffer_load_dwordx4 v210, s[20:23], s38 offen offset:2048 lds
buffer_load_dwordx4 v211, s[20:23], s38 offen offset:3072 lds
s_add_u32 m0, s46, 81920
s_lshl4_add_u32 s38, s73, 0
buffer_load_dwordx4 v208, s[20:23], s38 offen offset:0 lds
buffer_load_dwordx4 v209, s[20:23], s38 offen offset:1024 lds
s_add_u32 m0, s46, 81920
s_lshl4_add_u32 s38, s73, 0
buffer_load_dwordx4 v210, s[20:23], s38 offen offset:2048 lds
buffer_load_dwordx4 v211, s[20:23], s38 offen offset:3072 lds
s_add_u32 m0, s46, 0
s_lshl4_add_u32 s38, s74, 0
buffer_load_dwordx4 v208, s[20:23], s38 offen offset:0 lds
buffer_load_dwordx4 v209, s[20:23], s38 offen offset:1024 lds
s_add_u32 m0, s46, 0
s_lshl4_add_u32 s38, s74, 0
buffer_load_dwordx4 v210, s[20:23], s38 offen offset:2048 lds
buffer_load_dwordx4 v211, s[20:23], s38 offen offset:3072 lds
s_add_u32 m0, s46, 16384
s_lshl4_add_u32 s38, s75, 0
buffer_load_dwordx4 v208, s[20:23], s38 offen offset:0 lds
buffer_load_dwordx4 v209, s[20:23], s38 offen offset:1024 lds
s_add_u32 m0, s46, 16384
s_lshl4_add_u32 s38, s75, 0
buffer_load_dwordx4 v210, s[20:23], s38 offen offset:2048 lds
buffer_load_dwordx4 v211, s[20:23], s38 offen offset:3072 lds
s_and_b32 s88, s42, 1
s_lshl_b32 s88, s88, 1
s_add_u32 s88, s88, s43
s_sub_u32 s88, s88, 14
s_lshl_b32 s88, s88, 2
s_add_u32 s88, s88, s36
v_lshlrev_b32 v40, 7, v0
v_lshlrev_b32 v42, 10, v0
v_add_u32 v42, 384, v42
s_add_u32 s91, s81, 3
s_mov_b32 s58, 30000
Lpl12:
buffer_load_dword v38, v14, s[28:31], 0 offen sc1
s_sub_u32 s58, s58, 1
s_cmp_eq_u32 s58, 0
s_cselect_b64 s[88:89], 0, s[52:53]
s_waitcnt vmcnt(0)
v_subrev_u32 v33, s91, v38
v_cmp_lt_u32 vcc, 7, v33
s_nop 0
s_and_b64 vcc, vcc, s[88:89]
s_cbranch_scc1 Lpl12
s_and_b32 s88, s42, 1
s_lshl_b32 s88, s88, 1
s_add_u32 s88, s88, s43
s_sub_u32 s88, s88, 14
s_lshl_b32 s88, s88, 2
s_add_u32 s88, s88, s36
v_lshlrev_b32 v40, 7, v0
v_lshlrev_b32 v42, 10, v0
v_add_u32 v42, 384, v42
s_lshl_b32 s89, s88, 16
s_add_u32 s89, s89, 0
buffer_load_dword v41, v42, s[8:11], s89 offen
s_waitcnt vmcnt(1)
s_lshl_b32 s89, s88, 16
s_add_u32 s89, s89, 1048576
buffer_load_dword v41, v42, s[8:11], s89 offen
s_waitcnt vmcnt(1)
s_lshl_b32 s89, s88, 16
s_add_u32 s89, s89, 0
buffer_load_dword v41, v42, s[12:15], s89 offen
s_waitcnt vmcnt(1)
s_add_u32 s77, s79, s69
buffer_load_dwordx4 v[128:131], v1, s[28:31], s77 offen offset:0 sc1
buffer_load_dwordx4 v[132:135], v1, s[28:31], s77 offen offset:1024 sc1
buffer_load_dwordx4 v[136:139], v1, s[28:31], s77 offen offset:2048 sc1
buffer_load_dwordx4 v[140:143], v1, s[28:31], s77 offen offset:3072 sc1
s_add_u32 s77, s79, s70
buffer_load_dwordx4 v[144:147], v1, s[28:31], s77 offen offset:0 sc1
buffer_load_dwordx4 v[148:151], v1, s[28:31], s77 offen offset:1024 sc1
buffer_load_dwordx4 v[152:155], v1, s[28:31], s77 offen offset:2048 sc1
buffer_load_dwordx4 v[156:159], v1, s[28:31], s77 offen offset:3072 sc1
s_add_u32 s77, s79, s71
buffer_load_dwordx4 v[160:163], v1, s[28:31], s77 offen offset:0 sc1
buffer_load_dwordx4 v[164:167], v1, s[28:31], s77 offen offset:1024 sc1
buffer_load_dwordx4 v[168:171], v1, s[28:31], s77 offen offset:2048 sc1
buffer_load_dwordx4 v[172:175], v1, s[28:31], s77 offen offset:3072 sc1
s_add_u32 s77, s79, s72
buffer_load_dwordx4 v[176:179], v1, s[28:31], s77 offen offset:0 sc1
buffer_load_dwordx4 v[180:183], v1, s[28:31], s77 offen offset:1024 sc1
buffer_load_dwordx4 v[184:187], v1, s[28:31], s77 offen offset:2048 sc1
buffer_load_dwordx4 v[188:191], v1, s[28:31], s77 offen offset:3072 sc1
s_add_u32 s77, s79, s73
buffer_load_dwordx4 v[224:227], v1, s[28:31], s77 offen offset:0 sc1
buffer_load_dwordx4 v[228:231], v1, s[28:31], s77 offen offset:1024 sc1
buffer_load_dwordx4 v[232:235], v1, s[28:31], s77 offen offset:2048 sc1
buffer_load_dwordx4 v[236:239], v1, s[28:31], s77 offen offset:3072 sc1
s_add_u32 s77, s79, s74
buffer_load_dwordx4 v[248:251], v1, s[28:31], s77 offen offset:0 sc1
buffer_load_dwordx4 v[252:255], v1, s[28:31], s77 offen offset:1024 sc1
s_waitcnt vmcnt(0)
s_barrier
ds_read_b64_tr_b16 v[92:93], v205 offset:0
ds_read_b64_tr_b16 v[94:95], v205 offset:512
ds_read_b64_tr_b16 v[88:89], v204 offset:0
ds_read_b64_tr_b16 v[90:91], v204 offset:512
ds_read_b64_tr_b16 v[100:101], v205 offset:2048
ds_read_b64_tr_b16 v[102:103], v205 offset:2560
ds_read_b64_tr_b16 v[96:97], v204 offset:2048
ds_read_b64_tr_b16 v[98:99], v204 offset:2560
v_lshlrev_b32 v40, 16, v16
v_and_b32 v41, 0xffff0000, v16
v_lshlrev_b32 v42, 16, v17
v_and_b32 v43, 0xffff0000, v17
v_lshlrev_b32 v44, 16, v18
v_and_b32 v45, 0xffff0000, v18
v_lshlrev_b32 v46, 16, v19
v_and_b32 v47, 0xffff0000, v19
v_lshlrev_b32 v48, 16, v20
v_and_b32 v49, 0xffff0000, v20
v_lshlrev_b32 v50, 16, v21
v_and_b32 v51, 0xffff0000, v21
v_lshlrev_b32 v52, 16, v22
v_and_b32 v53, 0xffff0000, v22
v_lshlrev_b32 v54, 16, v23
v_and_b32 v55, 0xffff0000, v23
s_waitcnt lgkmcnt(0)
s_branch Lp3join9

Ls16:
s_mov_b32 s58, 0
Ls16_l:

s_mov_b32 s93, m0
s_add_u32 m0, s61, 65536
s_lshl_b32 s90, s36, 8
s_add_u32 s90, s90, 0
s_xor_b32 s90, s90, s3
s_lshl_b32 s90, s90, 3
s_add_u32 s90, s90, s78
buffer_load_dwordx4 v120, s[28:31], s90 offen sc1 lds
s_add_u32 m0, s61, 66560
s_lshl_b32 s90, s36, 8
s_add_u32 s90, s90, 128
s_xor_b32 s90, s90, s3
s_lshl_b32 s90, s90, 3
s_add_u32 s90, s90, s78
buffer_load_dwordx4 v120, s[28:31], s90 offen sc1 lds
s_mov_b32 m0, s93
s_add_u32 s58, s58, 1
s_cmp_gt_u32 s58, 30000
s_cbranch_scc1 Ls16_x
s_waitcnt vmcnt(0)
ds_read_b32 v122, v121
ds_read_b32 v123, v121 offset:1024
s_waitcnt lgkmcnt(0)
v_max_u32 v122, v122, v123
v_cmp_eq_u32 vcc, -1, v122
s_nop 0
s_and_b64 vcc, vcc, exec
s_cbranch_scc1 Ls16_l
Ls16_x:
s_waitcnt vmcnt(0) lgkmcnt(0)
s_branch Lb17
Ls18:
s_mov_b32 s58, 0
Ls18_l:

buffer_load_dword v125, v124, s[28:31], s94 offen sc1
s_add_u32 s58, s58, 1
s_cmp_gt_u32 s58, 30000
s_cbranch_scc1 Ls18_x
s_waitcnt vmcnt(0)

v_cmp_eq_u32 vcc, -1, v125
s_nop 0
s_and_b64 vcc, vcc, exec
s_cbranch_scc1 Ls18_l
Ls18_x:
s_waitcnt vmcnt(0) lgkmcnt(0)
s_branch Lb19
Ls23:
s_mov_b32 s58, 0
Ls23_l:

buffer_load_dword v38, v14, s[28:31], 0 offen sc1
s_add_u32 s58, s58, 1
s_cmp_gt_u32 s58, 30000
s_cbranch_scc1 Ls23_x
s_waitcnt vmcnt(0)

s_add_u32 s91, s81, 8
v_subrev_u32 v33, s91, v38
v_cmp_lt_u32 vcc, 7, v33
s_nop 0
s_and_b64 vcc, vcc, s[52:53]
s_cbranch_scc1 Ls23_l
Ls23_x:
s_waitcnt vmcnt(0) lgkmcnt(0)
s_branch Lb24
Ls26:
s_mov_b32 s58, 0
Ls26_l:

buffer_load_dword v127, v14, s[28:31], 0 offen sc1
s_add_u32 s58, s58, 1
s_cmp_gt_u32 s58, 30000
s_cbranch_scc1 Ls26_x
s_waitcnt vmcnt(0)

s_add_u32 s91, s81, 9
v_subrev_u32 v33, s91, v127
v_cmp_lt_u32 vcc, 7, v33
s_nop 0
s_and_b64 vcc, vcc, s[52:53]
s_cbranch_scc1 Ls26_l
Ls26_x:
s_waitcnt vmcnt(0) lgkmcnt(0)
s_branch Lb27
Lp3skip21:
s_lshr_b32 s88, s36, 1
s_lshl_b32 s89, s88, 13
v_add_u32 v200, s89, v11
v_add_u32 v201, s89, v12
v_add_u32 v202, 65536, v200
v_add_u32 v203, 65536, v201
v_add_u32 v204, 131072, v200
v_add_u32 v205, 131072, v201
s_mul_i32 s88, s88, 57344
s_mul_i32 s79, s57, 114688
s_add_u32 s79, s79, s88
s_add_u32 s79, s79, 16777216
s_add_u32 s80, s79, 4096
s_and_b32 s88, s42, 1
s_lshl_b32 s88, s88, 1
s_add_u32 s88, s88, s43
s_sub_u32 s88, s88, 14
s_lshl_b32 s88, s88, 2
s_add_u32 s88, s88, s36
v_lshlrev_b32 v40, 7, v0
v_lshlrev_b32 v42, 10, v0
v_add_u32 v42, 384, v42
s_lshl_b32 s89, s88, 16
s_add_u32 s89, s89, 0
buffer_load_dword v41, v42, s[20:23], s89 offen
s_waitcnt vmcnt(1)
s_lshl_b32 s89, s88, 16
s_add_u32 s89, s89, 1048576
buffer_load_dword v41, v42, s[20:23], s89 offen
s_waitcnt vmcnt(1)
s_add_u32 m0, s46, 131072
s_lshl4_add_u32 s38, s69, 0
buffer_load_dwordx4 v208, s[20:23], s38 offen offset:0 lds
buffer_load_dwordx4 v209, s[20:23], s38 offen offset:1024 lds
s_add_u32 m0, s46, 131072
s_lshl4_add_u32 s38, s69, 0
buffer_load_dwordx4 v210, s[20:23], s38 offen offset:2048 lds
buffer_load_dwordx4 v211, s[20:23], s38 offen offset:3072 lds
s_waitcnt vmcnt(0)
s_barrier
ds_read_b64_tr_b16 v[132:133], v205 offset:0
ds_read_b64_tr_b16 v[134:135], v205 offset:512
ds_read_b64_tr_b16 v[128:129], v204 offset:0
ds_read_b64_tr_b16 v[130:131], v204 offset:512
ds_read_b64_tr_b16 v[140:141], v205 offset:2048
ds_read_b64_tr_b16 v[142:143], v205 offset:2560
ds_read_b64_tr_b16 v[136:137], v204 offset:2048
ds_read_b64_tr_b16 v[138:139], v204 offset:2560
ds_read_b64_tr_b16 v[148:149], v205 offset:4096
ds_read_b64_tr_b16 v[150:151], v205 offset:4608
ds_read_b64_tr_b16 v[144:145], v204 offset:4096
ds_read_b64_tr_b16 v[146:147], v204 offset:4608
ds_read_b64_tr_b16 v[156:157], v205 offset:6144
ds_read_b64_tr_b16 v[158:159], v205 offset:6656
ds_read_b64_tr_b16 v[152:153], v204 offset:6144
ds_read_b64_tr_b16 v[154:155], v204 offset:6656
s_waitcnt lgkmcnt(0)
s_barrier
s_add_u32 m0, s46, 131072
s_lshl4_add_u32 s38, s70, 0
buffer_load_dwordx4 v208, s[20:23], s38 offen offset:0 lds
buffer_load_dwordx4 v209, s[20:23], s38 offen offset:1024 lds
s_add_u32 m0, s46, 131072
s_lshl4_add_u32 s38, s70, 0
buffer_load_dwordx4 v210, s[20:23], s38 offen offset:2048 lds
buffer_load_dwordx4 v211, s[20:23], s38 offen offset:3072 lds
s_waitcnt vmcnt(0)
s_barrier
ds_read_b64_tr_b16 v[164:165], v205 offset:0
ds_read_b64_tr_b16 v[166:167], v205 offset:512
ds_read_b64_tr_b16 v[160:161], v204 offset:0
ds_read_b64_tr_b16 v[162:163], v204 offset:512
ds_read_b64_tr_b16 v[172:173], v205 offset:2048
ds_read_b64_tr_b16 v[174:175], v205 offset:2560
ds_read_b64_tr_b16 v[168:169], v204 offset:2048
ds_read_b64_tr_b16 v[170:171], v204 offset:2560
ds_read_b64_tr_b16 v[180:181], v205 offset:4096
ds_read_b64_tr_b16 v[182:183], v205 offset:4608
ds_read_b64_tr_b16 v[176:177], v204 offset:4096
ds_read_b64_tr_b16 v[178:179], v204 offset:4608
ds_read_b64_tr_b16 v[188:189], v205 offset:6144
ds_read_b64_tr_b16 v[190:191], v205 offset:6656
ds_read_b64_tr_b16 v[184:185], v204 offset:6144
ds_read_b64_tr_b16 v[186:187], v204 offset:6656
s_waitcnt lgkmcnt(0)
s_barrier
s_add_u32 m0, s46, 131072
s_lshl4_add_u32 s38, s71, 0
buffer_load_dwordx4 v208, s[20:23], s38 offen offset:0 lds
buffer_load_dwordx4 v209, s[20:23], s38 offen offset:1024 lds
s_add_u32 m0, s46, 131072
s_lshl4_add_u32 s38, s71, 0
buffer_load_dwordx4 v210, s[20:23], s38 offen offset:2048 lds
buffer_load_dwordx4 v211, s[20:23], s38 offen offset:3072 lds
s_add_u32 m0, s46, 0
s_lshl4_add_u32 s38, s72, 0
buffer_load_dwordx4 v208, s[20:23], s38 offen offset:0 lds
buffer_load_dwordx4 v209, s[20:23], s38 offen offset:1024 lds
s_add_u32 m0, s46, 0
s_lshl4_add_u32 s38, s72, 0
buffer_load_dwordx4 v210, s[20:23], s38 offen offset:2048 lds
buffer_load_dwordx4 v211, s[20:23], s38 offen offset:3072 lds
s_add_u32 m0, s46, 16384
s_lshl4_add_u32 s38, s73, 0
buffer_load_dwordx4 v208, s[20:23], s38 offen offset:0 lds
buffer_load_dwordx4 v209, s[20:23], s38 offen offset:1024 lds
s_add_u32 m0, s46, 16384
s_lshl4_add_u32 s38, s73, 0
buffer_load_dwordx4 v210, s[20:23], s38 offen offset:2048 lds
buffer_load_dwordx4 v211, s[20:23], s38 offen offset:3072 lds
s_add_u32 m0, s46, 32768
s_lshl4_add_u32 s38, s74, 0
buffer_load_dwordx4 v208, s[20:23], s38 offen offset:0 lds
buffer_load_dwordx4 v209, s[20:23], s38 offen offset:1024 lds
s_add_u32 m0, s46, 32768
s_lshl4_add_u32 s38, s74, 0
buffer_load_dwordx4 v210, s[20:23], s38 offen offset:2048 lds
buffer_load_dwordx4 v211, s[20:23], s38 offen offset:3072 lds
s_add_u32 m0, s46, 49152
s_lshl4_add_u32 s38, s75, 0
buffer_load_dwordx4 v208, s[20:23], s38 offen offset:0 lds
buffer_load_dwordx4 v209, s[20:23], s38 offen offset:1024 lds
s_add_u32 m0, s46, 49152
s_lshl4_add_u32 s38, s75, 0
buffer_load_dwordx4 v210, s[20:23], s38 offen offset:2048 lds
buffer_load_dwordx4 v211, s[20:23], s38 offen offset:3072 lds
s_add_u32 m0, s46, 65536
s_lshl4_add_u32 s38, s69, 65536
buffer_load_dwordx4 v208, s[20:23], s38 offen offset:0 lds
buffer_load_dwordx4 v209, s[20:23], s38 offen offset:1024 lds
s_add_u32 m0, s46, 65536
s_lshl4_add_u32 s38, s69, 65536
buffer_load_dwordx4 v210, s[20:23], s38 offen offset:2048 lds
buffer_load_dwordx4 v211, s[20:23], s38 offen offset:3072 lds
s_and_b32 s88, s42, 1
s_lshl_b32 s88, s88, 1
s_add_u32 s88, s88, s43
s_sub_u32 s88, s88, 14
s_lshl_b32 s88, s88, 2
s_add_u32 s88, s88, s36
v_lshlrev_b32 v40, 7, v0
v_lshlrev_b32 v42, 10, v0
v_add_u32 v42, 384, v42
s_mul_i32 s89, s88, 7
s_add_u32 s89, s89, 0
s_lshr_b32 s90, s89, 3
s_lshl_b32 s90, s90, 17
s_and_b32 s89, s89, 7
s_lshl_b32 s89, s89, 13
s_add_u32 s89, s89, s90
s_add_u32 s89, s89, 65536
buffer_load_dword v41, v40, s[20:23], s89 offen
s_waitcnt vmcnt(1)
s_mul_i32 s89, s88, 7
s_add_u32 s89, s89, 1
s_lshr_b32 s90, s89, 3
s_lshl_b32 s90, s90, 17
s_and_b32 s89, s89, 7
s_lshl_b32 s89, s89, 13
s_add_u32 s89, s89, s90
s_add_u32 s89, s89, 65536
buffer_load_dword v41, v40, s[20:23], s89 offen
s_waitcnt vmcnt(1)
s_mul_i32 s89, s88, 7
s_add_u32 s89, s89, 2
s_lshr_b32 s90, s89, 3
s_lshl_b32 s90, s90, 17
s_and_b32 s89, s89, 7
s_lshl_b32 s89, s89, 13
s_add_u32 s89, s89, s90
s_add_u32 s89, s89, 65536
buffer_load_dword v41, v40, s[20:23], s89 offen
s_waitcnt vmcnt(1)
s_mul_i32 s89, s88, 7
s_add_u32 s89, s89, 3
s_lshr_b32 s90, s89, 3
s_lshl_b32 s90, s90, 17
s_and_b32 s89, s89, 7
s_lshl_b32 s89, s89, 13
s_add_u32 s89, s89, s90
s_add_u32 s89, s89, 65536
buffer_load_dword v41, v40, s[20:23], s89 offen
s_waitcnt vmcnt(1)
s_mul_i32 s89, s88, 7
s_add_u32 s89, s89, 4
s_lshr_b32 s90, s89, 3
s_lshl_b32 s90, s90, 17
s_and_b32 s89, s89, 7
s_lshl_b32 s89, s89, 13
s_add_u32 s89, s89, s90
s_add_u32 s89, s89, 65536
buffer_load_dword v41, v40, s[20:23], s89 offen
s_waitcnt vmcnt(1)
s_mul_i32 s89, s88, 7
s_add_u32 s89, s89, 5
s_lshr_b32 s90, s89, 3
s_lshl_b32 s90, s90, 17
s_and_b32 s89, s89, 7
s_lshl_b32 s89, s89, 13
s_add_u32 s89, s89, s90
s_add_u32 s89, s89, 65536
buffer_load_dword v41, v40, s[20:23], s89 offen
s_waitcnt vmcnt(1)
s_mul_i32 s89, s88, 7
s_add_u32 s89, s89, 6
s_lshr_b32 s90, s89, 3
s_lshl_b32 s90, s90, 17
s_and_b32 s89, s89, 7
s_lshl_b32 s89, s89, 13
s_add_u32 s89, s89, s90
s_add_u32 s89, s89, 65536
buffer_load_dword v41, v40, s[20:23], s89 offen
s_waitcnt vmcnt(1)
s_add_u32 s91, s81, 8
s_mov_b32 s58, 30000
Lpl28:
buffer_load_dword v38, v14, s[28:31], 0 offen sc1
s_sub_u32 s58, s58, 1
s_cmp_eq_u32 s58, 0
s_cselect_b64 s[88:89], 0, s[52:53]
s_waitcnt vmcnt(0)
v_subrev_u32 v33, s91, v38
v_cmp_lt_u32 vcc, 7, v33
s_nop 0
s_and_b64 vcc, vcc, s[88:89]
s_cbranch_scc1 Lpl28
s_add_u32 s77, s79, s69
buffer_load_dwordx4 a[0:3], v1, s[28:31], s77 offen offset:0 sc1
buffer_load_dwordx4 a[4:7], v1, s[28:31], s77 offen offset:1024 sc1
buffer_load_dwordx4 a[8:11], v1, s[28:31], s77 offen offset:2048 sc1
buffer_load_dwordx4 a[12:15], v1, s[28:31], s77 offen offset:3072 sc1
s_add_u32 s77, s79, s70
buffer_load_dwordx4 a[16:19], v1, s[28:31], s77 offen offset:0 sc1
buffer_load_dwordx4 a[20:23], v1, s[28:31], s77 offen offset:1024 sc1
buffer_load_dwordx4 a[24:27], v1, s[28:31], s77 offen offset:2048 sc1
buffer_load_dwordx4 a[28:31], v1, s[28:31], s77 offen offset:3072 sc1
s_add_u32 s77, s79, s71
buffer_load_dwordx4 a[32:35], v1, s[28:31], s77 offen offset:0 sc1
buffer_load_dwordx4 a[36:39], v1, s[28:31], s77 offen offset:1024 sc1
buffer_load_dwordx4 a[40:43], v1, s[28:31], s77 offen offset:2048 sc1
buffer_load_dwordx4 a[44:47], v1, s[28:31], s77 offen offset:3072 sc1
s_add_u32 s77, s79, s72
buffer_load_dwordx4 a[48:51], v1, s[28:31], s77 offen offset:0 sc1
buffer_load_dwordx4 a[52:55], v1, s[28:31], s77 offen offset:1024 sc1
buffer_load_dwordx4 a[56:59], v1, s[28:31], s77 offen offset:2048 sc1
buffer_load_dwordx4 a[60:63], v1, s[28:31], s77 offen offset:3072 sc1
s_add_u32 s77, s79, s73
buffer_load_dwordx4 a[64:67], v1, s[28:31], s77 offen offset:0 sc1
buffer_load_dwordx4 a[68:71], v1, s[28:31], s77 offen offset:1024 sc1
buffer_load_dwordx4 a[72:75], v1, s[28:31], s77 offen offset:2048 sc1
buffer_load_dwordx4 a[76:79], v1, s[28:31], s77 offen offset:3072 sc1
s_add_u32 s77, s79, s74
buffer_load_dwordx4 a[80:83], v1, s[28:31], s77 offen offset:0 sc1
buffer_load_dwordx4 a[84:87], v1, s[28:31], s77 offen offset:1024 sc1
buffer_load_dwordx4 a[88:91], v1, s[28:31], s77 offen offset:2048 sc1
buffer_load_dwordx4 a[92:95], v1, s[28:31], s77 offen offset:3072 sc1
s_add_u32 s77, s79, s75
buffer_load_dwordx4 a[96:99], v1, s[28:31], s77 offen offset:0 sc1
buffer_load_dwordx4 a[100:103], v1, s[28:31], s77 offen offset:1024 sc1
buffer_load_dwordx4 a[104:107], v1, s[28:31], s77 offen offset:2048 sc1
buffer_load_dwordx4 a[108:111], v1, s[28:31], s77 offen offset:3072 sc1
s_waitcnt vmcnt(0)
s_barrier
v_lshlrev_b32 v40, 16, v16
v_and_b32 v41, 0xffff0000, v16
v_lshlrev_b32 v42, 16, v17
v_and_b32 v43, 0xffff0000, v17
v_lshlrev_b32 v44, 16, v18
v_and_b32 v45, 0xffff0000, v18
v_lshlrev_b32 v46, 16, v19
v_and_b32 v47, 0xffff0000, v19
v_lshlrev_b32 v48, 16, v20
v_and_b32 v49, 0xffff0000, v20
v_lshlrev_b32 v50, 16, v21
v_and_b32 v51, 0xffff0000, v21
v_lshlrev_b32 v52, 16, v22
v_and_b32 v53, 0xffff0000, v22
v_lshlrev_b32 v54, 16, v23
v_and_b32 v55, 0xffff0000, v23
s_waitcnt lgkmcnt(0)
s_branch Lp3join25

Lpage12:
s_branch Ltour2
L_last:
s_endpgm
.section .rodata,"a"
.p2align 6
.amdhsa_kernel interleave_layers__sliding_local_dilated__glu_gated_glu__prompt_kernel
  .amdhsa_next_free_vgpr 512
  .amdhsa_next_free_sgpr 102
  .amdhsa_accum_offset 256
  .amdhsa_group_segment_fixed_size 0
  .amdhsa_kernarg_size 80
  .amdhsa_user_sgpr_count 2
  .amdhsa_user_sgpr_kernarg_segment_ptr 1
  .amdhsa_system_sgpr_workgroup_id_x 1
  .amdhsa_float_denorm_mode_32 3
.end_amdhsa_kernel
```
